```python
import torch

def _softmax(x, axis=-1):
    return torch.softmax(x, dim=axis)
def _gelu(x):
    return torch.nn.functional.gelu(x, approximate="tanh")
def _silu(x):
    return torch.nn.functional.silu(x)
def _sigmoid(x):
    return torch.sigmoid(x)
def _layernorm(x, axis=-1, eps=1e-5):
    m = x.mean(dim=axis, keepdim=True)
    v = x.var(dim=axis, keepdim=True, unbiased=False)
    return (x - m) / torch.sqrt(v + eps)
def _scatter_add(tgt, idx, src, axis=0):
    return tgt.clone().index_add_(axis, idx, src)
def _segment_sum(src, seg, n):
    out = torch.zeros((n,) + src.shape[1:], dtype=src.dtype)
    return out.index_add_(0, seg, src)
def _pad(x, pw):
    flat = tuple(v for pair in reversed(pw) for v in pair)
    return torch.nn.functional.pad(x, flat)

kernel_name = 'gated_mix__spectral_fnet__swiglu_ffn__prompt'

def setup_inputs():

    _w = (lambda a: (lambda t: t.to(torch.bfloat16) if t.is_floating_point() else t)(torch.as_tensor(a)))
    def _A_setup():
        B, S, D = 1, 2048, 576
        ns = torch.arange(S)[:, None] * torch.arange(S)[None, :]
        nd = torch.arange(D)[:, None] * torch.arange(D)[None, :]
        Ws_re = torch.cos(-2.0 * torch.pi * ns / S).to(float)
        Ws_im = torch.sin(-2.0 * torch.pi * ns / S).to(float)
        Wd_re = torch.cos(-2.0 * torch.pi * nd / D).to(float)
        Wd_im = torch.sin(-2.0 * torch.pi * nd / D).to(float)
        return {
            "x": _w((lambda *s: torch.randn(*s, dtype=torch.bfloat16) * 0.05)(B, S, D)),
            "dft_seq_re": _w(Ws_re),
            "dft_seq_im": _w(Ws_im),
            "dft_hid_re": _w(Wd_re),
            "dft_hid_im": _w(Wd_im),
        }
    _A_in = _A_setup()

    def _B_setup():
        B, S, D, F = 1, 2048, 576, 4608
        return {
            "x": _w((lambda *s: torch.randn(*s, dtype=torch.bfloat16) * 0.05)(B, S, D)),
            "w_gate": _w((lambda *s: torch.randn(*s, dtype=torch.bfloat16) * 0.8)(D, F)),
            "w_up": _w((lambda *s: torch.randn(*s, dtype=torch.bfloat16) * 0.8)(D, F)),
            "w_down": _w((lambda *s: torch.randn(*s, dtype=torch.bfloat16) * 0.8)(F, D)),
        }
    _B_in = _B_setup()

    return {
        "A_x": _A_in["x"],
        "A_dft_seq_re": _A_in["dft_seq_re"],
        "A_dft_seq_im": _A_in["dft_seq_im"],
        "A_dft_hid_re": _A_in["dft_hid_re"],
        "A_dft_hid_im": _A_in["dft_hid_im"],
        "B_x": _B_in["x"],
        "B_w_gate": _B_in["w_gate"],
        "B_w_up": _B_in["w_up"],
        "B_w_down": _B_in["w_down"],
        "gate_w": _w((lambda *s: torch.randn(*s, dtype=torch.bfloat16) * 0.05)(576) * 16.0),
    }

def reference(A_x, A_dft_seq_re, A_dft_seq_im, A_dft_hid_re, A_dft_hid_im, B_x, B_w_gate, B_w_up, B_w_down, gate_w):
    def _A_ref(x, dft_seq_re, dft_seq_im, dft_hid_re, dft_hid_im):
        a = torch.einsum("bsd,ed->bse", x, dft_hid_re)
        b = torch.einsum("bsd,ed->bse", x, dft_hid_im)
        y = torch.einsum("ts,bse->bte", dft_seq_re, a) - torch.einsum("ts,bse->bte", dft_seq_im, b)
        return y

    def _B_ref(x, w_gate, w_up, w_down):
        g = _silu(x @ w_gate)
        u = x @ w_up
        return (g * u) @ w_down

    x = A_x
    g = _sigmoid((x * gate_w).sum(-1, keepdims=True))
    a = _A_ref(x, A_dft_seq_re, A_dft_seq_im, A_dft_hid_re, A_dft_hid_im)
    b = _B_ref(x, B_w_gate, B_w_up, B_w_down)
    return g * a + (1 - g) * b
```

```asm
; @launch kernel=k1_kernel grid=(256,1,1) block=(256,1,1) lds=163840
; @launch kernel=k2_kernel grid=(198,1,1) block=(384,1,1) lds=98304
.amdgcn_target "amdgcn-amd-amdhsa--gfx950"
.text
.globl k1_kernel
.p2align 8
.type k1_kernel,@function
k1_kernel:
  s_cmp_ge_u32 s2, 256
  s_cbranch_scc1 K1_end
  s_load_dwordx2 s[20:21], s[0:1], 0
  s_load_dwordx2 s[8:9], s[0:1], 48
  s_load_dwordx2 s[12:13], s[0:1], 56
  s_load_dwordx2 s[16:17], s[0:1], 64
  s_load_dwordx2 s[24:25], s[0:1], 96
  s_load_dwordx2 s[28:29], s[0:1], 88
  s_load_dwordx2 s[40:41], s[0:1], 72
  s_getpc_b64 s[32:33]
K1_pc:
  s_and_b32 s33, s33, 0xffff
  s_mov_b32 s34, K1_codeend-K1_pc
  s_mov_b32 s35, 0x20000
  s_lshr_b32 s84, s2, 3
  s_mul_i32 s84, s84, 20
  v_add_u32 v3, s84, v0
  v_lshlrev_b32 v3, 7, v3
  v_mov_b32 v4, 0x7ff00000
  v_cmp_gt_u32 vcc, 20, v0
  s_nop 1
  v_cndmask_b32 v3, v4, v3, vcc
  buffer_load_dword v95, v3, s[32:35], 0 offen
  v_lshrrev_b32 v2, 6, v0
  v_and_b32 v0, 63, v0
  v_readfirstlane_b32 s48, v2
  v_lshlrev_b32 v1, 4, v0
  s_and_b32 s84, s2, 1
  s_lshl_b32 s84, s84, 3
  s_lshr_b32 s85, s2, 3
  s_and_b32 s86, s85, 7
  s_add_u32 s49, s84, s86
  s_and_b32 s84, s2, 6
  s_lshl_b32 s84, s84, 1
  s_lshr_b32 s85, s85, 3
  s_add_u32 s50, s84, s85
  s_and_b32 s51, s50, 1
  v_lshrrev_b32 v21, 3, v0
  v_and_b32 v22, 7, v0
  s_lshl_b32 s84, s49, 5
  v_add_u32 v16, s84, v21
  s_cmp_eq_u32 s48, 0
  s_cselect_b32 s84, 0, 1024
  s_cmp_eq_u32 s48, 3
  s_cselect_b32 s84, 2048, s84
  s_and_b32 s85, s48, 1
  v_sub_u32 v17, s84, v16
  v_add_u32 v19, s84, v16
  s_cmp_eq_u32 s85, 1
  s_cselect_b64 vcc, -1, 0
  s_lshl_b32 s86, s48, 10
  s_sub_u32 s86, s86, 1536
  v_cndmask_b32 v19, v19, v17, vcc
  v_mov_b32 v17, s86
  s_cmp_ge_u32 s48, 2
  s_cselect_b32 s85, 0, -1
  v_cmp_eq_u32 vcc, s85, v16
  s_nop 1
  v_cndmask_b32 v19, v19, v17, vcc
  s_and_b32 s85, s48, 1
  s_cmp_eq_u32 s85, 1
  s_cselect_b32 s85, -1, 1
  s_mul_i32 s85, s85, 9216
  s_lshl_b32 s84, s49, 5
  v_add_u32 v16, s84, v21
  s_cmp_eq_u32 s48, 0
  s_cselect_b32 s84, 0, 1024
  s_cmp_eq_u32 s48, 3
  s_cselect_b32 s84, 2048, s84
  v_sub_u32 v17, s84, v16
  v_add_u32 v18, s84, v16
  s_cmp_lt_i32 s85, 0
  s_cselect_b64 vcc, -1, 0
  v_mul_u32_u24 v19, 1152, v19
  v_lshrrev_b32 v20, 1, v21
  v_cndmask_b32 v17, v18, v17, vcc
  v_mul_u32_u24 v17, 1152, v17
  v_xor_b32 v23, v20, v22
  v_lshl_add_u32 v96, v23, 4, v19
  v_xor_b32 v18, 4, v23
  v_add_u32 v17, s85, v17
  v_lshl_add_u32 v97, v18, 4, v17
  v_add_u32 v17, s85, v17
  v_lshl_add_u32 v98, v23, 4, v17
  v_add_u32 v17, s85, v17
  v_lshl_add_u32 v99, v18, 4, v17
  s_mul_i32 s84, s50, 288
  s_lshl_b32 s85, s51, 5
  s_add_u32 s84, s84, s85
  s_lshl_b32 s75, s84, 1
  s_mul_i32 s85, s48, 294912
  s_add_u32 s52, s85, s75
  s_mul_i32 s85, s48, 73728
  s_add_u32 s85, s85, 2359296
  s_add_u32 s53, s85, s75
  s_lshl_b32 s63, s48, 12
  s_lshl_b32 s64, s48, 10
  s_add_u32 s64, s64, 32768
  v_bfe_u32 v17, v0, 2, 1
  v_bfe_u32 v18, v0, 4, 1
  v_xor_b32 v17, v17, v18
  v_lshlrev_b32 v17, 6, v17
  v_and_b32 v18, 3, v0
  v_lshl_add_u32 v17, v18, 4, v17
  s_mov_b32 s84, 9216
  v_mul_lo_u32 v18, v21, s84
  v_add_u32 v240, v18, v17
  v_xor_b32 v17, 32, v17
  v_add_u32 v19, v18, v17
  s_and_b32 s84, s48, 1
  s_cmp_eq_u32 s84, 1
  s_cselect_b64 vcc, -1, 0
  v_add_u32 v241, 72704, v19
  v_add_u32 v242, 145408, v240
  v_add_u32 v243, 218112, v19
  v_cndmask_b32 v11, v240, v19, vcc
  s_mul_i32 s3, s48, 20480
  s_add_u32 s3, s3, 73728
  s_lshr_b32 s84, s2, 3
  s_and_b32 s84, s84, 7
  s_mul_i32 s84, s84, 36
  s_mul_i32 s85, s48, 9
  s_add_u32 s84, s84, s85
  v_add_u32 v16, s84, v0
  s_mov_b32 s84, 9216
  v_mul_lo_u32 v17, v16, s84
  v_mov_b32 v18, 0x7ff00000
  v_cmp_gt_u32 vcc, 9, v0
  s_nop 1
  v_cndmask_b32 v14, v18, v17, vcc
  s_waitcnt lgkmcnt(0)
  s_and_b32 s21, s21, 0xffff
  s_mov_b32 s22, 2359296
  s_mov_b32 s23, 0x20000
  s_and_b32 s9, s9, 0xffff
  s_mov_b32 s10, 5308416
  s_mov_b32 s11, 0x20000
  s_and_b32 s13, s13, 0xffff
  s_mov_b32 s14, 5308416
  s_mov_b32 s15, 0x20000
  s_lshr_b32 s85, s2, 6
  s_add_u32 s85, s85, 0
  s_cmp_ge_u32 s85, 5
  s_cselect_b32 s86, 5, 0
  s_sub_u32 s85, s85, s86
  s_lshl_b32 s84, s85, 7
  s_lshl_b32 s85, s85, 12
  s_add_u32 s85, s85, s3
  s_add_u32 m0, s85, 0
  s_nop 0
  buffer_load_dwordx4 v96, s[20:23], s84 offen lds
  s_add_u32 m0, s85, 1024
  s_nop 0
  buffer_load_dwordx4 v97, s[20:23], s84 offen lds
  s_add_u32 m0, s85, 2048
  s_nop 0
  buffer_load_dwordx4 v98, s[20:23], s84 offen lds
  s_add_u32 m0, s85, 3072
  s_nop 0
  buffer_load_dwordx4 v99, s[20:23], s84 offen lds
  s_lshr_b32 s85, s2, 6
  s_add_u32 s85, s85, 1
  s_cmp_ge_u32 s85, 5
  s_cselect_b32 s86, 5, 0
  s_sub_u32 s85, s85, s86
  s_lshl_b32 s84, s85, 7
  s_lshl_b32 s85, s85, 12
  s_add_u32 s85, s85, s3
  s_add_u32 m0, s85, 0
  s_nop 0
  buffer_load_dwordx4 v96, s[20:23], s84 offen lds
  s_add_u32 m0, s85, 1024
  s_nop 0
  buffer_load_dwordx4 v97, s[20:23], s84 offen lds
  s_add_u32 m0, s85, 2048
  s_nop 0
  buffer_load_dwordx4 v98, s[20:23], s84 offen lds
  s_add_u32 m0, s85, 3072
  s_nop 0
  buffer_load_dwordx4 v99, s[20:23], s84 offen lds
  s_lshr_b32 s85, s2, 6
  s_add_u32 s85, s85, 2
  s_cmp_ge_u32 s85, 5
  s_cselect_b32 s86, 5, 0
  s_sub_u32 s85, s85, s86
  s_lshl_b32 s84, s85, 7
  s_lshl_b32 s85, s85, 12
  s_add_u32 s85, s85, s3
  s_add_u32 m0, s85, 0
  s_nop 0
  buffer_load_dwordx4 v96, s[20:23], s84 offen lds
  s_add_u32 m0, s85, 1024
  s_nop 0
  buffer_load_dwordx4 v97, s[20:23], s84 offen lds
  s_add_u32 m0, s85, 2048
  s_nop 0
  buffer_load_dwordx4 v98, s[20:23], s84 offen lds
  s_add_u32 m0, s85, 3072
  s_nop 0
  buffer_load_dwordx4 v99, s[20:23], s84 offen lds
  s_lshr_b32 s85, s2, 6
  s_add_u32 s85, s85, 3
  s_cmp_ge_u32 s85, 5
  s_cselect_b32 s86, 5, 0
  s_sub_u32 s85, s85, s86
  s_lshl_b32 s84, s85, 7
  s_lshl_b32 s85, s85, 12
  s_add_u32 s85, s85, s3
  s_add_u32 m0, s85, 0
  s_nop 0
  buffer_load_dwordx4 v96, s[20:23], s84 offen lds
  s_add_u32 m0, s85, 1024
  s_nop 0
  buffer_load_dwordx4 v97, s[20:23], s84 offen lds
  s_add_u32 m0, s85, 2048
  s_nop 0
  buffer_load_dwordx4 v98, s[20:23], s84 offen lds
  s_add_u32 m0, s85, 3072
  s_nop 0
  buffer_load_dwordx4 v99, s[20:23], s84 offen lds
  s_lshr_b32 s85, s2, 6
  s_add_u32 s85, s85, 4
  s_cmp_ge_u32 s85, 5
  s_cselect_b32 s86, 5, 0
  s_sub_u32 s85, s85, s86
  s_lshl_b32 s84, s85, 7
  s_lshl_b32 s85, s85, 12
  s_add_u32 s85, s85, s3
  s_add_u32 m0, s85, 0
  s_nop 0
  buffer_load_dwordx4 v96, s[20:23], s84 offen lds
  s_add_u32 m0, s85, 1024
  s_nop 0
  buffer_load_dwordx4 v97, s[20:23], s84 offen lds
  s_add_u32 m0, s85, 2048
  s_nop 0
  buffer_load_dwordx4 v98, s[20:23], s84 offen lds
  s_add_u32 m0, s85, 3072
  s_nop 0
  buffer_load_dwordx4 v99, s[20:23], s84 offen lds
  s_add_u32 s65, s52, 0
  s_add_u32 m0, s63, 0
  s_nop 0
  buffer_load_dwordx4 v240, s[8:11], s65 offen lds
  buffer_load_dwordx4 v241, s[8:11], s65 offen offset:1024 lds
  buffer_load_dwordx4 v242, s[8:11], s65 offen offset:2048 lds
  buffer_load_dwordx4 v243, s[8:11], s65 offen offset:3072 lds
  s_add_u32 s66, s52, 1179648
  s_add_u32 m0, s63, 16384
  s_nop 0
  buffer_load_dwordx4 v240, s[8:11], s66 offen lds
  buffer_load_dwordx4 v241, s[8:11], s66 offen offset:1024 lds
  buffer_load_dwordx4 v242, s[8:11], s66 offen offset:2048 lds
  buffer_load_dwordx4 v243, s[8:11], s66 offen offset:3072 lds
  s_add_u32 s67, s53, 0
  s_add_u32 m0, s64, 0
  s_nop 0
  buffer_load_dwordx4 v11, s[8:11], s67 offen lds
  s_add_u32 s65, s52, 0
  s_add_u32 m0, s63, 36864
  s_nop 0
  buffer_load_dwordx4 v240, s[12:15], s65 offen lds
  buffer_load_dwordx4 v241, s[12:15], s65 offen offset:1024 lds
  buffer_load_dwordx4 v242, s[12:15], s65 offen offset:2048 lds
  buffer_load_dwordx4 v243, s[12:15], s65 offen offset:3072 lds
  s_add_u32 s66, s52, 1179648
  s_add_u32 m0, s63, 53248
  s_nop 0
  buffer_load_dwordx4 v240, s[12:15], s66 offen lds
  buffer_load_dwordx4 v241, s[12:15], s66 offen offset:1024 lds
  buffer_load_dwordx4 v242, s[12:15], s66 offen offset:2048 lds
  buffer_load_dwordx4 v243, s[12:15], s66 offen offset:3072 lds
  s_add_u32 s67, s53, 0
  s_add_u32 m0, s64, 36864
  s_nop 0
  buffer_load_dwordx4 v11, s[12:15], s67 offen lds
  v_lshrrev_b32 v16, 4, v0
  v_bfe_u32 v18, v0, 2, 2
  v_and_b32 v19, 3, v0
  v_lshl_add_u32 v20, v16, 3, v18
  v_lshlrev_b32 v20, 7, v20
  v_lshl_add_u32 v20, v19, 3, v20
  v_and_b32 v21, 1, v16
  v_lshl_add_u32 v20, v21, 5, v20
  v_lshrrev_b32 v21, 1, v18
  s_and_b32 s84, s48, 1
  v_xor_b32 v21, s84, v21
  v_lshl_add_u32 v6, v21, 6, v20
  v_and_b32 v17, 15, v0
  v_lshrrev_b32 v18, 3, v17
  v_lshlrev_b32 v18, 10, v18
  v_and_b32 v19, 7, v17
  v_lshl_add_u32 v18, v19, 7, v18
  v_bfe_u32 v19, v17, 1, 3
  v_xor_b32 v20, v16, v19
  v_lshl_add_u32 v21, v20, 4, v18
  v_xor_b32 v22, 64, v21
  s_xor_b32 s85, s48, 1
  s_mul_i32 s85, s85, 20480
  s_add_u32 s85, s85, 73728
  v_add_u32 v100, s3, v21
  v_add_u32 v101, s3, v22
  v_add_u32 v102, s85, v21
  v_add_u32 v103, s85, v22
  s_waitcnt vmcnt(18)
  s_barrier
  ds_read_b128 a[0:3], v100 offset:0
  ds_read_b128 a[144:147], v102 offset:0
  ds_read_b128 a[4:7], v100 offset:2048
  ds_read_b128 a[148:151], v102 offset:2048
  ds_read_b128 a[8:11], v101 offset:0
  ds_read_b128 a[152:155], v103 offset:0
  ds_read_b128 a[12:15], v101 offset:2048
  ds_read_b128 a[156:159], v103 offset:2048
  ds_read_b128 a[16:19], v100 offset:4096
  ds_read_b128 a[160:163], v102 offset:4096
  ds_read_b128 a[20:23], v100 offset:6144
  ds_read_b128 a[164:167], v102 offset:6144
  ds_read_b128 a[24:27], v101 offset:4096
  ds_read_b128 a[168:171], v103 offset:4096
  ds_read_b128 a[28:31], v101 offset:6144
  ds_read_b128 a[172:175], v103 offset:6144
  ds_read_b128 a[32:35], v100 offset:8192
  ds_read_b128 a[176:179], v102 offset:8192
  ds_read_b128 a[36:39], v100 offset:10240
  ds_read_b128 a[180:183], v102 offset:10240
  ds_read_b128 a[40:43], v101 offset:8192
  ds_read_b128 a[184:187], v103 offset:8192
  ds_read_b128 a[44:47], v101 offset:10240
  ds_read_b128 a[188:191], v103 offset:10240
  ds_read_b128 a[48:51], v100 offset:12288
  ds_read_b128 a[192:195], v102 offset:12288
  ds_read_b128 a[52:55], v100 offset:14336
  ds_read_b128 a[196:199], v102 offset:14336
  ds_read_b128 a[56:59], v101 offset:12288
  ds_read_b128 a[200:203], v103 offset:12288
  ds_read_b128 a[60:63], v101 offset:14336
  ds_read_b128 a[204:207], v103 offset:14336
  ds_read_b128 a[64:67], v100 offset:16384
  ds_read_b128 a[208:211], v102 offset:16384
  ds_read_b128 a[68:71], v100 offset:18432
  ds_read_b128 a[212:215], v102 offset:18432
  ds_read_b128 a[72:75], v101 offset:16384
  ds_read_b128 a[216:219], v103 offset:16384
  ds_read_b128 a[76:79], v101 offset:18432
  ds_read_b128 a[220:223], v103 offset:18432
  v_mov_b32 v16, v96
  v_mov_b32 v20, v100
  v_mov_b32 v17, v97
  v_mov_b32 v21, v101
  v_mov_b32 v18, v98
  v_mov_b32 v22, v102
  v_mov_b32 v19, v99
  v_mov_b32 v23, v103
  s_lshl_b32 s83, s48, 13
  s_add_u32 s83, s83, 110592
  s_lshl_b32 s95, s48, 12
  s_add_u32 s95, s95, 147456
  s_sub_u32 s84, s83, s3
  v_add_u32 v20, s84, v20
  v_add_u32 v21, s84, v21
  s_xor_b32 s85, s48, 1
  s_lshl_b32 s86, s85, 13
  s_add_u32 s86, s86, 36864
  s_mul_i32 s85, s85, 20480
  s_sub_u32 s86, s86, s85
  v_add_u32 v22, s86, v22
  v_add_u32 v23, s86, v23
  s_waitcnt lgkmcnt(0)
  s_waitcnt vmcnt(9)
  s_barrier
  v_mov_b32 v2, v6
  v_xor_b32 v3, 32, v2
  ds_read_b64_tr_b16 a[240:241], v2 offset:0
  ds_read_b64_tr_b16 a[242:243], v2 offset:512
  ds_read_b64_tr_b16 a[244:245], v3 offset:0
  ds_read_b64_tr_b16 a[246:247], v3 offset:512
  ds_read_b64_tr_b16 a[248:249], v2 offset:4096
  ds_read_b64_tr_b16 a[250:251], v2 offset:4608
  s_waitcnt lgkmcnt(2)
  v_mfma_f32_16x16x32_bf16 v[96:99], a[240:243], a[0:3], 0
  ds_read_b64_tr_b16 a[252:253], v3 offset:4096
  ds_read_b64_tr_b16 a[254:255], v3 offset:4608
  v_mfma_f32_16x16x32_bf16 v[100:103], a[240:243], a[4:7], 0
  s_movk_i32 s4, 640
  s_add_u32 m0, s83, 0
  v_mfma_f32_16x16x32_bf16 v[104:107], a[240:243], a[144:147], 0
  buffer_load_dwordx4 v16, s[20:23], s4 offen lds
  s_add_u32 m0, s83, 1024
  v_mfma_f32_16x16x32_bf16 v[108:111], a[240:243], a[148:151], 0
  s_and_b32 s17, s17, 0xffff
  s_mov_b32 s18, 5308416
  v_mfma_f32_16x16x32_bf16 v[112:115], a[244:247], a[0:3], 0
  ds_read_b64_tr_b16 a[240:241], v2 offset:8192
  ds_read_b64_tr_b16 a[242:243], v2 offset:8704
  v_mfma_f32_16x16x32_bf16 v[116:119], a[244:247], a[4:7], 0
  buffer_load_dwordx4 v17, s[20:23], s4 offen lds
  s_add_u32 m0, s83, 2048
  v_mfma_f32_16x16x32_bf16 v[120:123], a[244:247], a[144:147], 0
  buffer_load_dwordx4 v18, s[20:23], s4 offen lds
  s_add_u32 m0, s83, 3072
  v_mfma_f32_16x16x32_bf16 v[124:127], a[244:247], a[148:151], 0
  s_mov_b32 s19, 0x20000
  s_and_b32 s25, s25, 0xffff
  s_waitcnt lgkmcnt(2)
  v_mfma_f32_16x16x32_bf16 v[96:99], a[248:251], a[8:11], v[96:99]
  ds_read_b64_tr_b16 a[244:245], v3 offset:8192
  ds_read_b64_tr_b16 a[246:247], v3 offset:8704
  buffer_load_dwordx4 v19, s[20:23], s4 offen lds
  v_mfma_f32_16x16x32_bf16 v[100:103], a[248:251], a[12:15], v[100:103]
  s_movk_i32 s4, 768
  s_add_u32 m0, s83, 4096
  v_mfma_f32_16x16x32_bf16 v[104:107], a[248:251], a[152:155], v[104:107]
  buffer_load_dwordx4 v16, s[20:23], s4 offen lds
  s_add_u32 m0, s83, 5120
  v_mfma_f32_16x16x32_bf16 v[108:111], a[248:251], a[156:159], v[108:111]
  s_mov_b32 s26, 268435456
  s_mov_b32 s27, 0x20000
  v_mfma_f32_16x16x32_bf16 v[112:115], a[252:255], a[8:11], v[112:115]
  ds_read_b64_tr_b16 a[248:249], v2 offset:12288
  ds_read_b64_tr_b16 a[250:251], v2 offset:12800
  v_mfma_f32_16x16x32_bf16 v[116:119], a[252:255], a[12:15], v[116:119]
  buffer_load_dwordx4 v17, s[20:23], s4 offen lds
  s_add_u32 m0, s83, 6144
  v_mfma_f32_16x16x32_bf16 v[120:123], a[252:255], a[152:155], v[120:123]
  buffer_load_dwordx4 v18, s[20:23], s4 offen lds
  s_add_u32 m0, s83, 7168
  v_mfma_f32_16x16x32_bf16 v[124:127], a[252:255], a[156:159], v[124:127]
  s_and_b32 s29, s29, 0xffff
  s_mov_b32 s30, 256
  s_waitcnt lgkmcnt(2)
  v_mfma_f32_16x16x32_bf16 v[96:99], a[240:243], a[16:19], v[96:99]
  ds_read_b64_tr_b16 a[252:253], v3 offset:12288
  ds_read_b64_tr_b16 a[254:255], v3 offset:12800
  buffer_load_dwordx4 v19, s[20:23], s4 offen lds
  v_mfma_f32_16x16x32_bf16 v[100:103], a[240:243], a[20:23], v[100:103]
  s_movk_i32 s4, 896
  s_add_u32 m0, s95, 0
  v_mfma_f32_16x16x32_bf16 v[104:107], a[240:243], a[160:163], v[104:107]
  buffer_load_dwordx4 v16, s[20:23], s4 offen lds
  s_add_u32 m0, s95, 1024
  v_mfma_f32_16x16x32_bf16 v[108:111], a[240:243], a[164:167], v[108:111]
  s_mov_b32 s31, 0x20000
  s_and_b32 s41, s41, 0xffff
  v_mfma_f32_16x16x32_bf16 v[112:115], a[244:247], a[16:19], v[112:115]
  ds_read_b64_tr_b16 a[240:241], v2 offset:16384
  ds_read_b64_tr_b16 a[242:243], v2 offset:16896
  v_mfma_f32_16x16x32_bf16 v[116:119], a[244:247], a[20:23], v[116:119]
  buffer_load_dwordx4 v17, s[20:23], s4 offen lds
  s_add_u32 m0, s95, 2048
  v_mfma_f32_16x16x32_bf16 v[120:123], a[244:247], a[160:163], v[120:123]
  buffer_load_dwordx4 v18, s[20:23], s4 offen lds
  s_add_u32 m0, s95, 3072
  v_mfma_f32_16x16x32_bf16 v[124:127], a[244:247], a[164:167], v[124:127]
  s_mov_b32 s42, 1152
  s_mov_b32 s43, 0x20000
  s_waitcnt lgkmcnt(2)
  v_mfma_f32_16x16x32_bf16 v[96:99], a[248:251], a[24:27], v[96:99]
  ds_read_b64_tr_b16 a[244:245], v3 offset:16384
  ds_read_b64_tr_b16 a[246:247], v3 offset:16896
  v_mfma_f32_16x16x32_bf16 v[100:103], a[248:251], a[28:31], v[100:103]
  buffer_load_dwordx4 v19, s[20:23], s4 offen lds
  s_lshr_b32 s84, s2, 3
  v_mfma_f32_16x16x32_bf16 v[104:107], a[248:251], a[168:171], v[104:107]
  s_add_u32 s65, s52, 2654208
  s_add_u32 m0, s63, 73728
  v_mfma_f32_16x16x32_bf16 v[108:111], a[248:251], a[172:175], v[108:111]
  s_and_b32 s84, s84, 7
  s_mul_i32 s84, s84, 36
  v_mfma_f32_16x16x32_bf16 v[112:115], a[252:255], a[24:27], v[112:115]
  ds_read_b64_tr_b16 a[248:249], v2 offset:20480
  ds_read_b64_tr_b16 a[250:251], v2 offset:20992
  v_mfma_f32_16x16x32_bf16 v[116:119], a[252:255], a[28:31], v[116:119]
  buffer_load_dwordx4 v240, s[8:11], s65 offen lds
  s_mul_i32 s85, s48, 9
  v_mfma_f32_16x16x32_bf16 v[120:123], a[252:255], a[168:171], v[120:123]
  buffer_load_dwordx4 v241, s[8:11], s65 offen offset:1024 lds
  s_add_u32 s84, s84, s85
  v_mfma_f32_16x16x32_bf16 v[124:127], a[252:255], a[172:175], v[124:127]
  v_add_u32 v24, s84, v0
  s_mov_b32 s84, 9216
  s_waitcnt lgkmcnt(2)
  v_mfma_f32_16x16x32_bf16 v[96:99], a[240:243], a[32:35], v[96:99]
  ds_read_b64_tr_b16 a[252:253], v3 offset:20480
  ds_read_b64_tr_b16 a[254:255], v3 offset:20992
  v_mfma_f32_16x16x32_bf16 v[100:103], a[240:243], a[36:39], v[100:103]
  buffer_load_dwordx4 v242, s[8:11], s65 offen offset:2048 lds
  v_mul_lo_u32 v25, v24, s84
  v_mfma_f32_16x16x32_bf16 v[104:107], a[240:243], a[176:179], v[104:107]
  buffer_load_dwordx4 v243, s[8:11], s65 offen offset:3072 lds
  v_mul_u32_u24 v26, 1152, v24
  v_mfma_f32_16x16x32_bf16 v[108:111], a[240:243], a[180:183], v[108:111]
  v_mov_b32 v27, 0x7ff00000
  v_cmp_gt_u32 vcc, 9, v0
  v_mfma_f32_16x16x32_bf16 v[112:115], a[244:247], a[32:35], v[112:115]
  ds_read_b64_tr_b16 a[240:241], v2 offset:24576
  ds_read_b64_tr_b16 a[242:243], v2 offset:25088
  v_mfma_f32_16x16x32_bf16 v[116:119], a[244:247], a[36:39], v[116:119]
  s_nop 1
  v_cndmask_b32 v14, v27, v25, vcc
  v_mfma_f32_16x16x32_bf16 v[120:123], a[244:247], a[176:179], v[120:123]
  s_add_u32 s66, s52, 3833856
  s_add_u32 m0, s63, 90112
  v_mfma_f32_16x16x32_bf16 v[124:127], a[244:247], a[180:183], v[124:127]
  v_cndmask_b32 v38, v27, v26, vcc
  s_nop 0
  s_waitcnt lgkmcnt(2)
  v_mfma_f32_16x16x32_bf16 v[96:99], a[248:251], a[40:43], v[96:99]
  ds_read_b64_tr_b16 a[244:245], v3 offset:24576
  ds_read_b64_tr_b16 a[246:247], v3 offset:25088
  v_mfma_f32_16x16x32_bf16 v[100:103], a[248:251], a[44:47], v[100:103]
  buffer_load_dwordx4 v240, s[8:11], s66 offen lds
  s_lshl_b32 s84, s49, 4
  v_mfma_f32_16x16x32_bf16 v[104:107], a[248:251], a[184:187], v[104:107]
  buffer_load_dwordx4 v241, s[8:11], s66 offen offset:1024 lds
  s_add_u32 s84, s84, s50
  v_mfma_f32_16x16x32_bf16 v[108:111], a[248:251], a[188:191], v[108:111]
  s_xor_b32 s87, s84, 1
  s_and_b32 s72, s87, 63
  v_mfma_f32_16x16x32_bf16 v[112:115], a[252:255], a[40:43], v[112:115]
  ds_read_b64_tr_b16 a[248:249], v2 offset:28672
  ds_read_b64_tr_b16 a[250:251], v2 offset:29184
  v_mfma_f32_16x16x32_bf16 v[116:119], a[252:255], a[44:47], v[116:119]
  buffer_load_dwordx4 v242, s[8:11], s66 offen offset:2048 lds
  s_lshl_b32 s72, s72, 2
  v_mfma_f32_16x16x32_bf16 v[120:123], a[252:255], a[184:187], v[120:123]
  buffer_load_dwordx4 v243, s[8:11], s66 offen offset:3072 lds
  s_lshr_b32 s73, s87, 6
  v_mfma_f32_16x16x32_bf16 v[124:127], a[252:255], a[188:191], v[124:127]
  s_lshl_b32 s85, s87, 7
  s_lshl_b32 s86, s48, 2
  s_waitcnt lgkmcnt(2)
  v_mfma_f32_16x16x32_bf16 v[96:99], a[240:243], a[48:51], v[96:99]
  ds_read_b64_tr_b16 a[252:253], v3 offset:28672
  ds_read_b64_tr_b16 a[254:255], v3 offset:29184
  v_mfma_f32_16x16x32_bf16 v[100:103], a[240:243], a[52:55], v[100:103]
  s_add_u32 s85, s85, s86
  s_add_u32 s74, s85, 79691776
  v_mfma_f32_16x16x32_bf16 v[104:107], a[240:243], a[192:195], v[104:107]
  s_add_u32 s67, s53, 2654208
  s_add_u32 m0, s64, 73728
  v_mfma_f32_16x16x32_bf16 v[108:111], a[240:243], a[196:199], v[108:111]
  s_and_b32 s85, s84, 63
  s_lshl_b32 s85, s85, 2
  v_mfma_f32_16x16x32_bf16 v[112:115], a[244:247], a[48:51], v[112:115]
  ds_read_b64_tr_b16 a[240:241], v2 offset:32768
  ds_read_b64_tr_b16 a[242:243], v2 offset:33280
  v_mfma_f32_16x16x32_bf16 v[116:119], a[244:247], a[52:55], v[116:119]
  buffer_load_dwordx4 v11, s[8:11], s67 offen lds
  s_lshr_b32 s86, s84, 6
  v_mfma_f32_16x16x32_bf16 v[120:123], a[244:247], a[192:195], v[120:123]
  s_lshl_b32 s86, 1, s86
  v_mov_b32 v13, s86
  v_mfma_f32_16x16x32_bf16 v[124:127], a[244:247], a[196:199], v[124:127]
  v_mov_b32 v10, s85
  v_mov_b32 v24, 0x7ffffff0
  s_waitcnt lgkmcnt(2)
  v_mfma_f32_16x16x32_bf16 v[96:99], a[248:251], a[56:59], v[96:99]
  ds_read_b64_tr_b16 a[244:245], v3 offset:32768
  ds_read_b64_tr_b16 a[246:247], v3 offset:33280
  v_mfma_f32_16x16x32_bf16 v[100:103], a[248:251], a[60:63], v[100:103]
  s_lshl_b32 s85, s84, 7
  s_add_u32 s85, s85, 79691776
  v_mfma_f32_16x16x32_bf16 v[104:107], a[248:251], a[200:203], v[104:107]
  s_lshl_b32 s86, s48, 2
  s_add_u32 s86, s86, s85
  v_mfma_f32_16x16x32_bf16 v[108:111], a[248:251], a[204:207], v[108:111]
  v_mov_b32 v12, s86
  v_mov_b32 v25, s85
  v_mfma_f32_16x16x32_bf16 v[112:115], a[252:255], a[56:59], v[112:115]
  v_cmp_eq_u32 vcc, 0, v0
  s_lshl_b32 s86, s48, 6
  v_mfma_f32_16x16x32_bf16 v[116:119], a[252:255], a[60:63], v[116:119]
  v_add_u32 v26, s86, v0
  v_cndmask_b32 v12, v24, v12, vcc
  v_mfma_f32_16x16x32_bf16 v[120:123], a[252:255], a[200:203], v[120:123]
  v_mfma_f32_16x16x32_bf16 v[124:127], a[252:255], a[204:207], v[124:127]
  s_waitcnt vmcnt(9) lgkmcnt(0)
  s_barrier
  v_add_u32 v2, 36864, v6
  v_xor_b32 v3, 32, v2
  v_mfma_f32_16x16x32_bf16 v[96:99], a[240:243], a[64:67], v[96:99]
  ds_read_b64_tr_b16 a[248:249], v2 offset:0
  ds_read_b64_tr_b16 a[250:251], v2 offset:512
  v_mfma_f32_16x16x32_bf16 v[100:103], a[240:243], a[68:71], v[100:103]
  ds_read_b64_tr_b16 a[252:253], v3 offset:0
  ds_read_b64_tr_b16 a[254:255], v3 offset:512
  v_mfma_f32_16x16x32_bf16 v[104:107], a[240:243], a[208:211], v[104:107]
  v_cmp_eq_u32 vcc, 0, v26
  v_mov_b32 v32, 0
  v_mfma_f32_16x16x32_bf16 v[108:111], a[240:243], a[212:215], v[108:111]
  v_mov_b32 v33, 0
  v_cndmask_b32 v10, v24, v10, vcc
  v_mfma_f32_16x16x32_bf16 v[112:115], a[244:247], a[64:67], v[112:115]
  ds_read_b64_tr_b16 a[240:241], v2 offset:4096
  ds_read_b64_tr_b16 a[242:243], v2 offset:4608
  s_add_u32 s5, s75, 2654208
  v_mfma_f32_16x16x32_bf16 v[116:119], a[244:247], a[68:71], v[116:119]
  buffer_load_dword v95, v14, s[8:11], s5 offen
  s_add_u32 s5, s75, 2654208
  buffer_load_dword v95, v14, s[12:15], s5 offen
  v_mfma_f32_16x16x32_bf16 v[120:123], a[244:247], a[208:211], v[120:123]
  s_add_u32 s5, s75, 128
  buffer_load_dword v95, v14, s[8:11], s5 offen
  v_mfma_f32_16x16x32_bf16 v[124:127], a[244:247], a[212:215], v[124:127]
  s_add_u32 s5, s75, 2654336
  buffer_load_dword v95, v14, s[8:11], s5 offen
  s_waitcnt lgkmcnt(2)
  v_mfma_f32_16x16x32_bf16 v[160:163], a[248:251], a[0:3], 0
  ds_read_b64_tr_b16 a[244:245], v3 offset:4096
  ds_read_b64_tr_b16 a[246:247], v3 offset:4608
  ds_read_b128 a[80:83], v20 offset:0
  v_mfma_f32_16x16x32_bf16 v[164:167], a[248:251], a[4:7], 0
  ds_read_b128 a[224:227], v22 offset:0
  ds_read_b128 a[84:87], v20 offset:2048
  ds_read_b128 a[228:231], v22 offset:2048
  v_mfma_f32_16x16x32_bf16 v[168:171], a[248:251], a[144:147], 0
  ds_read_b128 a[88:91], v21 offset:0
  ds_read_b128 a[232:235], v23 offset:0
  v_mfma_f32_16x16x32_bf16 v[172:175], a[248:251], a[148:151], 0
  ds_read_b128 a[92:95], v21 offset:2048
  ds_read_b128 a[236:239], v23 offset:2048
  v_mfma_f32_16x16x32_bf16 v[176:179], a[252:255], a[0:3], 0
  ds_read_b64_tr_b16 a[248:249], v2 offset:8192
  ds_read_b64_tr_b16 a[250:251], v2 offset:8704
  ds_read_b128 a[96:99], v20 offset:4096
  v_mfma_f32_16x16x32_bf16 v[180:183], a[252:255], a[4:7], 0
  ds_read_b128 v[192:195], v22 offset:4096
  ds_read_b128 a[100:103], v20 offset:6144
  ds_read_b128 v[196:199], v22 offset:6144
  v_mfma_f32_16x16x32_bf16 v[184:187], a[252:255], a[144:147], 0
  ds_read_b128 a[104:107], v21 offset:4096
  ds_read_b128 v[200:203], v23 offset:4096
  v_mfma_f32_16x16x32_bf16 v[188:191], a[252:255], a[148:151], 0
  ds_read_b128 a[108:111], v21 offset:6144
  ds_read_b128 v[204:207], v23 offset:6144
  s_waitcnt lgkmcnt(15)
  v_mfma_f32_16x16x32_bf16 v[160:163], a[240:243], a[8:11], v[160:163]
  ds_read_b64_tr_b16 a[252:253], v3 offset:8192
  ds_read_b64_tr_b16 a[254:255], v3 offset:8704
  s_sub_u32 s4, s95, s83
  v_add_u32 v20, s4, v20
  v_mfma_f32_16x16x32_bf16 v[164:167], a[240:243], a[12:15], v[164:167]
  v_add_u32 v21, s4, v21
  s_xor_b32 s5, s48, 1
  s_lshl_b32 s4, s5, 12
  s_lshl_b32 s5, s5, 13
  s_sub_u32 s4, s4, s5
  s_add_u32 s4, s4, 36864
  v_add_u32 v22, s4, v22
  v_add_u32 v23, s4, v23
  v_mfma_f32_16x16x32_bf16 v[168:171], a[240:243], a[152:155], v[168:171]
  ds_read_b128 a[112:115], v20 offset:0
  ds_read_b128 v[208:211], v22 offset:0
  v_mfma_f32_16x16x32_bf16 v[172:175], a[240:243], a[156:159], v[172:175]
  ds_read_b128 a[116:119], v20 offset:2048
  ds_read_b128 v[212:215], v22 offset:2048
  v_cndmask_b32 v36, v24, v25, vcc
  v_mov_b32 v34, 0
  v_mov_b32 v35, 0
  s_nop 0
  v_mfma_f32_16x16x32_bf16 v[176:179], a[244:247], a[8:11], v[176:179]
  ds_read_b64_tr_b16 a[240:241], v2 offset:12288
  ds_read_b64_tr_b16 a[242:243], v2 offset:12800
  ds_read_b128 a[120:123], v21 offset:0
  v_mfma_f32_16x16x32_bf16 v[180:183], a[244:247], a[12:15], v[180:183]
  ds_read_b128 v[216:219], v23 offset:0
  ds_read_b128 a[124:127], v21 offset:2048
  ds_read_b128 v[220:223], v23 offset:2048
  v_mfma_f32_16x16x32_bf16 v[184:187], a[244:247], a[152:155], v[184:187]
  s_mul_i32 s85, s48, 18432
  s_mul_i32 s86, s84, 73728
  v_mfma_f32_16x16x32_bf16 v[188:191], a[244:247], a[156:159], v[188:191]
  s_add_u32 s86, s86, s85
  s_add_u32 s68, s86, 0
  s_waitcnt lgkmcnt(10)
  v_mfma_f32_16x16x32_bf16 v[160:163], a[248:251], a[16:19], v[160:163]
  ds_read_b64_tr_b16 a[244:245], v3 offset:12288
  ds_read_b64_tr_b16 a[246:247], v3 offset:12800
  v_mfma_f32_16x16x32_bf16 v[164:167], a[248:251], a[20:23], v[164:167]
  s_mul_i32 s86, s87, 73728
  s_add_u32 s86, s86, s85
  s_waitcnt lgkmcnt(2)
  s_barrier
  v_mfma_f32_16x16x32_bf16 v[168:171], a[248:251], a[160:163], v[168:171]
  s_movk_i32 s4, 1024
  s_add_u32 m0, s95, 0
  v_mfma_f32_16x16x32_bf16 v[172:175], a[248:251], a[164:167], v[172:175]
  s_add_u32 s69, s86, 0
  s_lshr_b32 s85, s49, 1
  v_mfma_f32_16x16x32_bf16 v[176:179], a[252:255], a[16:19], v[176:179]
  ds_read_b64_tr_b16 a[248:249], v2 offset:16384
  ds_read_b64_tr_b16 a[250:251], v2 offset:16896
  v_mfma_f32_16x16x32_bf16 v[180:183], a[252:255], a[20:23], v[180:183]
  buffer_load_dwordx4 v16, s[20:23], s4 offen lds
  s_add_u32 m0, s95, 1024
  v_mfma_f32_16x16x32_bf16 v[184:187], a[252:255], a[160:163], v[184:187]
  buffer_load_dwordx4 v17, s[20:23], s4 offen lds
  s_add_u32 m0, s95, 2048
  v_mfma_f32_16x16x32_bf16 v[188:191], a[252:255], a[164:167], v[188:191]
  s_mul_i32 s85, s85, 2359296
  s_mul_i32 s86, s48, 589824
  s_waitcnt lgkmcnt(2)
  v_mfma_f32_16x16x32_bf16 v[160:163], a[240:243], a[24:27], v[160:163]
  ds_read_b64_tr_b16 a[252:253], v3 offset:16384
  ds_read_b64_tr_b16 a[254:255], v3 offset:16896
  v_mfma_f32_16x16x32_bf16 v[164:167], a[240:243], a[28:31], v[164:167]
  buffer_load_dwordx4 v18, s[20:23], s4 offen lds
  s_add_u32 m0, s95, 3072
  v_mfma_f32_16x16x32_bf16 v[168:171], a[240:243], a[168:171], v[168:171]
  buffer_load_dwordx4 v19, s[20:23], s4 offen lds
  s_add_u32 s85, s85, s86
  v_mfma_f32_16x16x32_bf16 v[172:175], a[240:243], a[172:175], v[172:175]
  s_lshr_b32 s86, s50, 1
  s_mul_i32 s86, s86, 36864
  v_mfma_f32_16x16x32_bf16 v[176:179], a[244:247], a[24:27], v[176:179]
  ds_read_b64_tr_b16 a[240:241], v2 offset:20480
  ds_read_b64_tr_b16 a[242:243], v2 offset:20992
  v_mfma_f32_16x16x32_bf16 v[180:183], a[244:247], a[28:31], v[180:183]
  s_add_u32 s85, s85, s86
  s_add_u32 s85, s85, 33554432
  v_mfma_f32_16x16x32_bf16 v[184:187], a[244:247], a[168:171], v[184:187]
  s_mul_i32 s86, s51, 20480
  s_add_u32 s70, s85, s86
  v_mfma_f32_16x16x32_bf16 v[188:191], a[244:247], a[172:175], v[188:191]
  s_add_u32 s86, s51, 8
  s_lshl_b32 s86, s86, 11
  s_waitcnt lgkmcnt(2)
  v_mfma_f32_16x16x32_bf16 v[160:163], a[248:251], a[32:35], v[160:163]
  ds_read_b64_tr_b16 a[244:245], v3 offset:20480
  ds_read_b64_tr_b16 a[246:247], v3 offset:20992
  v_mfma_f32_16x16x32_bf16 v[164:167], a[248:251], a[36:39], v[164:167]
  s_add_u32 s71, s85, s86
  s_mul_i32 s84, s50, 288
  v_mfma_f32_16x16x32_bf16 v[168:171], a[248:251], a[176:179], v[168:171]
  s_lshl_b32 s85, s51, 5
  s_add_u32 s85, s84, s85
  v_mfma_f32_16x16x32_bf16 v[172:175], a[248:251], a[180:183], v[172:175]
  s_xor_b32 s86, s51, 1
  s_lshl_b32 s86, s86, 8
  v_mfma_f32_16x16x32_bf16 v[176:179], a[252:255], a[32:35], v[176:179]
  ds_read_b64_tr_b16 a[248:249], v2 offset:24576
  ds_read_b64_tr_b16 a[250:251], v2 offset:25088
  v_mfma_f32_16x16x32_bf16 v[180:183], a[252:255], a[36:39], v[180:183]
  s_add_u32 s86, s84, s86
  s_xor_b32 s87, s50, 1
  v_mfma_f32_16x16x32_bf16 v[184:187], a[252:255], a[176:179], v[184:187]
  s_mul_i32 s87, s87, 288
  s_lshl_b32 s76, s86, 1
  v_mfma_f32_16x16x32_bf16 v[188:191], a[252:255], a[180:183], v[188:191]
  s_mul_i32 s88, s48, 589824
  s_add_u32 s54, s88, s76
  s_waitcnt lgkmcnt(2)
  v_mfma_f32_16x16x32_bf16 v[160:163], a[240:243], a[40:43], v[160:163]
  ds_read_b64_tr_b16 a[252:253], v3 offset:24576
  ds_read_b64_tr_b16 a[254:255], v3 offset:25088
  v_mfma_f32_16x16x32_bf16 v[164:167], a[240:243], a[44:47], v[164:167]
  s_mul_i32 s88, s48, 147456
  s_add_u32 s88, s88, 4718592
  v_mfma_f32_16x16x32_bf16 v[168:171], a[240:243], a[184:187], v[168:171]
  s_add_u32 s55, s88, s76
  s_mul_i32 s90, s51, 640
  v_mfma_f32_16x16x32_bf16 v[172:175], a[240:243], a[188:191], v[172:175]
  s_mul_i32 s91, s51, 576
  s_xor_b32 s92, s51, 1
  v_mfma_f32_16x16x32_bf16 v[176:179], a[244:247], a[40:43], v[176:179]
  ds_read_b64_tr_b16 a[240:241], v2 offset:28672
  ds_read_b64_tr_b16 a[242:243], v2 offset:29184
  v_mfma_f32_16x16x32_bf16 v[180:183], a[244:247], a[44:47], v[180:183]
  s_lshl_b32 s93, s92, 9
  s_add_u32 s91, s91, s93
  v_mfma_f32_16x16x32_bf16 v[184:187], a[244:247], a[184:187], v[184:187]
  s_mul_i32 s88, s84, 1152
  s_add_u32 s77, s88, s90
  v_mfma_f32_16x16x32_bf16 v[188:191], a[244:247], a[188:191], v[188:191]
  s_mul_i32 s88, s87, 1152
  s_add_u32 s78, s88, s90
  s_waitcnt lgkmcnt(2)
  v_mfma_f32_16x16x32_bf16 v[160:163], a[248:251], a[48:51], v[160:163]
  ds_read_b64_tr_b16 a[244:245], v3 offset:28672
  ds_read_b64_tr_b16 a[246:247], v3 offset:29184
  v_mfma_f32_16x16x32_bf16 v[164:167], a[248:251], a[52:55], v[164:167]
  s_and_b32 s88, s50, 14
  s_mul_i32 s88, s88, 331776
  v_mfma_f32_16x16x32_bf16 v[168:171], a[248:251], a[192:195], v[168:171]
  s_add_u32 s79, s88, s91
  s_lshl_b32 s93, s92, 5
  v_mfma_f32_16x16x32_bf16 v[172:175], a[248:251], a[196:199], v[172:175]
  s_add_u32 s93, s87, s93
  s_lshl_b32 s94, s51, 8
  v_mfma_f32_16x16x32_bf16 v[176:179], a[252:255], a[48:51], v[176:179]
  ds_read_b64_tr_b16 a[248:249], v2 offset:32768
  ds_read_b64_tr_b16 a[250:251], v2 offset:33280
  v_mfma_f32_16x16x32_bf16 v[180:183], a[252:255], a[52:55], v[180:183]
  s_add_u32 s94, s87, s94
  s_lshl_b32 s88, s48, 5
  v_mfma_f32_16x16x32_bf16 v[184:187], a[252:255], a[192:195], v[184:187]
  s_add_u32 s89, s85, s88
  s_mul_i32 s89, s89, 1152
  v_mfma_f32_16x16x32_bf16 v[188:191], a[252:255], a[196:199], v[188:191]
  s_add_u32 s56, s89, s90
  s_add_u32 s89, s93, s88
  s_waitcnt lgkmcnt(2)
  v_mfma_f32_16x16x32_bf16 v[160:163], a[240:243], a[56:59], v[160:163]
  ds_read_b64_tr_b16 a[252:253], v3 offset:32768
  ds_read_b64_tr_b16 a[254:255], v3 offset:33280
  v_mfma_f32_16x16x32_bf16 v[164:167], a[240:243], a[60:63], v[164:167]
  s_mul_i32 s89, s89, 1152
  s_add_u32 s58, s89, s90
  v_mfma_f32_16x16x32_bf16 v[168:171], a[240:243], a[200:203], v[168:171]
  s_lshl_b32 s88, s48, 3
  s_add_u32 s89, s86, s88
  v_mfma_f32_16x16x32_bf16 v[172:175], a[240:243], a[204:207], v[172:175]
  s_mul_i32 s89, s89, 1152
  s_add_u32 s57, s89, s90
  v_mfma_f32_16x16x32_bf16 v[176:179], a[244:247], a[56:59], v[176:179]
  buffer_store_dwordx4 v[32:35], v36, s[24:27], 0 offen sc1
  s_add_u32 s89, s94, s88
  v_mfma_f32_16x16x32_bf16 v[180:183], a[244:247], a[60:63], v[180:183]
  s_mul_i32 s89, s89, 1152
  s_add_u32 s59, s89, s90
  v_mfma_f32_16x16x32_bf16 v[184:187], a[244:247], a[200:203], v[184:187]
  s_add_u32 s5, s75, 128
  buffer_load_dword v95, v14, s[12:15], s5 offen
  v_mfma_f32_16x16x32_bf16 v[188:191], a[244:247], a[204:207], v[188:191]
  s_waitcnt vmcnt(10) lgkmcnt(0)
  s_barrier
  v_add_u32 v2, 73728, v6
  v_xor_b32 v3, 32, v2
  v_mfma_f32_16x16x32_bf16 v[160:163], a[248:251], a[64:67], v[160:163]
  ds_read_b64_tr_b16 a[240:241], v2 offset:0
  ds_read_b64_tr_b16 a[242:243], v2 offset:512
  ds_read_b64_tr_b16 a[244:245], v3 offset:0
  v_mfma_f32_16x16x32_bf16 v[164:167], a[248:251], a[68:71], v[164:167]
  ds_read_b64_tr_b16 a[246:247], v3 offset:512
  s_add_u32 s5, s75, 2654336
  buffer_load_dword v95, v14, s[12:15], s5 offen
  v_mfma_f32_16x16x32_bf16 v[168:171], a[248:251], a[208:211], v[168:171]
  s_lshl_b32 s88, s48, 6
  s_add_u32 s89, s85, s88
  v_mfma_f32_16x16x32_bf16 v[172:175], a[248:251], a[212:215], v[172:175]
  s_mul_i32 s89, s89, 1152
  s_add_u32 s60, s89, s91
  v_mfma_f32_16x16x32_bf16 v[176:179], a[252:255], a[64:67], v[176:179]
  ds_read_b64_tr_b16 a[248:249], v2 offset:4096
  ds_read_b64_tr_b16 a[250:251], v2 offset:4608
  v_mfma_f32_16x16x32_bf16 v[180:183], a[252:255], a[68:71], v[180:183]
  s_add_u32 s89, s93, s88
  s_mul_i32 s89, s89, 1152
  v_mfma_f32_16x16x32_bf16 v[184:187], a[252:255], a[208:211], v[184:187]
  s_add_u32 s61, s89, s91
  v_mfma_f32_16x16x32_bf16 v[188:191], a[252:255], a[212:215], v[188:191]
  s_cmp_lt_u32 s48, 2
  s_cselect_b32 s89, s86, s94
  s_waitcnt lgkmcnt(2)
  v_mfma_f32_16x16x32_bf16 v[96:99], a[240:243], a[72:75], v[96:99]
  ds_read_b64_tr_b16 a[252:253], v3 offset:4096
  ds_read_b64_tr_b16 a[254:255], v3 offset:4608
  v_mfma_f32_16x16x32_bf16 v[100:103], a[240:243], a[76:79], v[100:103]
  s_add_u32 s65, s52, 2654208
  s_add_u32 m0, s63, 110592
  v_mfma_f32_16x16x32_bf16 v[104:107], a[240:243], a[216:219], v[104:107]
  buffer_load_dwordx4 v240, s[12:15], s65 offen lds
  s_and_b32 s88, s48, 1
  v_mfma_f32_16x16x32_bf16 v[108:111], a[240:243], a[220:223], v[108:111]
  s_lshl_b32 s88, s88, 4
  s_add_u32 s89, s89, s88
  v_mfma_f32_16x16x32_bf16 v[112:115], a[244:247], a[72:75], v[112:115]
  ds_read_b64_tr_b16 a[240:241], v2 offset:8192
  ds_read_b64_tr_b16 a[242:243], v2 offset:8704
  v_mfma_f32_16x16x32_bf16 v[116:119], a[244:247], a[76:79], v[116:119]
  buffer_load_dwordx4 v241, s[12:15], s65 offen offset:1024 lds
  s_mul_i32 s89, s89, 1152
  v_mfma_f32_16x16x32_bf16 v[120:123], a[244:247], a[216:219], v[120:123]
  buffer_load_dwordx4 v242, s[12:15], s65 offen offset:2048 lds
  s_add_u32 s62, s89, s91
  v_mfma_f32_16x16x32_bf16 v[124:127], a[244:247], a[220:223], v[124:127]
  s_cmp_ge_u32 s50, 9
  s_cselect_b32 s81, 1, 0
  s_waitcnt lgkmcnt(2)
  v_mfma_f32_16x16x32_bf16 v[96:99], a[248:251], a[80:83], v[96:99]
  ds_read_b64_tr_b16 a[244:245], v3 offset:8192
  ds_read_b64_tr_b16 a[246:247], v3 offset:8704
  v_mfma_f32_16x16x32_bf16 v[100:103], a[248:251], a[84:87], v[100:103]
  buffer_load_dwordx4 v243, s[12:15], s65 offen offset:3072 lds
  s_lshl_b32 s85, s81, 3
  v_mfma_f32_16x16x32_bf16 v[104:107], a[248:251], a[224:227], v[104:107]
  s_add_u32 s66, s52, 3833856
  s_add_u32 m0, s63, 126976
  v_mfma_f32_16x16x32_bf16 v[108:111], a[248:251], a[228:231], v[108:111]
  s_sub_u32 s82, s50, s85
  v_lshrrev_b32 v24, 4, v0
  v_mfma_f32_16x16x32_bf16 v[112:115], a[252:255], a[80:83], v[112:115]
  ds_read_b64_tr_b16 a[248:249], v2 offset:12288
  ds_read_b64_tr_b16 a[250:251], v2 offset:12800
  v_mfma_f32_16x16x32_bf16 v[116:119], a[252:255], a[84:87], v[116:119]
  buffer_load_dwordx4 v240, s[12:15], s66 offen lds
  v_bfe_u32 v26, v0, 2, 2
  v_mfma_f32_16x16x32_bf16 v[120:123], a[252:255], a[224:227], v[120:123]
  buffer_load_dwordx4 v241, s[12:15], s66 offen offset:1024 lds
  v_and_b32 v27, 3, v0
  v_mfma_f32_16x16x32_bf16 v[124:127], a[252:255], a[228:231], v[124:127]
  v_and_b32 v28, 1, v24
  v_lshlrev_b32 v28, 5, v28
  s_waitcnt lgkmcnt(2)
  v_mfma_f32_16x16x32_bf16 v[96:99], a[240:243], a[88:91], v[96:99]
  ds_read_b64_tr_b16 a[252:253], v3 offset:12288
  ds_read_b64_tr_b16 a[254:255], v3 offset:12800
  v_mfma_f32_16x16x32_bf16 v[100:103], a[240:243], a[92:95], v[100:103]
  v_lshl_add_u32 v28, v27, 3, v28
  v_lshl_add_u32 v31, v24, 3, v26
  v_mfma_f32_16x16x32_bf16 v[104:107], a[240:243], a[232:235], v[104:107]
  buffer_load_dwordx4 v242, s[12:15], s66 offen offset:2048 lds
  v_lshl_add_u32 v7, v31, 6, v28
  v_mfma_f32_16x16x32_bf16 v[108:111], a[240:243], a[236:239], v[108:111]
  v_lshl_add_u32 v31, v24, 2, v26
  v_lshl_add_u32 v9, v31, 6, v28
  v_mfma_f32_16x16x32_bf16 v[112:115], a[244:247], a[88:91], v[112:115]
  ds_read_b64_tr_b16 a[240:241], v2 offset:16384
  ds_read_b64_tr_b16 a[242:243], v2 offset:16896
  v_mfma_f32_16x16x32_bf16 v[116:119], a[244:247], a[92:95], v[116:119]
  buffer_load_dwordx4 v243, s[12:15], s66 offen offset:3072 lds
  v_lshrrev_b32 v29, 1, v26
  v_mfma_f32_16x16x32_bf16 v[120:123], a[244:247], a[232:235], v[120:123]
  s_add_u32 s67, s53, 2654208
  s_add_u32 m0, s64, 110592
  v_mfma_f32_16x16x32_bf16 v[124:127], a[244:247], a[236:239], v[124:127]
  v_lshlrev_b32 v29, 6, v29
  v_lshlrev_b32 v37, 7, v31
  s_waitcnt lgkmcnt(2)
  v_mfma_f32_16x16x32_bf16 v[96:99], a[248:251], a[96:99], v[96:99]
  ds_read_b64_tr_b16 a[244:245], v3 offset:16384
  ds_read_b64_tr_b16 a[246:247], v3 offset:16896
  v_mfma_f32_16x16x32_bf16 v[100:103], a[248:251], a[100:103], v[100:103]
  buffer_load_dwordx4 v11, s[12:15], s67 offen lds
  v_add3_u32 v8, v37, v29, v28
  v_mfma_f32_16x16x32_bf16 v[104:107], a[248:251], v[192:195], v[104:107]
  v_bfe_u32 v24, v0, 2, 1
  v_bfe_u32 v25, v0, 4, 1
  v_mfma_f32_16x16x32_bf16 v[108:111], a[248:251], v[196:199], v[108:111]
  v_xor_b32 v24, v24, v25
  v_lshlrev_b32 v24, 6, v24
  v_mfma_f32_16x16x32_bf16 v[112:115], a[252:255], a[96:99], v[112:115]
  ds_read_b64_tr_b16 a[248:249], v2 offset:20480
  ds_read_b64_tr_b16 a[250:251], v2 offset:20992
  v_mfma_f32_16x16x32_bf16 v[116:119], a[252:255], a[100:103], v[116:119]
  v_bfe_u32 v25, v0, 1, 1
  v_bfe_u32 v26, v0, 5, 1
  v_mfma_f32_16x16x32_bf16 v[120:123], a[252:255], v[192:195], v[120:123]
  v_xor_b32 v25, v25, v26
  v_lshl_add_u32 v24, v25, 5, v24
  v_mfma_f32_16x16x32_bf16 v[124:127], a[252:255], v[196:199], v[124:127]
  v_and_b32 v25, 1, v0
  v_lshl_add_u32 v24, v25, 4, v24
  s_waitcnt lgkmcnt(2)
  v_mfma_f32_16x16x32_bf16 v[96:99], a[240:243], a[104:107], v[96:99]
  ds_read_b64_tr_b16 a[252:253], v3 offset:20480
  ds_read_b64_tr_b16 a[254:255], v3 offset:20992
  v_mfma_f32_16x16x32_bf16 v[100:103], a[240:243], a[108:111], v[100:103]
  s_add_u32 s65, s52, 128
  s_add_u32 m0, s63, 0
  v_mfma_f32_16x16x32_bf16 v[104:107], a[240:243], v[200:203], v[104:107]
  buffer_load_dwordx4 v240, s[8:11], s65 offen lds
  v_lshrrev_b32 v25, 3, v0
  v_mfma_f32_16x16x32_bf16 v[108:111], a[240:243], v[204:207], v[108:111]
  v_mul_u32_u24 v25, 1152, v25
  v_add_u32 v248, v25, v24
  s_waitcnt vmcnt(13)
  s_barrier
  v_mfma_f32_16x16x32_bf16 v[112:115], a[244:247], a[104:107], v[112:115]
  ds_read_b64_tr_b16 a[240:241], v2 offset:24576
  ds_read_b64_tr_b16 a[242:243], v2 offset:25088
  ds_read_b128 a[128:131], v20 offset:0
  v_mfma_f32_16x16x32_bf16 v[116:119], a[244:247], a[108:111], v[116:119]
  ds_read_b128 v[224:227], v22 offset:0
  ds_read_b128 a[132:135], v20 offset:2048
  ds_read_b128 v[228:231], v22 offset:2048
  v_mfma_f32_16x16x32_bf16 v[120:123], a[244:247], v[200:203], v[120:123]
  buffer_load_dwordx4 v241, s[8:11], s65 offen offset:1024 lds
  ds_read_b128 a[136:139], v21 offset:0
  ds_read_b128 v[232:235], v23 offset:0
  v_mfma_f32_16x16x32_bf16 v[124:127], a[244:247], v[204:207], v[124:127]
  ds_read_b128 a[140:143], v21 offset:2048
  ds_read_b128 v[236:239], v23 offset:2048
  s_waitcnt lgkmcnt(10)
  v_mfma_f32_16x16x32_bf16 v[96:99], a[248:251], a[112:115], v[96:99]
  ds_read_b64_tr_b16 a[244:245], v3 offset:24576
  ds_read_b64_tr_b16 a[246:247], v3 offset:25088
  v_mfma_f32_16x16x32_bf16 v[100:103], a[248:251], a[116:119], v[100:103]
  v_lshrrev_b32 v24, 2, v0
  v_bfe_u32 v25, v0, 1, 1
  v_mfma_f32_16x16x32_bf16 v[104:107], a[248:251], v[208:211], v[104:107]
  buffer_load_dwordx4 v242, s[8:11], s65 offen offset:2048 lds
  v_bfe_u32 v26, v0, 5, 1
  v_mfma_f32_16x16x32_bf16 v[108:111], a[248:251], v[212:215], v[108:111]
  v_xor_b32 v26, v25, v26
  v_lshlrev_b32 v26, 5, v26
  v_mfma_f32_16x16x32_bf16 v[112:115], a[252:255], a[112:115], v[112:115]
  ds_read_b64_tr_b16 a[248:249], v2 offset:28672
  ds_read_b64_tr_b16 a[250:251], v2 offset:29184
  v_mfma_f32_16x16x32_bf16 v[116:119], a[252:255], a[116:119], v[116:119]
  v_and_b32 v27, 1, v0
  v_lshl_add_u32 v26, v27, 4, v26
  v_mfma_f32_16x16x32_bf16 v[120:123], a[252:255], v[208:211], v[120:123]
  buffer_load_dwordx4 v243, s[8:11], s65 offen offset:3072 lds
  s_mov_b32 s84, 9216
  v_mfma_f32_16x16x32_bf16 v[124:127], a[252:255], v[212:215], v[124:127]
  v_mul_lo_u32 v28, v24, s84
  v_add_u32 v244, v28, v26
  s_waitcnt lgkmcnt(2)
  v_mfma_f32_16x16x32_bf16 v[96:99], a[240:243], a[120:123], v[96:99]
  ds_read_b64_tr_b16 a[252:253], v3 offset:28672
  ds_read_b64_tr_b16 a[254:255], v3 offset:29184
  v_mfma_f32_16x16x32_bf16 v[100:103], a[240:243], a[124:127], v[100:103]
  v_bfe_u32 v26, v0, 4, 1
  v_xor_b32 v26, v25, v26
  v_mfma_f32_16x16x32_bf16 v[104:107], a[240:243], v[216:219], v[104:107]
  s_add_u32 s66, s52, 1179776
  s_add_u32 m0, s63, 16384
  v_mfma_f32_16x16x32_bf16 v[108:111], a[240:243], v[220:223], v[108:111]
  v_lshlrev_b32 v26, 5, v26
  v_lshl_add_u32 v26, v27, 4, v26
  v_mfma_f32_16x16x32_bf16 v[112:115], a[244:247], a[120:123], v[112:115]
  ds_read_b64_tr_b16 a[240:241], v2 offset:32768
  ds_read_b64_tr_b16 a[242:243], v2 offset:33280
  v_mfma_f32_16x16x32_bf16 v[116:119], a[244:247], a[124:127], v[116:119]
  buffer_load_dwordx4 v240, s[8:11], s66 offen lds
  v_mul_u32_u24 v28, 1152, v24
  v_mfma_f32_16x16x32_bf16 v[120:123], a[244:247], v[216:219], v[120:123]
  buffer_load_dwordx4 v241, s[8:11], s66 offen offset:1024 lds
  v_add_u32 v252, v28, v26
  v_mfma_f32_16x16x32_bf16 v[124:127], a[244:247], v[220:223], v[124:127]
  s_lshl_b32 s84, s48, 11
  s_add_u32 s84, s84, 147456
  s_waitcnt lgkmcnt(2)
  v_mfma_f32_16x16x32_bf16 v[96:99], a[248:251], a[128:131], v[96:99]
  ds_read_b64_tr_b16 a[244:245], v3 offset:32768
  ds_read_b64_tr_b16 a[246:247], v3 offset:33280
  v_mfma_f32_16x16x32_bf16 v[100:103], a[248:251], a[132:135], v[100:103]
  buffer_load_dwordx4 v242, s[8:11], s66 offen offset:2048 lds
  v_add_u32 v4, s84, v1
  v_mfma_f32_16x16x32_bf16 v[104:107], a[248:251], v[224:227], v[104:107]
  buffer_load_dwordx4 v243, s[8:11], s66 offen offset:3072 lds
  s_xor_b32 s84, s48, 1
  v_mfma_f32_16x16x32_bf16 v[108:111], a[248:251], v[228:231], v[108:111]
  s_lshl_b32 s84, s84, 11
  s_add_u32 s84, s84, 147456
  v_mfma_f32_16x16x32_bf16 v[112:115], a[252:255], a[128:131], v[112:115]
  s_add_u32 s67, s53, 128
  s_add_u32 m0, s64, 0
  v_mfma_f32_16x16x32_bf16 v[116:119], a[252:255], a[132:135], v[116:119]
  v_add_u32 v5, s84, v1
  v_add_u32 v249, 8192, v248
  v_mfma_f32_16x16x32_bf16 v[120:123], a[252:255], v[224:227], v[120:123]
  buffer_load_dwordx4 v11, s[8:11], s67 offen lds
  s_add_u32 s5, s75, 256
  v_mfma_f32_16x16x32_bf16 v[124:127], a[252:255], v[228:231], v[124:127]
  buffer_load_dword v95, v14, s[8:11], s5 offen
  s_waitcnt vmcnt(10) lgkmcnt(0)
  s_barrier
  v_add_u32 v2, 110592, v6
  v_xor_b32 v3, 32, v2
  v_mfma_f32_16x16x32_bf16 v[96:99], a[240:243], a[136:139], v[96:99]
  ds_read_b64_tr_b16 a[248:249], v2 offset:0
  ds_read_b64_tr_b16 a[250:251], v2 offset:512
  ds_read_b64_tr_b16 a[252:253], v3 offset:0
  v_mfma_f32_16x16x32_bf16 v[100:103], a[240:243], a[140:143], v[100:103]
  ds_read_b64_tr_b16 a[254:255], v3 offset:512
  s_add_u32 s5, s75, 2654464
  buffer_load_dword v95, v14, s[8:11], s5 offen
  v_mfma_f32_16x16x32_bf16 v[104:107], a[240:243], v[232:235], v[104:107]
  v_add_u32 v245, 146432, v244
  v_add_u32 v253, 17408, v252
  v_mfma_f32_16x16x32_bf16 v[108:111], a[240:243], v[236:239], v[108:111]
  v_add_u32 v250, 16384, v248
  v_add_u32 v246, 292864, v244
  v_mfma_f32_16x16x32_bf16 v[112:115], a[244:247], a[136:139], v[112:115]
  ds_read_b64_tr_b16 a[240:241], v2 offset:4096
  ds_read_b64_tr_b16 a[242:243], v2 offset:4608
  v_mfma_f32_16x16x32_bf16 v[116:119], a[244:247], a[140:143], v[116:119]
  v_add_u32 v254, 34816, v252
  v_add_u32 v251, 24576, v248
  v_mfma_f32_16x16x32_bf16 v[120:123], a[244:247], v[232:235], v[120:123]
  v_add_u32 v247, 439296, v244
  v_add_u32 v255, 52224, v252
  v_mfma_f32_16x16x32_bf16 v[124:127], a[244:247], v[236:239], v[124:127]
  v_mov_b32 v0, v38
  s_nop 0
  s_waitcnt lgkmcnt(2)
  v_mfma_f32_16x16x32_bf16 v[160:163], a[248:251], a[72:75], v[160:163]
  ds_read_b64_tr_b16 a[244:245], v3 offset:4096
  ds_read_b64_tr_b16 a[246:247], v3 offset:4608
  v_mfma_f32_16x16x32_bf16 v[164:167], a[248:251], a[76:79], v[164:167]
  v_mfma_f32_16x16x32_bf16 v[168:171], a[248:251], a[216:219], v[168:171]
  s_add_u32 s65, s52, 2654336
  s_add_u32 m0, s63, 36864
  v_mfma_f32_16x16x32_bf16 v[172:175], a[248:251], a[220:223], v[172:175]
  v_mfma_f32_16x16x32_bf16 v[176:179], a[252:255], a[72:75], v[176:179]
  ds_read_b64_tr_b16 a[248:249], v2 offset:8192
  ds_read_b64_tr_b16 a[250:251], v2 offset:8704
  v_mfma_f32_16x16x32_bf16 v[180:183], a[252:255], a[76:79], v[180:183]
  buffer_load_dwordx4 v240, s[8:11], s65 offen lds
  v_mfma_f32_16x16x32_bf16 v[184:187], a[252:255], a[216:219], v[184:187]
  buffer_load_dwordx4 v241, s[8:11], s65 offen offset:1024 lds
  v_mul_f32 v16, 0xbfb8aa3b, v96
  v_mfma_f32_16x16x32_bf16 v[188:191], a[252:255], a[220:223], v[188:191]
  v_exp_f32 v16, v16
  s_waitcnt lgkmcnt(2)
  v_mfma_f32_16x16x32_bf16 v[160:163], a[240:243], a[80:83], v[160:163]
  ds_read_b64_tr_b16 a[252:253], v3 offset:8192
  ds_read_b64_tr_b16 a[254:255], v3 offset:8704
  v_mfma_f32_16x16x32_bf16 v[164:167], a[240:243], a[84:87], v[164:167]
  buffer_load_dwordx4 v242, s[8:11], s65 offen offset:2048 lds
  v_add_f32 v16, 1.0, v16
  v_mfma_f32_16x16x32_bf16 v[168:171], a[240:243], a[224:227], v[168:171]
  buffer_load_dwordx4 v243, s[8:11], s65 offen offset:3072 lds
  v_mul_f32 v17, 0xbfb8aa3b, v97
  v_mfma_f32_16x16x32_bf16 v[172:175], a[240:243], a[228:231], v[172:175]
  v_rcp_f32 v16, v16
  v_mfma_f32_16x16x32_bf16 v[176:179], a[244:247], a[80:83], v[176:179]
  ds_read_b64_tr_b16 a[240:241], v2 offset:12288
  ds_read_b64_tr_b16 a[242:243], v2 offset:12800
  v_mfma_f32_16x16x32_bf16 v[180:183], a[244:247], a[84:87], v[180:183]
  v_mul_f32 v96, v96, v16
  v_mul_f32 v18, 0xbfb8aa3b, v98
  v_mfma_f32_16x16x32_bf16 v[184:187], a[244:247], a[224:227], v[184:187]
  s_add_u32 s66, s52, 3833984
  s_add_u32 m0, s63, 53248
  v_mfma_f32_16x16x32_bf16 v[188:191], a[244:247], a[228:231], v[188:191]
  v_exp_f32 v17, v17
  s_waitcnt lgkmcnt(2)
  v_mfma_f32_16x16x32_bf16 v[160:163], a[248:251], a[88:91], v[160:163]
  ds_read_b64_tr_b16 a[244:245], v3 offset:12288
  ds_read_b64_tr_b16 a[246:247], v3 offset:12800
  v_mfma_f32_16x16x32_bf16 v[164:167], a[248:251], a[92:95], v[164:167]
  buffer_load_dwordx4 v240, s[8:11], s66 offen lds
  v_add_f32 v17, 1.0, v17
  v_mfma_f32_16x16x32_bf16 v[168:171], a[248:251], a[232:235], v[168:171]
  buffer_load_dwordx4 v241, s[8:11], s66 offen offset:1024 lds
  v_mul_f32 v19, 0xbfb8aa3b, v99
  v_mfma_f32_16x16x32_bf16 v[172:175], a[248:251], a[236:239], v[172:175]
  v_rcp_f32 v17, v17
  v_mfma_f32_16x16x32_bf16 v[176:179], a[252:255], a[88:91], v[176:179]
  ds_read_b64_tr_b16 a[248:249], v2 offset:16384
  ds_read_b64_tr_b16 a[250:251], v2 offset:16896
  v_mfma_f32_16x16x32_bf16 v[180:183], a[252:255], a[92:95], v[180:183]
  buffer_load_dwordx4 v242, s[8:11], s66 offen offset:2048 lds
  v_mul_f32 v97, v97, v17
  v_mfma_f32_16x16x32_bf16 v[184:187], a[252:255], a[232:235], v[184:187]
  buffer_load_dwordx4 v243, s[8:11], s66 offen offset:3072 lds
  v_mul_f32 v20, 0xbfb8aa3b, v100
  v_mfma_f32_16x16x32_bf16 v[188:191], a[252:255], a[236:239], v[188:191]
  v_exp_f32 v18, v18
  s_waitcnt lgkmcnt(2)
  v_mfma_f32_16x16x32_bf16 v[160:163], a[240:243], a[96:99], v[160:163]
  ds_read_b64_tr_b16 a[252:253], v3 offset:16384
  ds_read_b64_tr_b16 a[254:255], v3 offset:16896
  v_mfma_f32_16x16x32_bf16 v[164:167], a[240:243], a[100:103], v[164:167]
  v_add_f32 v18, 1.0, v18
  v_mul_f32 v21, 0xbfb8aa3b, v101
  v_mfma_f32_16x16x32_bf16 v[168:171], a[240:243], v[192:195], v[168:171]
  s_add_u32 s67, s53, 2654336
  s_add_u32 m0, s64, 36864
  v_mfma_f32_16x16x32_bf16 v[172:175], a[240:243], v[196:199], v[172:175]
  v_rcp_f32 v18, v18
  v_mfma_f32_16x16x32_bf16 v[176:179], a[244:247], a[96:99], v[176:179]
  ds_read_b64_tr_b16 a[240:241], v2 offset:20480
  ds_read_b64_tr_b16 a[242:243], v2 offset:20992
  v_mfma_f32_16x16x32_bf16 v[180:183], a[244:247], a[100:103], v[180:183]
  buffer_load_dwordx4 v11, s[8:11], s67 offen lds
  v_mul_f32 v98, v98, v18
  v_mfma_f32_16x16x32_bf16 v[184:187], a[244:247], v[192:195], v[184:187]
  v_exp_f32 v19, v19
  v_mfma_f32_16x16x32_bf16 v[188:191], a[244:247], v[196:199], v[188:191]
  v_add_f32 v19, 1.0, v19
  v_mul_f32 v22, 0xbfb8aa3b, v102
  s_waitcnt lgkmcnt(2)
  v_mfma_f32_16x16x32_bf16 v[160:163], a[248:251], a[104:107], v[160:163]
  ds_read_b64_tr_b16 a[244:245], v3 offset:20480
  ds_read_b64_tr_b16 a[246:247], v3 offset:20992
  v_mfma_f32_16x16x32_bf16 v[164:167], a[248:251], a[108:111], v[164:167]
  s_add_u32 s65, s52, 128
  s_add_u32 m0, s63, 73728
  v_mfma_f32_16x16x32_bf16 v[168:171], a[248:251], v[200:203], v[168:171]
  buffer_load_dwordx4 v240, s[12:15], s65 offen lds
  v_mul_f32 v23, 0xbfb8aa3b, v103
  v_mfma_f32_16x16x32_bf16 v[172:175], a[248:251], v[204:207], v[172:175]
  v_rcp_f32 v19, v19
  v_mfma_f32_16x16x32_bf16 v[176:179], a[252:255], a[104:107], v[176:179]
  ds_read_b64_tr_b16 a[248:249], v2 offset:24576
  ds_read_b64_tr_b16 a[250:251], v2 offset:25088
  v_mfma_f32_16x16x32_bf16 v[180:183], a[252:255], a[108:111], v[180:183]
  v_mul_f32 v99, v99, v19
  v_mul_f32 v16, 0xbfb8aa3b, v104
  v_mfma_f32_16x16x32_bf16 v[184:187], a[252:255], v[200:203], v[184:187]
  buffer_load_dwordx4 v241, s[12:15], s65 offen offset:1024 lds
  v_mul_f32 v17, 0xbfb8aa3b, v105
  v_mfma_f32_16x16x32_bf16 v[188:191], a[252:255], v[204:207], v[188:191]
  v_exp_f32 v20, v20
  s_waitcnt lgkmcnt(2)
  v_mfma_f32_16x16x32_bf16 v[160:163], a[240:243], a[112:115], v[160:163]
  ds_read_b64_tr_b16 a[252:253], v3 offset:24576
  ds_read_b64_tr_b16 a[254:255], v3 offset:25088
  v_mfma_f32_16x16x32_bf16 v[164:167], a[240:243], a[116:119], v[164:167]
  v_add_f32 v20, 1.0, v20
  v_mul_f32 v18, 0xbfb8aa3b, v106
  v_mfma_f32_16x16x32_bf16 v[168:171], a[240:243], v[208:211], v[168:171]
  buffer_load_dwordx4 v242, s[12:15], s65 offen offset:2048 lds
  v_mul_f32 v19, 0xbfb8aa3b, v107
  v_mfma_f32_16x16x32_bf16 v[172:175], a[240:243], v[212:215], v[172:175]
  v_rcp_f32 v20, v20
  v_mfma_f32_16x16x32_bf16 v[176:179], a[244:247], a[112:115], v[176:179]
  ds_read_b64_tr_b16 a[240:241], v2 offset:28672
  ds_read_b64_tr_b16 a[242:243], v2 offset:29184
  v_mfma_f32_16x16x32_bf16 v[180:183], a[244:247], a[116:119], v[180:183]
  s_add_u32 s5, s75, 256
  buffer_load_dword v95, v14, s[12:15], s5 offen
  v_mfma_f32_16x16x32_bf16 v[184:187], a[244:247], v[208:211], v[184:187]
  buffer_load_dwordx4 v243, s[12:15], s65 offen offset:3072 lds
  v_mul_f32 v100, v100, v20
  v_mfma_f32_16x16x32_bf16 v[188:191], a[244:247], v[212:215], v[188:191]
  v_exp_f32 v21, v21
  s_waitcnt lgkmcnt(2)
  v_mfma_f32_16x16x32_bf16 v[160:163], a[248:251], a[120:123], v[160:163]
  ds_read_b64_tr_b16 a[244:245], v3 offset:28672
  ds_read_b64_tr_b16 a[246:247], v3 offset:29184
  v_mfma_f32_16x16x32_bf16 v[164:167], a[248:251], a[124:127], v[164:167]
  s_add_u32 s5, s75, 2654464
  buffer_load_dword v95, v14, s[12:15], s5 offen
  v_mfma_f32_16x16x32_bf16 v[168:171], a[248:251], v[216:219], v[168:171]
  s_add_u32 s66, s52, 1179776
  s_add_u32 m0, s63, 90112
  v_mfma_f32_16x16x32_bf16 v[172:175], a[248:251], v[220:223], v[172:175]
  v_add_f32 v21, 1.0, v21
  v_mul_f32 v20, 0xbfb8aa3b, v108
  v_mfma_f32_16x16x32_bf16 v[176:179], a[252:255], a[120:123], v[176:179]
  ds_read_b64_tr_b16 a[248:249], v2 offset:32768
  ds_read_b64_tr_b16 a[250:251], v2 offset:33280
  v_mfma_f32_16x16x32_bf16 v[180:183], a[252:255], a[124:127], v[180:183]
  buffer_load_dwordx4 v240, s[12:15], s66 offen lds
  v_mfma_f32_16x16x32_bf16 v[184:187], a[252:255], v[216:219], v[184:187]
  buffer_load_dwordx4 v241, s[12:15], s66 offen offset:1024 lds
  v_mfma_f32_16x16x32_bf16 v[188:191], a[252:255], v[220:223], v[188:191]
  v_rcp_f32 v21, v21
  s_waitcnt lgkmcnt(2)
  v_mfma_f32_16x16x32_bf16 v[160:163], a[240:243], a[128:131], v[160:163]
  ds_read_b64_tr_b16 a[252:253], v3 offset:32768
  ds_read_b64_tr_b16 a[254:255], v3 offset:33280
  v_mfma_f32_16x16x32_bf16 v[164:167], a[240:243], a[132:135], v[164:167]
  buffer_load_dwordx4 v242, s[12:15], s66 offen offset:2048 lds
  v_mul_f32 v101, v101, v21
  v_mfma_f32_16x16x32_bf16 v[168:171], a[240:243], v[224:227], v[168:171]
  buffer_load_dwordx4 v243, s[12:15], s66 offen offset:3072 lds
  v_mul_f32 v21, 0xbfb8aa3b, v109
  v_mfma_f32_16x16x32_bf16 v[172:175], a[240:243], v[228:231], v[172:175]
  v_exp_f32 v22, v22
  v_mfma_f32_16x16x32_bf16 v[176:179], a[244:247], a[128:131], v[176:179]
  s_add_u32 s67, s53, 128
  s_add_u32 m0, s64, 73728
  v_mfma_f32_16x16x32_bf16 v[180:183], a[244:247], a[132:135], v[180:183]
  v_add_f32 v22, 1.0, v22
  v_mfma_f32_16x16x32_bf16 v[184:187], a[244:247], v[224:227], v[184:187]
  buffer_load_dwordx4 v11, s[12:15], s67 offen lds
  v_mfma_f32_16x16x32_bf16 v[188:191], a[244:247], v[228:231], v[188:191]
  s_waitcnt vmcnt(22) lgkmcnt(0)
  s_barrier
  v_mov_b32 v2, v6
  v_xor_b32 v3, 32, v2
  v_mfma_f32_16x16x32_bf16 v[160:163], a[248:251], a[136:139], v[160:163]
  ds_read_b64_tr_b16 a[240:241], v2 offset:0
  ds_read_b64_tr_b16 a[242:243], v2 offset:512
  v_mfma_f32_16x16x32_bf16 v[164:167], a[248:251], a[140:143], v[164:167]
  ds_read_b64_tr_b16 a[244:245], v3 offset:0
  ds_read_b64_tr_b16 a[246:247], v3 offset:512
  v_mfma_f32_16x16x32_bf16 v[168:171], a[248:251], v[232:235], v[168:171]
  v_rcp_f32 v22, v22
  v_mfma_f32_16x16x32_bf16 v[172:175], a[248:251], v[236:239], v[172:175]
  v_mul_f32 v102, v102, v22
  v_mul_f32 v22, 0xbfb8aa3b, v110
  v_mfma_f32_16x16x32_bf16 v[176:179], a[252:255], a[136:139], v[176:179]
  ds_read_b64_tr_b16 a[248:249], v2 offset:4096
  ds_read_b64_tr_b16 a[250:251], v2 offset:4608
  v_mfma_f32_16x16x32_bf16 v[180:183], a[252:255], a[140:143], v[180:183]
  v_exp_f32 v23, v23
  v_mfma_f32_16x16x32_bf16 v[184:187], a[252:255], v[232:235], v[184:187]
  v_add_f32 v23, 1.0, v23
  v_mfma_f32_16x16x32_bf16 v[188:191], a[252:255], v[236:239], v[188:191]
  v_rcp_f32 v23, v23
  s_waitcnt lgkmcnt(2)
  v_mfma_f32_16x16x32_bf16 v[128:131], a[240:243], a[0:3], 0
  ds_read_b64_tr_b16 a[252:253], v3 offset:4096
  ds_read_b64_tr_b16 a[254:255], v3 offset:4608
  v_mfma_f32_16x16x32_bf16 v[132:135], a[240:243], a[4:7], 0
  v_mul_f32 v103, v103, v23
  v_mul_f32 v23, 0xbfb8aa3b, v111
  v_mfma_f32_16x16x32_bf16 v[136:139], a[240:243], a[144:147], 0
  s_add_u32 s65, s52, 2654336
  s_add_u32 m0, s63, 110592
  v_mfma_f32_16x16x32_bf16 v[140:143], a[240:243], a[148:151], 0
  v_exp_f32 v16, v16
  v_mfma_f32_16x16x32_bf16 v[144:147], a[244:247], a[0:3], 0
  ds_read_b64_tr_b16 a[240:241], v2 offset:8192
  ds_read_b64_tr_b16 a[242:243], v2 offset:8704
  v_mfma_f32_16x16x32_bf16 v[148:151], a[244:247], a[4:7], 0
  buffer_load_dwordx4 v240, s[12:15], s65 offen lds
  s_min_u32 s83, s50, 3
  v_mfma_f32_16x16x32_bf16 v[152:155], a[244:247], a[144:147], 0
  v_add_f32 v16, 1.0, v16
  v_mfma_f32_16x16x32_bf16 v[156:159], a[244:247], a[148:151], 0
  v_rcp_f32 v16, v16
  s_waitcnt lgkmcnt(2)
  v_mfma_f32_16x16x32_bf16 v[128:131], a[248:251], a[8:11], v[128:131]
  ds_read_b64_tr_b16 a[244:245], v3 offset:8192
  ds_read_b64_tr_b16 a[246:247], v3 offset:8704
  v_mfma_f32_16x16x32_bf16 v[132:135], a[248:251], a[12:15], v[132:135]
  buffer_load_dwordx4 v241, s[12:15], s65 offen offset:1024 lds
  v_mul_f32 v104, v104, v16
  v_mfma_f32_16x16x32_bf16 v[136:139], a[248:251], a[152:155], v[136:139]
  v_exp_f32 v17, v17
  v_mfma_f32_16x16x32_bf16 v[140:143], a[248:251], a[156:159], v[140:143]
  v_add_f32 v17, 1.0, v17
  v_mul_f32 v16, 0xbfb8aa3b, v112
  v_mfma_f32_16x16x32_bf16 v[144:147], a[252:255], a[8:11], v[144:147]
  ds_read_b64_tr_b16 a[248:249], v2 offset:12288
  ds_read_b64_tr_b16 a[250:251], v2 offset:12800
  v_mfma_f32_16x16x32_bf16 v[148:151], a[252:255], a[12:15], v[148:151]
  buffer_load_dwordx4 v242, s[12:15], s65 offen offset:2048 lds
  v_mfma_f32_16x16x32_bf16 v[152:155], a[252:255], a[152:155], v[152:155]
  v_rcp_f32 v17, v17
  v_mfma_f32_16x16x32_bf16 v[156:159], a[252:255], a[156:159], v[156:159]
  v_mul_f32 v105, v105, v17
  v_mul_f32 v17, 0xbfb8aa3b, v113
  s_waitcnt lgkmcnt(2)
  v_mfma_f32_16x16x32_bf16 v[128:131], a[240:243], a[16:19], v[128:131]
  ds_read_b64_tr_b16 a[252:253], v3 offset:12288
  ds_read_b64_tr_b16 a[254:255], v3 offset:12800
  v_mfma_f32_16x16x32_bf16 v[132:135], a[240:243], a[20:23], v[132:135]
  buffer_load_dwordx4 v243, s[12:15], s65 offen offset:3072 lds
  v_mfma_f32_16x16x32_bf16 v[136:139], a[240:243], a[160:163], v[136:139]
  v_exp_f32 v18, v18
  v_mfma_f32_16x16x32_bf16 v[140:143], a[240:243], a[164:167], v[140:143]
  v_add_f32 v18, 1.0, v18
  v_mfma_f32_16x16x32_bf16 v[144:147], a[244:247], a[16:19], v[144:147]
  ds_read_b64_tr_b16 a[240:241], v2 offset:16384
  ds_read_b64_tr_b16 a[242:243], v2 offset:16896
  v_mfma_f32_16x16x32_bf16 v[148:151], a[244:247], a[20:23], v[148:151]
  s_add_u32 s66, s52, 3833984
  s_add_u32 m0, s63, 126976
  v_mfma_f32_16x16x32_bf16 v[152:155], a[244:247], a[160:163], v[152:155]
  buffer_load_dwordx4 v240, s[12:15], s66 offen lds
  v_mfma_f32_16x16x32_bf16 v[156:159], a[244:247], a[164:167], v[156:159]
  v_rcp_f32 v18, v18
  s_waitcnt lgkmcnt(2)
  v_mfma_f32_16x16x32_bf16 v[128:131], a[248:251], a[24:27], v[128:131]
  ds_read_b64_tr_b16 a[244:245], v3 offset:16384
  ds_read_b64_tr_b16 a[246:247], v3 offset:16896
  v_mfma_f32_16x16x32_bf16 v[132:135], a[248:251], a[28:31], v[132:135]
  v_mul_f32 v106, v106, v18
  v_mul_f32 v18, 0xbfb8aa3b, v114
  v_mfma_f32_16x16x32_bf16 v[136:139], a[248:251], a[168:171], v[136:139]
  buffer_load_dwordx4 v241, s[12:15], s66 offen offset:1024 lds
  v_mfma_f32_16x16x32_bf16 v[140:143], a[248:251], a[172:175], v[140:143]
  v_exp_f32 v19, v19
  v_mfma_f32_16x16x32_bf16 v[144:147], a[252:255], a[24:27], v[144:147]
  ds_read_b64_tr_b16 a[248:249], v2 offset:20480
  ds_read_b64_tr_b16 a[250:251], v2 offset:20992
  v_mfma_f32_16x16x32_bf16 v[148:151], a[252:255], a[28:31], v[148:151]
  v_add_f32 v19, 1.0, v19
  v_mfma_f32_16x16x32_bf16 v[152:155], a[252:255], a[168:171], v[152:155]
  buffer_load_dwordx4 v242, s[12:15], s66 offen offset:2048 lds
  v_mfma_f32_16x16x32_bf16 v[156:159], a[252:255], a[172:175], v[156:159]
  v_rcp_f32 v19, v19
  s_waitcnt lgkmcnt(2)
  v_mfma_f32_16x16x32_bf16 v[128:131], a[240:243], a[32:35], v[128:131]
  ds_read_b64_tr_b16 a[252:253], v3 offset:20480
  ds_read_b64_tr_b16 a[254:255], v3 offset:20992
  v_mfma_f32_16x16x32_bf16 v[132:135], a[240:243], a[36:39], v[132:135]
  v_mul_f32 v107, v107, v19
  v_mul_f32 v19, 0xbfb8aa3b, v115
  v_mfma_f32_16x16x32_bf16 v[136:139], a[240:243], a[176:179], v[136:139]
  buffer_load_dwordx4 v243, s[12:15], s66 offen offset:3072 lds
  v_mfma_f32_16x16x32_bf16 v[140:143], a[240:243], a[180:183], v[140:143]
  v_exp_f32 v20, v20
  v_mfma_f32_16x16x32_bf16 v[144:147], a[244:247], a[32:35], v[144:147]
  ds_read_b64_tr_b16 a[240:241], v2 offset:24576
  ds_read_b64_tr_b16 a[242:243], v2 offset:25088
  v_mfma_f32_16x16x32_bf16 v[148:151], a[244:247], a[36:39], v[148:151]
  v_add_f32 v20, 1.0, v20
  v_mfma_f32_16x16x32_bf16 v[152:155], a[244:247], a[176:179], v[152:155]
  s_add_u32 s67, s53, 2654336
  s_add_u32 m0, s64, 110592
  v_mfma_f32_16x16x32_bf16 v[156:159], a[244:247], a[180:183], v[156:159]
  v_rcp_f32 v20, v20
  s_waitcnt lgkmcnt(2)
  v_mfma_f32_16x16x32_bf16 v[128:131], a[248:251], a[40:43], v[128:131]
  ds_read_b64_tr_b16 a[244:245], v3 offset:24576
  ds_read_b64_tr_b16 a[246:247], v3 offset:25088
  v_mfma_f32_16x16x32_bf16 v[132:135], a[248:251], a[44:47], v[132:135]
  buffer_load_dwordx4 v11, s[12:15], s67 offen lds
  v_mul_f32 v108, v108, v20
  v_mfma_f32_16x16x32_bf16 v[136:139], a[248:251], a[184:187], v[136:139]
  v_exp_f32 v21, v21
  v_mfma_f32_16x16x32_bf16 v[140:143], a[248:251], a[188:191], v[140:143]
  v_add_f32 v21, 1.0, v21
  v_mul_f32 v20, 0xbfb8aa3b, v116
  v_mfma_f32_16x16x32_bf16 v[144:147], a[252:255], a[40:43], v[144:147]
  ds_read_b64_tr_b16 a[248:249], v2 offset:28672
  ds_read_b64_tr_b16 a[250:251], v2 offset:29184
  v_mfma_f32_16x16x32_bf16 v[148:151], a[252:255], a[44:47], v[148:151]
  s_add_u32 s5, s75, 384
  buffer_load_dword v95, v14, s[8:11], s5 offen
  v_mfma_f32_16x16x32_bf16 v[152:155], a[252:255], a[184:187], v[152:155]
  v_rcp_f32 v21, v21
  v_mfma_f32_16x16x32_bf16 v[156:159], a[252:255], a[188:191], v[156:159]
  v_mul_f32 v109, v109, v21
  v_mul_f32 v21, 0xbfb8aa3b, v117
  s_waitcnt lgkmcnt(2)
  v_mfma_f32_16x16x32_bf16 v[128:131], a[240:243], a[48:51], v[128:131]
  ds_read_b64_tr_b16 a[252:253], v3 offset:28672
  ds_read_b64_tr_b16 a[254:255], v3 offset:29184
  v_mfma_f32_16x16x32_bf16 v[132:135], a[240:243], a[52:55], v[132:135]
  s_add_u32 s5, s75, 2654592
  buffer_load_dword v95, v14, s[8:11], s5 offen
  v_mfma_f32_16x16x32_bf16 v[136:139], a[240:243], a[192:195], v[136:139]
  v_exp_f32 v22, v22
  v_mfma_f32_16x16x32_bf16 v[140:143], a[240:243], a[196:199], v[140:143]
  v_add_f32 v22, 1.0, v22
  v_mfma_f32_16x16x32_bf16 v[144:147], a[244:247], a[48:51], v[144:147]
  ds_read_b64_tr_b16 a[240:241], v2 offset:32768
  ds_read_b64_tr_b16 a[242:243], v2 offset:33280
  v_mfma_f32_16x16x32_bf16 v[148:151], a[244:247], a[52:55], v[148:151]
  v_rcp_f32 v22, v22
  v_mfma_f32_16x16x32_bf16 v[152:155], a[244:247], a[192:195], v[152:155]
  v_mul_f32 v110, v110, v22
  v_mul_f32 v22, 0xbfb8aa3b, v118
  v_mfma_f32_16x16x32_bf16 v[156:159], a[244:247], a[196:199], v[156:159]
  v_exp_f32 v23, v23
  s_waitcnt lgkmcnt(2)
  v_mfma_f32_16x16x32_bf16 v[128:131], a[248:251], a[56:59], v[128:131]
  ds_read_b64_tr_b16 a[244:245], v3 offset:32768
  ds_read_b64_tr_b16 a[246:247], v3 offset:33280
  v_mfma_f32_16x16x32_bf16 v[132:135], a[248:251], a[60:63], v[132:135]
  v_add_f32 v23, 1.0, v23
  v_mfma_f32_16x16x32_bf16 v[136:139], a[248:251], a[200:203], v[136:139]
  v_rcp_f32 v23, v23
  v_mfma_f32_16x16x32_bf16 v[140:143], a[248:251], a[204:207], v[140:143]
  v_mul_f32 v111, v111, v23
  v_mul_f32 v23, 0xbfb8aa3b, v119
  v_mfma_f32_16x16x32_bf16 v[144:147], a[252:255], a[56:59], v[144:147]
  v_exp_f32 v16, v16
  v_mfma_f32_16x16x32_bf16 v[148:151], a[252:255], a[60:63], v[148:151]
  v_add_f32 v16, 1.0, v16
  v_mfma_f32_16x16x32_bf16 v[152:155], a[252:255], a[200:203], v[152:155]
  v_mfma_f32_16x16x32_bf16 v[156:159], a[252:255], a[204:207], v[156:159]
  s_waitcnt vmcnt(22) lgkmcnt(0)
  s_barrier
  v_add_u32 v2, 36864, v6
  v_xor_b32 v3, 32, v2
  v_mfma_f32_16x16x32_bf16 v[128:131], a[240:243], a[64:67], v[128:131]
  ds_read_b64_tr_b16 a[248:249], v2 offset:0
  ds_read_b64_tr_b16 a[250:251], v2 offset:512
  v_mfma_f32_16x16x32_bf16 v[132:135], a[240:243], a[68:71], v[132:135]
  ds_read_b64_tr_b16 a[252:253], v3 offset:0
  ds_read_b64_tr_b16 a[254:255], v3 offset:512
  v_mfma_f32_16x16x32_bf16 v[136:139], a[240:243], a[208:211], v[136:139]
  v_rcp_f32 v16, v16
  v_mfma_f32_16x16x32_bf16 v[140:143], a[240:243], a[212:215], v[140:143]
  v_mul_f32 v112, v112, v16
  v_mul_f32 v16, 0xbfb8aa3b, v120
  v_mfma_f32_16x16x32_bf16 v[144:147], a[244:247], a[64:67], v[144:147]
  ds_read_b64_tr_b16 a[240:241], v2 offset:4096
  ds_read_b64_tr_b16 a[242:243], v2 offset:4608
  v_mfma_f32_16x16x32_bf16 v[148:151], a[244:247], a[68:71], v[148:151]
  buffer_atomic_or v13, v10, s[28:31], 0 offen
  v_mfma_f32_16x16x32_bf16 v[152:155], a[244:247], a[208:211], v[152:155]
  v_exp_f32 v17, v17
  v_mfma_f32_16x16x32_bf16 v[156:159], a[244:247], a[212:215], v[156:159]
  v_add_f32 v17, 1.0, v17
  s_waitcnt lgkmcnt(2)
  v_mfma_f32_16x16x32_bf16 v[128:131], a[248:251], a[72:75], v[128:131]
  ds_read_b64_tr_b16 a[244:245], v3 offset:4096
  ds_read_b64_tr_b16 a[246:247], v3 offset:4608
  v_mfma_f32_16x16x32_bf16 v[132:135], a[248:251], a[76:79], v[132:135]
  v_rcp_f32 v17, v17
  v_mfma_f32_16x16x32_bf16 v[136:139], a[248:251], a[216:219], v[136:139]
  s_add_u32 s65, s52, 256
  s_add_u32 m0, s63, 0
  v_mfma_f32_16x16x32_bf16 v[140:143], a[248:251], a[220:223], v[140:143]
  v_mul_f32 v113, v113, v17
  v_mul_f32 v17, 0xbfb8aa3b, v121
  v_mfma_f32_16x16x32_bf16 v[144:147], a[252:255], a[72:75], v[144:147]
  ds_read_b64_tr_b16 a[248:249], v2 offset:8192
  ds_read_b64_tr_b16 a[250:251], v2 offset:8704
  v_mfma_f32_16x16x32_bf16 v[148:151], a[252:255], a[76:79], v[148:151]
  buffer_load_dwordx4 v240, s[8:11], s65 offen lds
  v_mfma_f32_16x16x32_bf16 v[152:155], a[252:255], a[216:219], v[152:155]
  v_exp_f32 v18, v18
  v_mfma_f32_16x16x32_bf16 v[156:159], a[252:255], a[220:223], v[156:159]
  v_add_f32 v18, 1.0, v18
  s_waitcnt lgkmcnt(2)
  v_mfma_f32_16x16x32_bf16 v[128:131], a[240:243], a[80:83], v[128:131]
  ds_read_b64_tr_b16 a[252:253], v3 offset:8192
  ds_read_b64_tr_b16 a[254:255], v3 offset:8704
  v_mfma_f32_16x16x32_bf16 v[132:135], a[240:243], a[84:87], v[132:135]
  buffer_load_dwordx4 v241, s[8:11], s65 offen offset:1024 lds
  v_mfma_f32_16x16x32_bf16 v[136:139], a[240:243], a[224:227], v[136:139]
  v_rcp_f32 v18, v18
  v_mfma_f32_16x16x32_bf16 v[140:143], a[240:243], a[228:231], v[140:143]
  v_mul_f32 v114, v114, v18
  v_mul_f32 v18, 0xbfb8aa3b, v122
  v_mfma_f32_16x16x32_bf16 v[144:147], a[244:247], a[80:83], v[144:147]
  ds_read_b64_tr_b16 a[240:241], v2 offset:12288
  ds_read_b64_tr_b16 a[242:243], v2 offset:12800
  v_mfma_f32_16x16x32_bf16 v[148:151], a[244:247], a[84:87], v[148:151]
  buffer_load_dwordx4 v242, s[8:11], s65 offen offset:2048 lds
  v_mfma_f32_16x16x32_bf16 v[152:155], a[244:247], a[224:227], v[152:155]
  v_exp_f32 v19, v19
  v_mfma_f32_16x16x32_bf16 v[156:159], a[244:247], a[228:231], v[156:159]
  v_add_f32 v19, 1.0, v19
  s_waitcnt lgkmcnt(2)
  v_mfma_f32_16x16x32_bf16 v[128:131], a[248:251], a[88:91], v[128:131]
  ds_read_b64_tr_b16 a[244:245], v3 offset:12288
  ds_read_b64_tr_b16 a[246:247], v3 offset:12800
  v_mfma_f32_16x16x32_bf16 v[132:135], a[248:251], a[92:95], v[132:135]
  buffer_load_dwordx4 v243, s[8:11], s65 offen offset:3072 lds
  v_mfma_f32_16x16x32_bf16 v[136:139], a[248:251], a[232:235], v[136:139]
  v_rcp_f32 v19, v19
  v_mfma_f32_16x16x32_bf16 v[140:143], a[248:251], a[236:239], v[140:143]
  v_mul_f32 v115, v115, v19
  v_mul_f32 v19, 0xbfb8aa3b, v123
  v_mfma_f32_16x16x32_bf16 v[144:147], a[252:255], a[88:91], v[144:147]
  ds_read_b64_tr_b16 a[248:249], v2 offset:16384
  ds_read_b64_tr_b16 a[250:251], v2 offset:16896
  v_mfma_f32_16x16x32_bf16 v[148:151], a[252:255], a[92:95], v[148:151]
  s_add_u32 s66, s52, 1179904
  s_add_u32 m0, s63, 16384
  v_mfma_f32_16x16x32_bf16 v[152:155], a[252:255], a[232:235], v[152:155]
  buffer_load_dwordx4 v240, s[8:11], s66 offen lds
  v_mfma_f32_16x16x32_bf16 v[156:159], a[252:255], a[236:239], v[156:159]
  v_exp_f32 v20, v20
  s_waitcnt lgkmcnt(2)
  v_mfma_f32_16x16x32_bf16 v[128:131], a[240:243], a[96:99], v[128:131]
  ds_read_b64_tr_b16 a[252:253], v3 offset:16384
  ds_read_b64_tr_b16 a[254:255], v3 offset:16896
  v_mfma_f32_16x16x32_bf16 v[132:135], a[240:243], a[100:103], v[132:135]
  v_add_f32 v20, 1.0, v20
  v_mfma_f32_16x16x32_bf16 v[136:139], a[240:243], v[192:195], v[136:139]
  buffer_load_dwordx4 v241, s[8:11], s66 offen offset:1024 lds
  v_mfma_f32_16x16x32_bf16 v[140:143], a[240:243], v[196:199], v[140:143]
  v_rcp_f32 v20, v20
  v_mfma_f32_16x16x32_bf16 v[144:147], a[244:247], a[96:99], v[144:147]
  ds_read_b64_tr_b16 a[240:241], v2 offset:20480
  ds_read_b64_tr_b16 a[242:243], v2 offset:20992
  v_mfma_f32_16x16x32_bf16 v[148:151], a[244:247], a[100:103], v[148:151]
  v_mul_f32 v116, v116, v20
  v_mul_f32 v20, 0xbfb8aa3b, v124
  v_mfma_f32_16x16x32_bf16 v[152:155], a[244:247], v[192:195], v[152:155]
  buffer_load_dwordx4 v242, s[8:11], s66 offen offset:2048 lds
  v_mfma_f32_16x16x32_bf16 v[156:159], a[244:247], v[196:199], v[156:159]
  v_exp_f32 v21, v21
  s_waitcnt lgkmcnt(2)
  v_mfma_f32_16x16x32_bf16 v[128:131], a[248:251], a[104:107], v[128:131]
  ds_read_b64_tr_b16 a[244:245], v3 offset:20480
  ds_read_b64_tr_b16 a[246:247], v3 offset:20992
  v_mfma_f32_16x16x32_bf16 v[132:135], a[248:251], a[108:111], v[132:135]
  v_add_f32 v21, 1.0, v21
  v_mfma_f32_16x16x32_bf16 v[136:139], a[248:251], v[200:203], v[136:139]
  buffer_load_dwordx4 v243, s[8:11], s66 offen offset:3072 lds
  v_mfma_f32_16x16x32_bf16 v[140:143], a[248:251], v[204:207], v[140:143]
  v_rcp_f32 v21, v21
  v_mfma_f32_16x16x32_bf16 v[144:147], a[252:255], a[104:107], v[144:147]
  ds_read_b64_tr_b16 a[248:249], v2 offset:24576
  ds_read_b64_tr_b16 a[250:251], v2 offset:25088
  v_mfma_f32_16x16x32_bf16 v[148:151], a[252:255], a[108:111], v[148:151]
  v_mul_f32 v117, v117, v21
  v_mul_f32 v21, 0xbfb8aa3b, v125
  v_mfma_f32_16x16x32_bf16 v[152:155], a[252:255], v[200:203], v[152:155]
  s_add_u32 s67, s53, 256
  s_add_u32 m0, s64, 0
  v_mfma_f32_16x16x32_bf16 v[156:159], a[252:255], v[204:207], v[156:159]
  v_exp_f32 v22, v22
  s_waitcnt lgkmcnt(2)
  v_mfma_f32_16x16x32_bf16 v[128:131], a[240:243], a[112:115], v[128:131]
  ds_read_b64_tr_b16 a[252:253], v3 offset:24576
  ds_read_b64_tr_b16 a[254:255], v3 offset:25088
  v_mfma_f32_16x16x32_bf16 v[132:135], a[240:243], a[116:119], v[132:135]
  buffer_load_dwordx4 v11, s[8:11], s67 offen lds
  v_add_f32 v22, 1.0, v22
  v_mfma_f32_16x16x32_bf16 v[136:139], a[240:243], v[208:211], v[136:139]
  v_rcp_f32 v22, v22
  v_mfma_f32_16x16x32_bf16 v[140:143], a[240:243], v[212:215], v[140:143]
  v_mul_f32 v118, v118, v22
  v_mul_f32 v22, 0xbfb8aa3b, v126
  v_mfma_f32_16x16x32_bf16 v[144:147], a[244:247], a[112:115], v[144:147]
  ds_read_b64_tr_b16 a[240:241], v2 offset:28672
  ds_read_b64_tr_b16 a[242:243], v2 offset:29184
  v_mfma_f32_16x16x32_bf16 v[148:151], a[244:247], a[116:119], v[148:151]
  s_add_u32 s5, s75, 384
  buffer_load_dword v95, v14, s[12:15], s5 offen
  v_mfma_f32_16x16x32_bf16 v[152:155], a[244:247], v[208:211], v[152:155]
  v_exp_f32 v23, v23
  v_mfma_f32_16x16x32_bf16 v[156:159], a[244:247], v[212:215], v[156:159]
  v_add_f32 v23, 1.0, v23
  v_mul_f32 v96, v96, v160
  s_waitcnt lgkmcnt(2)
  v_mfma_f32_16x16x32_bf16 v[128:131], a[248:251], a[120:123], v[128:131]
  ds_read_b64_tr_b16 a[244:245], v3 offset:28672
  ds_read_b64_tr_b16 a[246:247], v3 offset:29184
  v_mfma_f32_16x16x32_bf16 v[132:135], a[248:251], a[124:127], v[132:135]
  s_add_u32 s5, s75, 2654592
  buffer_load_dword v95, v14, s[12:15], s5 offen
  v_mfma_f32_16x16x32_bf16 v[136:139], a[248:251], v[216:219], v[136:139]
  v_rcp_f32 v23, v23
  v_mfma_f32_16x16x32_bf16 v[140:143], a[248:251], v[220:223], v[140:143]
  v_mul_f32 v119, v119, v23
  v_mul_f32 v23, 0xbfb8aa3b, v127
  v_mfma_f32_16x16x32_bf16 v[144:147], a[252:255], a[120:123], v[144:147]
  ds_read_b64_tr_b16 a[248:249], v2 offset:32768
  ds_read_b64_tr_b16 a[250:251], v2 offset:33280
  v_mfma_f32_16x16x32_bf16 v[148:151], a[252:255], a[124:127], v[148:151]
  v_exp_f32 v16, v16
  v_mfma_f32_16x16x32_bf16 v[152:155], a[252:255], v[216:219], v[152:155]
  v_add_f32 v16, 1.0, v16
  v_mul_f32 v97, v97, v161
  v_mfma_f32_16x16x32_bf16 v[156:159], a[252:255], v[220:223], v[156:159]
  v_rcp_f32 v16, v16
  s_waitcnt lgkmcnt(2)
  v_mfma_f32_16x16x32_bf16 v[128:131], a[240:243], a[128:131], v[128:131]
  ds_read_b64_tr_b16 a[252:253], v3 offset:32768
  ds_read_b64_tr_b16 a[254:255], v3 offset:33280
  v_mfma_f32_16x16x32_bf16 v[132:135], a[240:243], a[132:135], v[132:135]
  v_mul_f32 v120, v120, v16
  v_cvt_pk_bf16_f32 v24, v96, v97
  v_mfma_f32_16x16x32_bf16 v[136:139], a[240:243], v[224:227], v[136:139]
  v_exp_f32 v17, v17
  v_mfma_f32_16x16x32_bf16 v[140:143], a[240:243], v[228:231], v[140:143]
  v_add_f32 v17, 1.0, v17
  v_mul_f32 v98, v98, v162
  v_mfma_f32_16x16x32_bf16 v[144:147], a[244:247], a[128:131], v[144:147]
  v_rcp_f32 v17, v17
  v_mfma_f32_16x16x32_bf16 v[148:151], a[244:247], a[132:135], v[148:151]
  v_mul_f32 v121, v121, v17
  v_mul_f32 v99, v99, v163
  v_mfma_f32_16x16x32_bf16 v[152:155], a[244:247], v[224:227], v[152:155]
  v_mfma_f32_16x16x32_bf16 v[156:159], a[244:247], v[228:231], v[156:159]
  s_waitcnt vmcnt(23) lgkmcnt(0)
  s_barrier
  v_add_u32 v2, 73728, v6
  v_xor_b32 v3, 32, v2
  v_mfma_f32_16x16x32_bf16 v[128:131], a[248:251], a[136:139], v[128:131]
  ds_read_b64_tr_b16 a[240:241], v2 offset:0
  ds_read_b64_tr_b16 a[242:243], v2 offset:512
  v_mfma_f32_16x16x32_bf16 v[132:135], a[248:251], a[140:143], v[132:135]
  ds_read_b64_tr_b16 a[244:245], v3 offset:0
  ds_read_b64_tr_b16 a[246:247], v3 offset:512
  v_mfma_f32_16x16x32_bf16 v[136:139], a[248:251], v[232:235], v[136:139]
  v_exp_f32 v18, v18
  v_mfma_f32_16x16x32_bf16 v[140:143], a[248:251], v[236:239], v[140:143]
  v_add_f32 v18, 1.0, v18
  v_cvt_pk_bf16_f32 v25, v98, v99
  v_mfma_f32_16x16x32_bf16 v[144:147], a[252:255], a[136:139], v[144:147]
  ds_read_b64_tr_b16 a[248:249], v2 offset:4096
  ds_read_b64_tr_b16 a[250:251], v2 offset:4608
  v_mfma_f32_16x16x32_bf16 v[148:151], a[252:255], a[140:143], v[148:151]
  v_rcp_f32 v18, v18
  v_mfma_f32_16x16x32_bf16 v[152:155], a[252:255], v[232:235], v[152:155]
  v_mul_f32 v122, v122, v18
  v_mul_f32 v112, v112, v176
  v_mfma_f32_16x16x32_bf16 v[156:159], a[252:255], v[236:239], v[156:159]
  v_exp_f32 v19, v19
  v_mul_f32 v118, v118, v182
  v_mul_f32 v119, v119, v183
  v_mul_f32 v116, v116, v180
  v_mul_f32 v117, v117, v181
  v_mul_f32 v102, v102, v166
  v_mul_f32 v103, v103, v167
  v_mul_f32 v100, v100, v164
  v_mul_f32 v101, v101, v165
  v_cvt_pk_bf16_f32 v28, v100, v101
  v_cvt_pk_bf16_f32 v29, v102, v103
  v_cvt_pk_bf16_f32 v30, v116, v117
  v_mul_f32 v114, v114, v178
  v_mul_f32 v115, v115, v179
  v_mul_f32 v113, v113, v177
  v_cvt_pk_bf16_f32 v26, v112, v113
  v_cvt_pk_bf16_f32 v27, v114, v115
  v_cvt_pk_bf16_f32 v31, v118, v119
  v_exp_f32 v22, v22
  s_nop 0
  v_add_f32 v22, 1.0, v22
  v_rcp_f32 v22, v22
  s_nop 0
  v_mul_f32 v126, v126, v22
  v_mul_f32 v126, v126, v190
  v_exp_f32 v23, v23
  s_nop 0
  v_add_f32 v23, 1.0, v23
  v_rcp_f32 v23, v23
  s_nop 0
  v_mul_f32 v127, v127, v23
  v_mul_f32 v127, v127, v191
  v_exp_f32 v20, v20
  s_nop 0
  v_add_f32 v20, 1.0, v20
  v_rcp_f32 v20, v20
  s_nop 0
  v_mul_f32 v124, v124, v20
  v_mul_f32 v124, v124, v188
  v_exp_f32 v21, v21
  s_nop 0
  v_add_f32 v21, 1.0, v21
  v_rcp_f32 v21, v21
  s_nop 0
  v_mul_f32 v125, v125, v21
  v_mul_f32 v125, v125, v189
  v_mul_f32 v110, v110, v174
  v_mul_f32 v111, v111, v175
  v_mul_f32 v108, v108, v172
  v_mul_f32 v109, v109, v173
  v_cvt_pk_bf16_f32 v108, v108, v109
  v_cvt_pk_bf16_f32 v109, v110, v111
  v_cvt_pk_bf16_f32 v110, v124, v125
  v_cvt_pk_bf16_f32 v111, v126, v127
  v_mul_f32 v122, v122, v186
  v_add_f32 v19, 1.0, v19
  v_rcp_f32 v19, v19
  s_nop 0
  v_mul_f32 v123, v123, v19
  v_mul_f32 v123, v123, v187
  v_mul_f32 v120, v120, v184
  v_mul_f32 v121, v121, v185
  v_mul_f32 v106, v106, v170
  v_mul_f32 v107, v107, v171
  v_mul_f32 v104, v104, v168
  v_mul_f32 v105, v105, v169
  v_cvt_pk_bf16_f32 v104, v104, v105
  v_cvt_pk_bf16_f32 v105, v106, v107
  v_cvt_pk_bf16_f32 v106, v120, v121
  v_cvt_pk_bf16_f32 v107, v122, v123
  ds_write_b128 v4, v[104:107] offset:0
  ds_write_b128 v4, v[108:111] offset:1024
  s_waitcnt lgkmcnt(4)
  v_mfma_f32_16x16x32_bf16 v[160:163], a[240:243], a[0:3], 0
  ds_read_b64_tr_b16 a[252:253], v3 offset:4096
  ds_read_b64_tr_b16 a[254:255], v3 offset:4608
  v_mfma_f32_16x16x32_bf16 v[164:167], a[240:243], a[4:7], 0
  v_mfma_f32_16x16x32_bf16 v[168:171], a[240:243], a[144:147], 0
  s_add_u32 s65, s52, 2654464
  s_add_u32 m0, s63, 36864
  v_mfma_f32_16x16x32_bf16 v[172:175], a[240:243], a[148:151], 0
  v_mfma_f32_16x16x32_bf16 v[176:179], a[244:247], a[0:3], 0
  ds_read_b64_tr_b16 a[240:241], v2 offset:8192
  ds_read_b64_tr_b16 a[242:243], v2 offset:8704
  v_mfma_f32_16x16x32_bf16 v[180:183], a[244:247], a[4:7], 0
  buffer_load_dwordx4 v240, s[8:11], s65 offen lds
  v_mfma_f32_16x16x32_bf16 v[184:187], a[244:247], a[144:147], 0
  v_mul_f32 v16, 0xbfb8aa3b, v128
  v_mul_f32 v17, 0xbfb8aa3b, v129
  v_mfma_f32_16x16x32_bf16 v[188:191], a[244:247], a[148:151], 0
  v_exp_f32 v16, v16
  s_waitcnt lgkmcnt(2)
  v_mfma_f32_16x16x32_bf16 v[160:163], a[248:251], a[8:11], v[160:163]
  ds_read_b64_tr_b16 a[244:245], v3 offset:8192
  ds_read_b64_tr_b16 a[246:247], v3 offset:8704
  v_mfma_f32_16x16x32_bf16 v[164:167], a[248:251], a[12:15], v[164:167]
  buffer_load_dwordx4 v241, s[8:11], s65 offen offset:1024 lds
  v_add_f32 v16, 1.0, v16
  v_mfma_f32_16x16x32_bf16 v[168:171], a[248:251], a[152:155], v[168:171]
  v_rcp_f32 v16, v16
  v_mfma_f32_16x16x32_bf16 v[172:175], a[248:251], a[156:159], v[172:175]
  v_mul_f32 v128, v128, v16
  v_mul_f32 v18, 0xbfb8aa3b, v130
  v_mfma_f32_16x16x32_bf16 v[176:179], a[252:255], a[8:11], v[176:179]
  ds_read_b64_tr_b16 a[248:249], v2 offset:12288
  ds_read_b64_tr_b16 a[250:251], v2 offset:12800
  v_mfma_f32_16x16x32_bf16 v[180:183], a[252:255], a[12:15], v[180:183]
  buffer_load_dwordx4 v242, s[8:11], s65 offen offset:2048 lds
  v_mul_f32 v19, 0xbfb8aa3b, v131
  v_mfma_f32_16x16x32_bf16 v[184:187], a[252:255], a[152:155], v[184:187]
  v_exp_f32 v17, v17
  v_mfma_f32_16x16x32_bf16 v[188:191], a[252:255], a[156:159], v[188:191]
  v_add_f32 v17, 1.0, v17
  v_mul_f32 v20, 0xbfb8aa3b, v132
  s_waitcnt lgkmcnt(2)
  v_mfma_f32_16x16x32_bf16 v[160:163], a[240:243], a[16:19], v[160:163]
  ds_read_b64_tr_b16 a[252:253], v3 offset:12288
  ds_read_b64_tr_b16 a[254:255], v3 offset:12800
  v_mfma_f32_16x16x32_bf16 v[164:167], a[240:243], a[20:23], v[164:167]
  buffer_load_dwordx4 v243, s[8:11], s65 offen offset:3072 lds
  v_mul_f32 v21, 0xbfb8aa3b, v133
  v_mfma_f32_16x16x32_bf16 v[168:171], a[240:243], a[160:163], v[168:171]
  v_rcp_f32 v17, v17
  v_mfma_f32_16x16x32_bf16 v[172:175], a[240:243], a[164:167], v[172:175]
  v_mul_f32 v129, v129, v17
  v_mul_f32 v22, 0xbfb8aa3b, v134
  v_mfma_f32_16x16x32_bf16 v[176:179], a[244:247], a[16:19], v[176:179]
  ds_read_b64_tr_b16 a[240:241], v2 offset:16384
  ds_read_b64_tr_b16 a[242:243], v2 offset:16896
  v_mfma_f32_16x16x32_bf16 v[180:183], a[244:247], a[20:23], v[180:183]
  s_add_u32 s66, s52, 3834112
  s_add_u32 m0, s63, 53248
  v_mfma_f32_16x16x32_bf16 v[184:187], a[244:247], a[160:163], v[184:187]
  buffer_load_dwordx4 v240, s[8:11], s66 offen lds
  v_mul_f32 v23, 0xbfb8aa3b, v135
  v_mfma_f32_16x16x32_bf16 v[188:191], a[244:247], a[164:167], v[188:191]
  v_exp_f32 v18, v18
  s_waitcnt lgkmcnt(2)
  v_mfma_f32_16x16x32_bf16 v[160:163], a[248:251], a[24:27], v[160:163]
  ds_read_b64_tr_b16 a[244:245], v3 offset:16384
  ds_read_b64_tr_b16 a[246:247], v3 offset:16896
  v_mfma_f32_16x16x32_bf16 v[164:167], a[248:251], a[28:31], v[164:167]
  v_add_f32 v18, 1.0, v18
  v_mul_f32 v16, 0xbfb8aa3b, v136
  v_mfma_f32_16x16x32_bf16 v[168:171], a[248:251], a[168:171], v[168:171]
  buffer_load_dwordx4 v241, s[8:11], s66 offen offset:1024 lds
  v_mul_f32 v17, 0xbfb8aa3b, v137
  v_mfma_f32_16x16x32_bf16 v[172:175], a[248:251], a[172:175], v[172:175]
  v_rcp_f32 v18, v18
  v_mfma_f32_16x16x32_bf16 v[176:179], a[252:255], a[24:27], v[176:179]
  ds_read_b64_tr_b16 a[248:249], v2 offset:20480
  ds_read_b64_tr_b16 a[250:251], v2 offset:20992
  v_mfma_f32_16x16x32_bf16 v[180:183], a[252:255], a[28:31], v[180:183]
  v_mul_f32 v130, v130, v18
  v_mul_f32 v18, 0xbfb8aa3b, v138
  v_mfma_f32_16x16x32_bf16 v[184:187], a[252:255], a[168:171], v[184:187]
  buffer_load_dwordx4 v242, s[8:11], s66 offen offset:2048 lds
  v_mfma_f32_16x16x32_bf16 v[188:191], a[252:255], a[172:175], v[188:191]
  v_exp_f32 v19, v19
  s_waitcnt lgkmcnt(2)
  v_mfma_f32_16x16x32_bf16 v[160:163], a[240:243], a[32:35], v[160:163]
  ds_read_b64_tr_b16 a[252:253], v3 offset:20480
  ds_read_b64_tr_b16 a[254:255], v3 offset:20992
  v_mfma_f32_16x16x32_bf16 v[164:167], a[240:243], a[36:39], v[164:167]
  v_add_f32 v19, 1.0, v19
  v_mfma_f32_16x16x32_bf16 v[168:171], a[240:243], a[176:179], v[168:171]
  buffer_load_dwordx4 v243, s[8:11], s66 offen offset:3072 lds
  v_mfma_f32_16x16x32_bf16 v[172:175], a[240:243], a[180:183], v[172:175]
  v_rcp_f32 v19, v19
  v_mfma_f32_16x16x32_bf16 v[176:179], a[244:247], a[32:35], v[176:179]
  ds_read_b64_tr_b16 a[240:241], v2 offset:24576
  ds_read_b64_tr_b16 a[242:243], v2 offset:25088
  v_mfma_f32_16x16x32_bf16 v[180:183], a[244:247], a[36:39], v[180:183]
  v_mul_f32 v131, v131, v19
  v_mul_f32 v19, 0xbfb8aa3b, v139
  v_mfma_f32_16x16x32_bf16 v[184:187], a[244:247], a[176:179], v[184:187]
  s_add_u32 s67, s53, 2654464
  s_add_u32 m0, s64, 36864
  v_mfma_f32_16x16x32_bf16 v[188:191], a[244:247], a[180:183], v[188:191]
  v_exp_f32 v20, v20
  s_waitcnt lgkmcnt(2)
  v_mfma_f32_16x16x32_bf16 v[160:163], a[248:251], a[40:43], v[160:163]
  ds_read_b64_tr_b16 a[244:245], v3 offset:24576
  ds_read_b64_tr_b16 a[246:247], v3 offset:25088
  v_mfma_f32_16x16x32_bf16 v[164:167], a[248:251], a[44:47], v[164:167]
  buffer_load_dwordx4 v11, s[8:11], s67 offen lds
  v_add_f32 v20, 1.0, v20
  v_mfma_f32_16x16x32_bf16 v[168:171], a[248:251], a[184:187], v[168:171]
  v_rcp_f32 v20, v20
  v_mfma_f32_16x16x32_bf16 v[172:175], a[248:251], a[188:191], v[172:175]
  v_mul_f32 v132, v132, v20
  v_mul_f32 v20, 0xbfb8aa3b, v140
  v_mfma_f32_16x16x32_bf16 v[176:179], a[252:255], a[40:43], v[176:179]
  ds_read_b64_tr_b16 a[248:249], v2 offset:28672
  ds_read_b64_tr_b16 a[250:251], v2 offset:29184
  s_add_u32 s5, s76, 0
  v_mfma_f32_16x16x32_bf16 v[180:183], a[252:255], a[44:47], v[180:183]
  buffer_load_dword v95, v14, s[8:11], s5 offen
  s_add_u32 s5, s76, 2654208
  buffer_load_dword v95, v14, s[8:11], s5 offen
  v_mfma_f32_16x16x32_bf16 v[184:187], a[252:255], a[184:187], v[184:187]
  v_exp_f32 v21, v21
  v_mfma_f32_16x16x32_bf16 v[188:191], a[252:255], a[188:191], v[188:191]
  v_add_f32 v21, 1.0, v21
  s_waitcnt lgkmcnt(2)
  v_mfma_f32_16x16x32_bf16 v[160:163], a[240:243], a[48:51], v[160:163]
  ds_read_b64_tr_b16 a[252:253], v3 offset:28672
  ds_read_b64_tr_b16 a[254:255], v3 offset:29184
  s_add_u32 s5, s76, 0
  v_mfma_f32_16x16x32_bf16 v[164:167], a[240:243], a[52:55], v[164:167]
  buffer_load_dword v95, v14, s[12:15], s5 offen
  s_add_u32 s5, s76, 2654208
  buffer_load_dword v95, v14, s[12:15], s5 offen
  v_mfma_f32_16x16x32_bf16 v[168:171], a[240:243], a[192:195], v[168:171]
  v_rcp_f32 v21, v21
  v_mfma_f32_16x16x32_bf16 v[172:175], a[240:243], a[196:199], v[172:175]
  v_mul_f32 v133, v133, v21
  v_mul_f32 v21, 0xbfb8aa3b, v141
  v_mfma_f32_16x16x32_bf16 v[176:179], a[244:247], a[48:51], v[176:179]
  ds_read_b64_tr_b16 a[240:241], v2 offset:32768
  ds_read_b64_tr_b16 a[242:243], v2 offset:33280
  v_mfma_f32_16x16x32_bf16 v[180:183], a[244:247], a[52:55], v[180:183]
  v_exp_f32 v22, v22
  v_mfma_f32_16x16x32_bf16 v[184:187], a[244:247], a[192:195], v[184:187]
  v_add_f32 v22, 1.0, v22
  v_mfma_f32_16x16x32_bf16 v[188:191], a[244:247], a[196:199], v[188:191]
  v_rcp_f32 v22, v22
  s_waitcnt lgkmcnt(2)
  v_mfma_f32_16x16x32_bf16 v[160:163], a[248:251], a[56:59], v[160:163]
  ds_read_b64_tr_b16 a[244:245], v3 offset:32768
  ds_read_b64_tr_b16 a[246:247], v3 offset:33280
  v_mfma_f32_16x16x32_bf16 v[164:167], a[248:251], a[60:63], v[164:167]
  v_mul_f32 v134, v134, v22
  v_mul_f32 v22, 0xbfb8aa3b, v142
  v_mfma_f32_16x16x32_bf16 v[168:171], a[248:251], a[200:203], v[168:171]
  v_exp_f32 v23, v23
  v_mfma_f32_16x16x32_bf16 v[172:175], a[248:251], a[204:207], v[172:175]
  v_add_f32 v23, 1.0, v23
  v_mfma_f32_16x16x32_bf16 v[176:179], a[252:255], a[56:59], v[176:179]
  v_rcp_f32 v23, v23
  v_mfma_f32_16x16x32_bf16 v[180:183], a[252:255], a[60:63], v[180:183]
  v_mul_f32 v135, v135, v23
  v_mul_f32 v23, 0xbfb8aa3b, v143
  v_mfma_f32_16x16x32_bf16 v[184:187], a[252:255], a[200:203], v[184:187]
  v_mfma_f32_16x16x32_bf16 v[188:191], a[252:255], a[204:207], v[188:191]
  s_waitcnt vmcnt(27) lgkmcnt(0)
  s_barrier
  ds_read_b128 v[32:35], v5 offset:0
  ds_read_b128 v[36:39], v5 offset:1024
  v_add_u32 v2, 110592, v6
  v_xor_b32 v3, 32, v2
  v_mfma_f32_16x16x32_bf16 v[160:163], a[240:243], a[64:67], v[160:163]
  ds_read_b64_tr_b16 a[248:249], v2 offset:0
  ds_read_b64_tr_b16 a[250:251], v2 offset:512
  v_mfma_f32_16x16x32_bf16 v[164:167], a[240:243], a[68:71], v[164:167]
  ds_read_b64_tr_b16 a[252:253], v3 offset:0
  ds_read_b64_tr_b16 a[254:255], v3 offset:512
  v_mfma_f32_16x16x32_bf16 v[168:171], a[240:243], a[208:211], v[168:171]
  v_exp_f32 v16, v16
  v_mfma_f32_16x16x32_bf16 v[172:175], a[240:243], a[212:215], v[172:175]
  v_add_f32 v16, 1.0, v16
  v_mfma_f32_16x16x32_bf16 v[176:179], a[244:247], a[64:67], v[176:179]
  ds_read_b64_tr_b16 a[240:241], v2 offset:4096
  ds_read_b64_tr_b16 a[242:243], v2 offset:4608
  v_mfma_f32_16x16x32_bf16 v[180:183], a[244:247], a[68:71], v[180:183]
  v_rcp_f32 v16, v16
  v_mfma_f32_16x16x32_bf16 v[184:187], a[244:247], a[208:211], v[184:187]
  v_mul_f32 v136, v136, v16
  v_mul_f32 v16, 0xbfb8aa3b, v144
  v_mfma_f32_16x16x32_bf16 v[188:191], a[244:247], a[212:215], v[188:191]
  v_exp_f32 v17, v17
  s_waitcnt lgkmcnt(2)
  v_mfma_f32_16x16x32_bf16 v[160:163], a[248:251], a[72:75], v[160:163]
  ds_read_b64_tr_b16 a[244:245], v3 offset:4096
  ds_read_b64_tr_b16 a[246:247], v3 offset:4608
  v_mfma_f32_16x16x32_bf16 v[164:167], a[248:251], a[76:79], v[164:167]
  v_add_f32 v17, 1.0, v17
  v_mfma_f32_16x16x32_bf16 v[168:171], a[248:251], a[216:219], v[168:171]
  s_add_u32 s65, s52, 256
  s_add_u32 m0, s63, 73728
  v_mfma_f32_16x16x32_bf16 v[172:175], a[248:251], a[220:223], v[172:175]
  v_rcp_f32 v17, v17
  v_mfma_f32_16x16x32_bf16 v[176:179], a[252:255], a[72:75], v[176:179]
  ds_read_b64_tr_b16 a[248:249], v2 offset:8192
  ds_read_b64_tr_b16 a[250:251], v2 offset:8704
  v_mfma_f32_16x16x32_bf16 v[180:183], a[252:255], a[76:79], v[180:183]
  buffer_load_dwordx4 v240, s[12:15], s65 offen lds
  v_mul_f32 v137, v137, v17
  s_waitcnt lgkmcnt(10)
  s_bitcmp1_b32 s48, 0
  s_cbranch_scc0 K1_nosw0
  v_swap_b32 v24, v32
  v_swap_b32 v25, v33
  v_swap_b32 v26, v34
  v_swap_b32 v27, v35
  v_swap_b32 v28, v36
  v_swap_b32 v29, v37
  v_swap_b32 v30, v38
  v_swap_b32 v31, v39
K1_nosw0:
  v_mfma_f32_16x16x32_bf16 v[184:187], a[252:255], a[216:219], v[184:187]
  v_exp_f32 v18, v18
  v_mfma_f32_16x16x32_bf16 v[188:191], a[252:255], a[220:223], v[188:191]
  v_add_f32 v18, 1.0, v18
  v_mul_f32 v17, 0xbfb8aa3b, v145
  s_waitcnt lgkmcnt(2)
  v_mfma_f32_16x16x32_bf16 v[160:163], a[240:243], a[80:83], v[160:163]
  ds_read_b64_tr_b16 a[252:253], v3 offset:8192
  ds_read_b64_tr_b16 a[254:255], v3 offset:8704
  v_mfma_f32_16x16x32_bf16 v[164:167], a[240:243], a[84:87], v[164:167]
  buffer_load_dwordx4 v241, s[12:15], s65 offen offset:1024 lds
  v_mfma_f32_16x16x32_bf16 v[168:171], a[240:243], a[224:227], v[168:171]
  v_rcp_f32 v18, v18
  v_mfma_f32_16x16x32_bf16 v[172:175], a[240:243], a[228:231], v[172:175]
  v_mul_f32 v138, v138, v18
  v_mul_f32 v18, 0xbfb8aa3b, v146
  v_mfma_f32_16x16x32_bf16 v[176:179], a[244:247], a[80:83], v[176:179]
  ds_read_b64_tr_b16 a[240:241], v2 offset:12288
  ds_read_b64_tr_b16 a[242:243], v2 offset:12800
  v_mfma_f32_16x16x32_bf16 v[180:183], a[244:247], a[84:87], v[180:183]
  buffer_load_dwordx4 v242, s[12:15], s65 offen offset:2048 lds
  v_mfma_f32_16x16x32_bf16 v[184:187], a[244:247], a[224:227], v[184:187]
  v_exp_f32 v19, v19
  v_mfma_f32_16x16x32_bf16 v[188:191], a[244:247], a[228:231], v[188:191]
  v_add_f32 v19, 1.0, v19
  s_waitcnt lgkmcnt(2)
  v_mfma_f32_16x16x32_bf16 v[160:163], a[248:251], a[88:91], v[160:163]
  ds_read_b64_tr_b16 a[244:245], v3 offset:12288
  ds_read_b64_tr_b16 a[246:247], v3 offset:12800
  v_mfma_f32_16x16x32_bf16 v[164:167], a[248:251], a[92:95], v[164:167]
  buffer_load_dwordx4 v243, s[12:15], s65 offen offset:3072 lds
  v_mfma_f32_16x16x32_bf16 v[168:171], a[248:251], a[232:235], v[168:171]
  v_rcp_f32 v19, v19
  v_mfma_f32_16x16x32_bf16 v[172:175], a[248:251], a[236:239], v[172:175]
  v_mul_f32 v139, v139, v19
  v_mul_f32 v19, 0xbfb8aa3b, v147
  v_mfma_f32_16x16x32_bf16 v[176:179], a[252:255], a[88:91], v[176:179]
  ds_read_b64_tr_b16 a[248:249], v2 offset:16384
  ds_read_b64_tr_b16 a[250:251], v2 offset:16896
  v_mfma_f32_16x16x32_bf16 v[180:183], a[252:255], a[92:95], v[180:183]
  s_add_u32 s66, s52, 1179904
  s_add_u32 m0, s63, 90112
  v_mfma_f32_16x16x32_bf16 v[184:187], a[252:255], a[232:235], v[184:187]
  buffer_load_dwordx4 v240, s[12:15], s66 offen lds
  v_mfma_f32_16x16x32_bf16 v[188:191], a[252:255], a[236:239], v[188:191]
  v_exp_f32 v20, v20
  s_waitcnt lgkmcnt(2)
  v_mfma_f32_16x16x32_bf16 v[160:163], a[240:243], a[96:99], v[160:163]
  ds_read_b64_tr_b16 a[252:253], v3 offset:16384
  ds_read_b64_tr_b16 a[254:255], v3 offset:16896
  v_mfma_f32_16x16x32_bf16 v[164:167], a[240:243], a[100:103], v[164:167]
  v_add_f32 v20, 1.0, v20
  v_mfma_f32_16x16x32_bf16 v[168:171], a[240:243], v[192:195], v[168:171]
  buffer_load_dwordx4 v241, s[12:15], s66 offen offset:1024 lds
  v_mfma_f32_16x16x32_bf16 v[172:175], a[240:243], v[196:199], v[172:175]
  v_rcp_f32 v20, v20
  v_mfma_f32_16x16x32_bf16 v[176:179], a[244:247], a[96:99], v[176:179]
  ds_read_b64_tr_b16 a[240:241], v2 offset:20480
  ds_read_b64_tr_b16 a[242:243], v2 offset:20992
  v_mfma_f32_16x16x32_bf16 v[180:183], a[244:247], a[100:103], v[180:183]
  v_mul_f32 v140, v140, v20
  v_mul_f32 v20, 0xbfb8aa3b, v148
  v_mfma_f32_16x16x32_bf16 v[184:187], a[244:247], v[192:195], v[184:187]
  buffer_load_dwordx4 v242, s[12:15], s66 offen offset:2048 lds
  v_mfma_f32_16x16x32_bf16 v[188:191], a[244:247], v[196:199], v[188:191]
  v_exp_f32 v21, v21
  s_waitcnt lgkmcnt(2)
  v_mfma_f32_16x16x32_bf16 v[160:163], a[248:251], a[104:107], v[160:163]
  ds_read_b64_tr_b16 a[244:245], v3 offset:20480
  ds_read_b64_tr_b16 a[246:247], v3 offset:20992
  v_mfma_f32_16x16x32_bf16 v[164:167], a[248:251], a[108:111], v[164:167]
  v_add_f32 v21, 1.0, v21
  v_mfma_f32_16x16x32_bf16 v[168:171], a[248:251], v[200:203], v[168:171]
  buffer_load_dwordx4 v243, s[12:15], s66 offen offset:3072 lds
  v_mfma_f32_16x16x32_bf16 v[172:175], a[248:251], v[204:207], v[172:175]
  v_rcp_f32 v21, v21
  v_mfma_f32_16x16x32_bf16 v[176:179], a[252:255], a[104:107], v[176:179]
  ds_read_b64_tr_b16 a[248:249], v2 offset:24576
  ds_read_b64_tr_b16 a[250:251], v2 offset:25088
  v_mfma_f32_16x16x32_bf16 v[180:183], a[252:255], a[108:111], v[180:183]
  v_mul_f32 v141, v141, v21
  v_mul_f32 v21, 0xbfb8aa3b, v149
  v_mfma_f32_16x16x32_bf16 v[184:187], a[252:255], v[200:203], v[184:187]
  s_add_u32 s67, s53, 256
  s_add_u32 m0, s64, 73728
  v_mfma_f32_16x16x32_bf16 v[188:191], a[252:255], v[204:207], v[188:191]
  v_exp_f32 v22, v22
  s_waitcnt lgkmcnt(2)
  v_mfma_f32_16x16x32_bf16 v[160:163], a[240:243], a[112:115], v[160:163]
  ds_read_b64_tr_b16 a[252:253], v3 offset:24576
  ds_read_b64_tr_b16 a[254:255], v3 offset:25088
  v_mfma_f32_16x16x32_bf16 v[164:167], a[240:243], a[116:119], v[164:167]
  buffer_load_dwordx4 v11, s[12:15], s67 offen lds
  v_add_f32 v22, 1.0, v22
  v_mfma_f32_16x16x32_bf16 v[168:171], a[240:243], v[208:211], v[168:171]
  v_rcp_f32 v22, v22
  v_mfma_f32_16x16x32_bf16 v[172:175], a[240:243], v[212:215], v[172:175]
  v_mul_f32 v142, v142, v22
  v_mul_f32 v22, 0xbfb8aa3b, v150
  v_mfma_f32_16x16x32_bf16 v[176:179], a[244:247], a[112:115], v[176:179]
  ds_read_b64_tr_b16 a[240:241], v2 offset:28672
  ds_read_b64_tr_b16 a[242:243], v2 offset:29184
  v_mfma_f32_16x16x32_bf16 v[180:183], a[244:247], a[116:119], v[180:183]
  s_add_u32 s5, s77, 0
  buffer_load_dword v95, v0, s[16:19], s5 offen
  v_mfma_f32_16x16x32_bf16 v[184:187], a[244:247], v[208:211], v[184:187]
  v_exp_f32 v23, v23
  v_mfma_f32_16x16x32_bf16 v[188:191], a[244:247], v[212:215], v[188:191]
  v_add_f32 v23, 1.0, v23
  s_waitcnt lgkmcnt(2)
  v_mfma_f32_16x16x32_bf16 v[160:163], a[248:251], a[120:123], v[160:163]
  ds_read_b64_tr_b16 a[244:245], v3 offset:28672
  ds_read_b64_tr_b16 a[246:247], v3 offset:29184
  v_mfma_f32_16x16x32_bf16 v[164:167], a[248:251], a[124:127], v[164:167]
  s_add_u32 s5, s77, 128
  buffer_load_dword v95, v0, s[16:19], s5 offen
  v_mfma_f32_16x16x32_bf16 v[168:171], a[248:251], v[216:219], v[168:171]
  s_add_u32 s6, s68, 0
  buffer_store_dwordx4 v[24:27], v1, s[24:27], s6 offen offset:0 sc1
  v_mfma_f32_16x16x32_bf16 v[172:175], a[248:251], v[220:223], v[172:175]
  v_rcp_f32 v23, v23
  v_mfma_f32_16x16x32_bf16 v[176:179], a[252:255], a[120:123], v[176:179]
  ds_read_b64_tr_b16 a[248:249], v2 offset:32768
  ds_read_b64_tr_b16 a[250:251], v2 offset:33280
  v_mfma_f32_16x16x32_bf16 v[180:183], a[252:255], a[124:127], v[180:183]
  v_mul_f32 v143, v143, v23
  v_mul_f32 v23, 0xbfb8aa3b, v151
  v_mfma_f32_16x16x32_bf16 v[184:187], a[252:255], v[216:219], v[184:187]
  v_exp_f32 v16, v16
  v_mfma_f32_16x16x32_bf16 v[188:191], a[252:255], v[220:223], v[188:191]
  v_add_f32 v16, 1.0, v16
  s_waitcnt lgkmcnt(2)
  v_mfma_f32_16x16x32_bf16 v[160:163], a[240:243], a[128:131], v[160:163]
  ds_read_b64_tr_b16 a[252:253], v3 offset:32768
  ds_read_b64_tr_b16 a[254:255], v3 offset:33280
  v_mfma_f32_16x16x32_bf16 v[164:167], a[240:243], a[132:135], v[164:167]
  v_rcp_f32 v16, v16
  v_mfma_f32_16x16x32_bf16 v[168:171], a[240:243], v[224:227], v[168:171]
  v_mul_f32 v144, v144, v16
  v_mul_f32 v16, 0xbfb8aa3b, v152
  v_mfma_f32_16x16x32_bf16 v[172:175], a[240:243], v[228:231], v[172:175]
  v_exp_f32 v17, v17
  v_mfma_f32_16x16x32_bf16 v[176:179], a[244:247], a[128:131], v[176:179]
  v_add_f32 v17, 1.0, v17
  v_mfma_f32_16x16x32_bf16 v[180:183], a[244:247], a[132:135], v[180:183]
  v_rcp_f32 v17, v17
  v_mfma_f32_16x16x32_bf16 v[184:187], a[244:247], v[224:227], v[184:187]
  v_mfma_f32_16x16x32_bf16 v[188:191], a[244:247], v[228:231], v[188:191]
  s_waitcnt vmcnt(27) lgkmcnt(0)
  s_barrier
  v_mov_b32 v2, v6
  v_xor_b32 v3, 32, v2
  v_mfma_f32_16x16x32_bf16 v[160:163], a[248:251], a[136:139], v[160:163]
  ds_read_b64_tr_b16 a[240:241], v2 offset:0
  ds_read_b64_tr_b16 a[242:243], v2 offset:512
  v_mfma_f32_16x16x32_bf16 v[164:167], a[248:251], a[140:143], v[164:167]
  ds_read_b64_tr_b16 a[244:245], v3 offset:0
  ds_read_b64_tr_b16 a[246:247], v3 offset:512
  v_mfma_f32_16x16x32_bf16 v[168:171], a[248:251], v[232:235], v[168:171]
  v_mul_f32 v145, v145, v17
  v_mul_f32 v17, 0xbfb8aa3b, v153
  v_mfma_f32_16x16x32_bf16 v[172:175], a[248:251], v[236:239], v[172:175]
  v_exp_f32 v18, v18
  v_mfma_f32_16x16x32_bf16 v[176:179], a[252:255], a[136:139], v[176:179]
  ds_read_b64_tr_b16 a[248:249], v2 offset:4096
  ds_read_b64_tr_b16 a[250:251], v2 offset:4608
  v_mfma_f32_16x16x32_bf16 v[180:183], a[252:255], a[140:143], v[180:183]
  v_add_f32 v18, 1.0, v18
  v_mfma_f32_16x16x32_bf16 v[184:187], a[252:255], v[232:235], v[184:187]
  v_rcp_f32 v18, v18
  v_mfma_f32_16x16x32_bf16 v[188:191], a[252:255], v[236:239], v[188:191]
  v_mul_f32 v146, v146, v18
  v_mul_f32 v18, 0xbfb8aa3b, v154
  s_waitcnt lgkmcnt(2)
  v_mfma_f32_16x16x32_bf16 v[96:99], a[240:243], a[0:3], 0
  ds_read_b64_tr_b16 a[252:253], v3 offset:4096
  ds_read_b64_tr_b16 a[254:255], v3 offset:4608
  v_mfma_f32_16x16x32_bf16 v[100:103], a[240:243], a[4:7], 0
  v_exp_f32 v19, v19
  v_mfma_f32_16x16x32_bf16 v[104:107], a[240:243], a[144:147], 0
  s_add_u32 s65, s52, 2654464
  s_add_u32 m0, s63, 110592
  v_mfma_f32_16x16x32_bf16 v[108:111], a[240:243], a[148:151], 0
  v_add_f32 v19, 1.0, v19
  v_mfma_f32_16x16x32_bf16 v[112:115], a[244:247], a[0:3], 0
  ds_read_b64_tr_b16 a[240:241], v2 offset:8192
  ds_read_b64_tr_b16 a[242:243], v2 offset:8704
  v_mfma_f32_16x16x32_bf16 v[116:119], a[244:247], a[4:7], 0
  buffer_load_dwordx4 v240, s[12:15], s65 offen lds
  v_mfma_f32_16x16x32_bf16 v[120:123], a[244:247], a[144:147], 0
  v_rcp_f32 v19, v19
  v_mfma_f32_16x16x32_bf16 v[124:127], a[244:247], a[148:151], 0
  v_mul_f32 v147, v147, v19
  v_mul_f32 v19, 0xbfb8aa3b, v155
  s_waitcnt lgkmcnt(2)
  v_mfma_f32_16x16x32_bf16 v[96:99], a[248:251], a[8:11], v[96:99]
  ds_read_b64_tr_b16 a[244:245], v3 offset:8192
  ds_read_b64_tr_b16 a[246:247], v3 offset:8704
  v_mfma_f32_16x16x32_bf16 v[100:103], a[248:251], a[12:15], v[100:103]
  buffer_load_dwordx4 v241, s[12:15], s65 offen offset:1024 lds
  v_mfma_f32_16x16x32_bf16 v[104:107], a[248:251], a[152:155], v[104:107]
  v_exp_f32 v20, v20
  v_mfma_f32_16x16x32_bf16 v[108:111], a[248:251], a[156:159], v[108:111]
  v_add_f32 v20, 1.0, v20
  v_mfma_f32_16x16x32_bf16 v[112:115], a[252:255], a[8:11], v[112:115]
  ds_read_b64_tr_b16 a[248:249], v2 offset:12288
  ds_read_b64_tr_b16 a[250:251], v2 offset:12800
  v_mfma_f32_16x16x32_bf16 v[116:119], a[252:255], a[12:15], v[116:119]
  buffer_load_dwordx4 v242, s[12:15], s65 offen offset:2048 lds
  v_mfma_f32_16x16x32_bf16 v[120:123], a[252:255], a[152:155], v[120:123]
  v_rcp_f32 v20, v20
  v_mfma_f32_16x16x32_bf16 v[124:127], a[252:255], a[156:159], v[124:127]
  v_mul_f32 v148, v148, v20
  v_mul_f32 v20, 0xbfb8aa3b, v156
  s_waitcnt lgkmcnt(2)
  v_mfma_f32_16x16x32_bf16 v[96:99], a[240:243], a[16:19], v[96:99]
  ds_read_b64_tr_b16 a[252:253], v3 offset:12288
  ds_read_b64_tr_b16 a[254:255], v3 offset:12800
  v_mfma_f32_16x16x32_bf16 v[100:103], a[240:243], a[20:23], v[100:103]
  buffer_load_dwordx4 v243, s[12:15], s65 offen offset:3072 lds
  v_mfma_f32_16x16x32_bf16 v[104:107], a[240:243], a[160:163], v[104:107]
  v_exp_f32 v21, v21
  v_mfma_f32_16x16x32_bf16 v[108:111], a[240:243], a[164:167], v[108:111]
  v_add_f32 v21, 1.0, v21
  v_mfma_f32_16x16x32_bf16 v[112:115], a[244:247], a[16:19], v[112:115]
  ds_read_b64_tr_b16 a[240:241], v2 offset:16384
  ds_read_b64_tr_b16 a[242:243], v2 offset:16896
  v_mfma_f32_16x16x32_bf16 v[116:119], a[244:247], a[20:23], v[116:119]
  s_add_u32 s66, s52, 3834112
  s_add_u32 m0, s63, 126976
  v_mfma_f32_16x16x32_bf16 v[120:123], a[244:247], a[160:163], v[120:123]
  buffer_load_dwordx4 v240, s[12:15], s66 offen lds
  v_mfma_f32_16x16x32_bf16 v[124:127], a[244:247], a[164:167], v[124:127]
  v_rcp_f32 v21, v21
  s_waitcnt lgkmcnt(2)
  v_mfma_f32_16x16x32_bf16 v[96:99], a[248:251], a[24:27], v[96:99]
  ds_read_b64_tr_b16 a[244:245], v3 offset:16384
  ds_read_b64_tr_b16 a[246:247], v3 offset:16896
  v_mfma_f32_16x16x32_bf16 v[100:103], a[248:251], a[28:31], v[100:103]
  v_mul_f32 v149, v149, v21
  v_mul_f32 v21, 0xbfb8aa3b, v157
  v_mfma_f32_16x16x32_bf16 v[104:107], a[248:251], a[168:171], v[104:107]
  buffer_load_dwordx4 v241, s[12:15], s66 offen offset:1024 lds
  v_mfma_f32_16x16x32_bf16 v[108:111], a[248:251], a[172:175], v[108:111]
  v_exp_f32 v22, v22
  v_mfma_f32_16x16x32_bf16 v[112:115], a[252:255], a[24:27], v[112:115]
  ds_read_b64_tr_b16 a[248:249], v2 offset:20480
  ds_read_b64_tr_b16 a[250:251], v2 offset:20992
  v_mfma_f32_16x16x32_bf16 v[116:119], a[252:255], a[28:31], v[116:119]
  v_add_f32 v22, 1.0, v22
  v_mfma_f32_16x16x32_bf16 v[120:123], a[252:255], a[168:171], v[120:123]
  buffer_load_dwordx4 v242, s[12:15], s66 offen offset:2048 lds
  v_mfma_f32_16x16x32_bf16 v[124:127], a[252:255], a[172:175], v[124:127]
  v_rcp_f32 v22, v22
  s_waitcnt lgkmcnt(2)
  v_mfma_f32_16x16x32_bf16 v[96:99], a[240:243], a[32:35], v[96:99]
  ds_read_b64_tr_b16 a[252:253], v3 offset:20480
  ds_read_b64_tr_b16 a[254:255], v3 offset:20992
  v_mfma_f32_16x16x32_bf16 v[100:103], a[240:243], a[36:39], v[100:103]
  v_mul_f32 v150, v150, v22
  v_mul_f32 v22, 0xbfb8aa3b, v158
  v_mfma_f32_16x16x32_bf16 v[104:107], a[240:243], a[176:179], v[104:107]
  buffer_load_dwordx4 v243, s[12:15], s66 offen offset:3072 lds
  v_mul_f32 v128, v128, v160
  v_mfma_f32_16x16x32_bf16 v[108:111], a[240:243], a[180:183], v[108:111]
  v_exp_f32 v23, v23
  v_mfma_f32_16x16x32_bf16 v[112:115], a[244:247], a[32:35], v[112:115]
  ds_read_b64_tr_b16 a[240:241], v2 offset:24576
  ds_read_b64_tr_b16 a[242:243], v2 offset:25088
  v_mfma_f32_16x16x32_bf16 v[116:119], a[244:247], a[36:39], v[116:119]
  v_add_f32 v23, 1.0, v23
  v_mul_f32 v129, v129, v161
  v_mfma_f32_16x16x32_bf16 v[120:123], a[244:247], a[176:179], v[120:123]
  s_add_u32 s67, s53, 2654464
  s_add_u32 m0, s64, 110592
  v_mfma_f32_16x16x32_bf16 v[124:127], a[244:247], a[180:183], v[124:127]
  v_rcp_f32 v23, v23
  s_waitcnt lgkmcnt(2)
  v_mfma_f32_16x16x32_bf16 v[96:99], a[248:251], a[40:43], v[96:99]
  ds_read_b64_tr_b16 a[244:245], v3 offset:24576
  ds_read_b64_tr_b16 a[246:247], v3 offset:25088
  v_mfma_f32_16x16x32_bf16 v[100:103], a[248:251], a[44:47], v[100:103]
  buffer_load_dwordx4 v11, s[12:15], s67 offen lds
  v_mul_f32 v151, v151, v23
  v_mfma_f32_16x16x32_bf16 v[104:107], a[248:251], a[184:187], v[104:107]
  v_exp_f32 v16, v16
  v_mfma_f32_16x16x32_bf16 v[108:111], a[248:251], a[188:191], v[108:111]
  v_add_f32 v16, 1.0, v16
  v_mul_f32 v23, 0xbfb8aa3b, v159
  v_mfma_f32_16x16x32_bf16 v[112:115], a[252:255], a[40:43], v[112:115]
  ds_read_b64_tr_b16 a[248:249], v2 offset:28672
  ds_read_b64_tr_b16 a[250:251], v2 offset:29184
  v_mfma_f32_16x16x32_bf16 v[116:119], a[252:255], a[44:47], v[116:119]
  s_add_u32 s5, s77, 256
  buffer_load_dword v95, v0, s[16:19], s5 offen
  v_mfma_f32_16x16x32_bf16 v[120:123], a[252:255], a[184:187], v[120:123]
  v_rcp_f32 v16, v16
  v_mfma_f32_16x16x32_bf16 v[124:127], a[252:255], a[188:191], v[124:127]
  v_mul_f32 v152, v152, v16
  v_cvt_pk_bf16_f32 v40, v128, v129
  s_waitcnt lgkmcnt(2)
  v_mfma_f32_16x16x32_bf16 v[96:99], a[240:243], a[48:51], v[96:99]
  ds_read_b64_tr_b16 a[252:253], v3 offset:28672
  ds_read_b64_tr_b16 a[254:255], v3 offset:29184
  s_add_u32 s5, s77, 384
  v_mfma_f32_16x16x32_bf16 v[100:103], a[240:243], a[52:55], v[100:103]
  buffer_load_dword v95, v0, s[16:19], s5 offen
  buffer_load_dword v10, off, s[28:31], s72 sc1
  v_mfma_f32_16x16x32_bf16 v[104:107], a[240:243], a[192:195], v[104:107]
  s_add_u32 s6, s68, 0
  buffer_store_dwordx4 v[28:31], v1, s[24:27], s6 offen offset:1024 sc1
  v_mfma_f32_16x16x32_bf16 v[108:111], a[240:243], a[196:199], v[108:111]
  v_exp_f32 v17, v17
  v_mfma_f32_16x16x32_bf16 v[112:115], a[244:247], a[48:51], v[112:115]
  ds_read_b64_tr_b16 a[240:241], v2 offset:32768
  ds_read_b64_tr_b16 a[242:243], v2 offset:33280
  v_mfma_f32_16x16x32_bf16 v[116:119], a[244:247], a[52:55], v[116:119]
  v_add_f32 v17, 1.0, v17
  v_mul_f32 v130, v130, v162
  v_mfma_f32_16x16x32_bf16 v[120:123], a[244:247], a[192:195], v[120:123]
  v_rcp_f32 v17, v17
  v_mfma_f32_16x16x32_bf16 v[124:127], a[244:247], a[196:199], v[124:127]
  v_mul_f32 v153, v153, v17
  v_mul_f32 v131, v131, v163
  s_waitcnt lgkmcnt(2)
  v_mfma_f32_16x16x32_bf16 v[96:99], a[248:251], a[56:59], v[96:99]
  ds_read_b64_tr_b16 a[244:245], v3 offset:32768
  ds_read_b64_tr_b16 a[246:247], v3 offset:33280
  v_mfma_f32_16x16x32_bf16 v[100:103], a[248:251], a[60:63], v[100:103]
  v_exp_f32 v18, v18
  v_mfma_f32_16x16x32_bf16 v[104:107], a[248:251], a[200:203], v[104:107]
  v_add_f32 v18, 1.0, v18
  v_cvt_pk_bf16_f32 v41, v130, v131
  v_mfma_f32_16x16x32_bf16 v[108:111], a[248:251], a[204:207], v[108:111]
  v_rcp_f32 v18, v18
  v_mfma_f32_16x16x32_bf16 v[112:115], a[252:255], a[56:59], v[112:115]
  v_mul_f32 v154, v154, v18
  v_mul_f32 v144, v144, v176
  v_mfma_f32_16x16x32_bf16 v[116:119], a[252:255], a[60:63], v[116:119]
  v_exp_f32 v19, v19
  v_mfma_f32_16x16x32_bf16 v[120:123], a[252:255], a[200:203], v[120:123]
  v_mfma_f32_16x16x32_bf16 v[124:127], a[252:255], a[204:207], v[124:127]
  s_waitcnt vmcnt(29) lgkmcnt(0)
  s_barrier
  v_add_u32 v2, 36864, v6
  v_xor_b32 v3, 32, v2
  v_mfma_f32_16x16x32_bf16 v[96:99], a[240:243], a[64:67], v[96:99]
  ds_read_b64_tr_b16 a[248:249], v2 offset:0
  ds_read_b64_tr_b16 a[250:251], v2 offset:512
  v_mfma_f32_16x16x32_bf16 v[100:103], a[240:243], a[68:71], v[100:103]
  ds_read_b64_tr_b16 a[252:253], v3 offset:0
  ds_read_b64_tr_b16 a[254:255], v3 offset:512
  v_mfma_f32_16x16x32_bf16 v[104:107], a[240:243], a[208:211], v[104:107]
  v_add_f32 v19, 1.0, v19
  v_mul_f32 v145, v145, v177
  v_mfma_f32_16x16x32_bf16 v[108:111], a[240:243], a[212:215], v[108:111]
  v_rcp_f32 v19, v19
  v_mfma_f32_16x16x32_bf16 v[112:115], a[244:247], a[64:67], v[112:115]
  ds_read_b64_tr_b16 a[240:241], v2 offset:4096
  ds_read_b64_tr_b16 a[242:243], v2 offset:4608
  v_mfma_f32_16x16x32_bf16 v[116:119], a[244:247], a[68:71], v[116:119]
  v_mul_f32 v155, v155, v19
  v_cvt_pk_bf16_f32 v42, v144, v145
  v_mfma_f32_16x16x32_bf16 v[120:123], a[244:247], a[208:211], v[120:123]
  v_exp_f32 v20, v20
  v_mfma_f32_16x16x32_bf16 v[124:127], a[244:247], a[212:215], v[124:127]
  v_add_f32 v20, 1.0, v20
  v_mul_f32 v146, v146, v178
  s_waitcnt lgkmcnt(2)
  v_mfma_f32_16x16x32_bf16 v[96:99], a[248:251], a[72:75], v[96:99]
  ds_read_b64_tr_b16 a[244:245], v3 offset:4096
  ds_read_b64_tr_b16 a[246:247], v3 offset:4608
  v_mfma_f32_16x16x32_bf16 v[100:103], a[248:251], a[76:79], v[100:103]
  v_rcp_f32 v20, v20
  v_mfma_f32_16x16x32_bf16 v[104:107], a[248:251], a[216:219], v[104:107]
  s_add_u32 s65, s52, 384
  s_add_u32 m0, s63, 0
  v_mfma_f32_16x16x32_bf16 v[108:111], a[248:251], a[220:223], v[108:111]
  v_mul_f32 v156, v156, v20
  v_mul_f32 v147, v147, v179
  v_mfma_f32_16x16x32_bf16 v[112:115], a[252:255], a[72:75], v[112:115]
  ds_read_b64_tr_b16 a[248:249], v2 offset:8192
  ds_read_b64_tr_b16 a[250:251], v2 offset:8704
  v_mfma_f32_16x16x32_bf16 v[116:119], a[252:255], a[76:79], v[116:119]
  buffer_load_dwordx4 v240, s[8:11], s65 offen lds
  v_cvt_pk_bf16_f32 v43, v146, v147
  v_mfma_f32_16x16x32_bf16 v[120:123], a[252:255], a[216:219], v[120:123]
  v_exp_f32 v21, v21
  v_mfma_f32_16x16x32_bf16 v[124:127], a[252:255], a[220:223], v[124:127]
  v_add_f32 v21, 1.0, v21
  v_mul_f32 v132, v132, v164
  s_waitcnt lgkmcnt(2)
  v_mfma_f32_16x16x32_bf16 v[96:99], a[240:243], a[80:83], v[96:99]
  ds_read_b64_tr_b16 a[252:253], v3 offset:8192
  ds_read_b64_tr_b16 a[254:255], v3 offset:8704
  v_mfma_f32_16x16x32_bf16 v[100:103], a[240:243], a[84:87], v[100:103]
  buffer_load_dwordx4 v241, s[8:11], s65 offen offset:1024 lds
  v_mul_f32 v133, v133, v165
  v_mfma_f32_16x16x32_bf16 v[104:107], a[240:243], a[224:227], v[104:107]
  v_rcp_f32 v21, v21
  v_mfma_f32_16x16x32_bf16 v[108:111], a[240:243], a[228:231], v[108:111]
  v_mul_f32 v157, v157, v21
  v_cvt_pk_bf16_f32 v44, v132, v133
  v_mfma_f32_16x16x32_bf16 v[112:115], a[244:247], a[80:83], v[112:115]
  ds_read_b64_tr_b16 a[240:241], v2 offset:12288
  ds_read_b64_tr_b16 a[242:243], v2 offset:12800
  v_mfma_f32_16x16x32_bf16 v[116:119], a[244:247], a[84:87], v[116:119]
  buffer_load_dwordx4 v242, s[8:11], s65 offen offset:2048 lds
  v_mul_f32 v134, v134, v166
  v_mfma_f32_16x16x32_bf16 v[120:123], a[244:247], a[224:227], v[120:123]
  v_exp_f32 v22, v22
  v_mfma_f32_16x16x32_bf16 v[124:127], a[244:247], a[228:231], v[124:127]
  v_add_f32 v22, 1.0, v22
  v_mul_f32 v135, v135, v167
  s_waitcnt lgkmcnt(2)
  v_mfma_f32_16x16x32_bf16 v[96:99], a[248:251], a[88:91], v[96:99]
  ds_read_b64_tr_b16 a[244:245], v3 offset:12288
  ds_read_b64_tr_b16 a[246:247], v3 offset:12800
  v_mfma_f32_16x16x32_bf16 v[100:103], a[248:251], a[92:95], v[100:103]
  buffer_load_dwordx4 v243, s[8:11], s65 offen offset:3072 lds
  v_cvt_pk_bf16_f32 v45, v134, v135
  v_mfma_f32_16x16x32_bf16 v[104:107], a[248:251], a[232:235], v[104:107]
  v_rcp_f32 v22, v22
  v_mfma_f32_16x16x32_bf16 v[108:111], a[248:251], a[236:239], v[108:111]
  v_mul_f32 v158, v158, v22
  v_mul_f32 v148, v148, v180
  v_mfma_f32_16x16x32_bf16 v[112:115], a[252:255], a[88:91], v[112:115]
  ds_read_b64_tr_b16 a[248:249], v2 offset:16384
  ds_read_b64_tr_b16 a[250:251], v2 offset:16896
  v_mfma_f32_16x16x32_bf16 v[116:119], a[252:255], a[92:95], v[116:119]
  s_add_u32 s66, s52, 1180032
  s_add_u32 m0, s63, 16384
  v_mfma_f32_16x16x32_bf16 v[120:123], a[252:255], a[232:235], v[120:123]
  buffer_load_dwordx4 v240, s[8:11], s66 offen lds
  v_mul_f32 v149, v149, v181
  v_mfma_f32_16x16x32_bf16 v[124:127], a[252:255], a[236:239], v[124:127]
  v_exp_f32 v23, v23
  s_waitcnt lgkmcnt(2)
  v_mfma_f32_16x16x32_bf16 v[96:99], a[240:243], a[96:99], v[96:99]
  ds_read_b64_tr_b16 a[252:253], v3 offset:16384
  ds_read_b64_tr_b16 a[254:255], v3 offset:16896
  v_mfma_f32_16x16x32_bf16 v[100:103], a[240:243], a[100:103], v[100:103]
  v_add_f32 v23, 1.0, v23
  v_cvt_pk_bf16_f32 v46, v148, v149
  v_mfma_f32_16x16x32_bf16 v[104:107], a[240:243], v[192:195], v[104:107]
  buffer_load_dwordx4 v241, s[8:11], s66 offen offset:1024 lds
  v_mul_f32 v150, v150, v182
  v_mfma_f32_16x16x32_bf16 v[108:111], a[240:243], v[196:199], v[108:111]
  v_rcp_f32 v23, v23
  v_mfma_f32_16x16x32_bf16 v[112:115], a[244:247], a[96:99], v[112:115]
  ds_read_b64_tr_b16 a[240:241], v2 offset:20480
  ds_read_b64_tr_b16 a[242:243], v2 offset:20992
  v_mfma_f32_16x16x32_bf16 v[116:119], a[244:247], a[100:103], v[116:119]
  v_mul_f32 v159, v159, v23
  v_mul_f32 v151, v151, v183
  v_mfma_f32_16x16x32_bf16 v[120:123], a[244:247], v[192:195], v[120:123]
  buffer_load_dwordx4 v242, s[8:11], s66 offen offset:2048 lds
  v_cvt_pk_bf16_f32 v47, v150, v151
  v_mfma_f32_16x16x32_bf16 v[124:127], a[244:247], v[196:199], v[124:127]
  v_mul_f32 v136, v136, v168
  v_mul_f32 v137, v137, v169
  s_waitcnt lgkmcnt(2)
  v_mfma_f32_16x16x32_bf16 v[96:99], a[248:251], a[104:107], v[96:99]
  ds_read_b64_tr_b16 a[244:245], v3 offset:20480
  ds_read_b64_tr_b16 a[246:247], v3 offset:20992
  v_mfma_f32_16x16x32_bf16 v[100:103], a[248:251], a[108:111], v[100:103]
  v_cvt_pk_bf16_f32 v136, v136, v137
  v_mul_f32 v138, v138, v170
  v_mfma_f32_16x16x32_bf16 v[104:107], a[248:251], v[200:203], v[104:107]
  buffer_load_dwordx4 v243, s[8:11], s66 offen offset:3072 lds
  v_mul_f32 v139, v139, v171
  v_mfma_f32_16x16x32_bf16 v[108:111], a[248:251], v[204:207], v[108:111]
  v_cvt_pk_bf16_f32 v137, v138, v139
  v_mul_f32 v152, v152, v184
  v_mfma_f32_16x16x32_bf16 v[112:115], a[252:255], a[104:107], v[112:115]
  ds_read_b64_tr_b16 a[248:249], v2 offset:24576
  ds_read_b64_tr_b16 a[250:251], v2 offset:25088
  v_mfma_f32_16x16x32_bf16 v[116:119], a[252:255], a[108:111], v[116:119]
  v_mul_f32 v153, v153, v185
  v_cvt_pk_bf16_f32 v138, v152, v153
  v_mfma_f32_16x16x32_bf16 v[120:123], a[252:255], v[200:203], v[120:123]
  s_add_u32 s67, s53, 384
  s_add_u32 m0, s64, 0
  v_mfma_f32_16x16x32_bf16 v[124:127], a[252:255], v[204:207], v[124:127]
  v_mul_f32 v154, v154, v186
  v_mul_f32 v155, v155, v187
  s_waitcnt lgkmcnt(2)
  v_mfma_f32_16x16x32_bf16 v[96:99], a[240:243], a[112:115], v[96:99]
  ds_read_b64_tr_b16 a[252:253], v3 offset:24576
  ds_read_b64_tr_b16 a[254:255], v3 offset:25088
  v_mfma_f32_16x16x32_bf16 v[100:103], a[240:243], a[116:119], v[100:103]
  buffer_load_dwordx4 v11, s[8:11], s67 offen lds
  v_cvt_pk_bf16_f32 v139, v154, v155
  v_mfma_f32_16x16x32_bf16 v[104:107], a[240:243], v[208:211], v[104:107]
  ds_write_b128 v4, v[136:139] offset:0
  v_mul_f32 v140, v140, v172
  v_mfma_f32_16x16x32_bf16 v[108:111], a[240:243], v[212:215], v[108:111]
  v_mul_f32 v141, v141, v173
  v_cvt_pk_bf16_f32 v140, v140, v141
  v_mfma_f32_16x16x32_bf16 v[112:115], a[244:247], a[112:115], v[112:115]
  ds_read_b64_tr_b16 a[240:241], v2 offset:28672
  ds_read_b64_tr_b16 a[242:243], v2 offset:29184
  v_mfma_f32_16x16x32_bf16 v[116:119], a[244:247], a[116:119], v[116:119]
  v_mul_f32 v142, v142, v174
  v_mul_f32 v143, v143, v175
  v_mfma_f32_16x16x32_bf16 v[120:123], a[244:247], v[208:211], v[120:123]
  v_cvt_pk_bf16_f32 v141, v142, v143
  v_mul_f32 v156, v156, v188
  v_mfma_f32_16x16x32_bf16 v[124:127], a[244:247], v[212:215], v[124:127]
  v_mul_f32 v157, v157, v189
  v_cvt_pk_bf16_f32 v142, v156, v157
  s_waitcnt lgkmcnt(3)
  v_mfma_f32_16x16x32_bf16 v[96:99], a[248:251], a[120:123], v[96:99]
  ds_read_b64_tr_b16 a[244:245], v3 offset:28672
  ds_read_b64_tr_b16 a[246:247], v3 offset:29184
  s_add_u32 s5, s79, 0
  v_mfma_f32_16x16x32_bf16 v[100:103], a[248:251], a[124:127], v[100:103]
  buffer_load_dword v95, v0, s[16:19], s5 offen
  s_add_u32 s5, s79, 331776
  buffer_load_dword v95, v0, s[16:19], s5 offen
  v_mfma_f32_16x16x32_bf16 v[104:107], a[248:251], v[216:219], v[104:107]
  s_add_u32 s6, s68, 0
  buffer_store_dwordx4 v[32:35], v1, s[24:27], s6 offen offset:2048 sc1
  v_mfma_f32_16x16x32_bf16 v[108:111], a[248:251], v[220:223], v[108:111]
  v_mul_f32 v158, v158, v190
  v_mul_f32 v159, v159, v191
  v_mfma_f32_16x16x32_bf16 v[112:115], a[252:255], a[120:123], v[112:115]
  ds_read_b64_tr_b16 a[248:249], v2 offset:32768
  ds_read_b64_tr_b16 a[250:251], v2 offset:33280
  v_mfma_f32_16x16x32_bf16 v[116:119], a[252:255], a[124:127], v[116:119]
  v_cvt_pk_bf16_f32 v143, v158, v159
  ds_write_b128 v4, v[140:143] offset:1024
  v_mfma_f32_16x16x32_bf16 v[120:123], a[252:255], v[216:219], v[120:123]
  v_mfma_f32_16x16x32_bf16 v[124:127], a[252:255], v[220:223], v[124:127]
  s_waitcnt lgkmcnt(3)
  v_mfma_f32_16x16x32_bf16 v[96:99], a[240:243], a[128:131], v[96:99]
  ds_read_b64_tr_b16 a[252:253], v3 offset:32768
  ds_read_b64_tr_b16 a[254:255], v3 offset:33280
  v_mfma_f32_16x16x32_bf16 v[100:103], a[240:243], a[132:135], v[100:103]
  v_mfma_f32_16x16x32_bf16 v[104:107], a[240:243], v[224:227], v[104:107]
  v_mfma_f32_16x16x32_bf16 v[108:111], a[240:243], v[228:231], v[108:111]
  v_mfma_f32_16x16x32_bf16 v[112:115], a[244:247], a[128:131], v[112:115]
  v_mfma_f32_16x16x32_bf16 v[116:119], a[244:247], a[132:135], v[116:119]
  v_mfma_f32_16x16x32_bf16 v[120:123], a[244:247], v[224:227], v[120:123]
  v_mfma_f32_16x16x32_bf16 v[124:127], a[244:247], v[228:231], v[124:127]
  s_waitcnt vmcnt(28) lgkmcnt(0)
  s_barrier
  v_add_u32 v2, 73728, v6
  v_xor_b32 v3, 32, v2
  v_mfma_f32_16x16x32_bf16 v[96:99], a[248:251], a[136:139], v[96:99]
  ds_read_b64_tr_b16 a[240:241], v2 offset:0
  ds_read_b64_tr_b16 a[242:243], v2 offset:512
  v_mfma_f32_16x16x32_bf16 v[100:103], a[248:251], a[140:143], v[100:103]
  ds_read_b64_tr_b16 a[244:245], v3 offset:0
  ds_read_b64_tr_b16 a[246:247], v3 offset:512
  v_mfma_f32_16x16x32_bf16 v[104:107], a[248:251], v[232:235], v[104:107]
  v_mfma_f32_16x16x32_bf16 v[108:111], a[248:251], v[236:239], v[108:111]
  v_mfma_f32_16x16x32_bf16 v[112:115], a[252:255], a[136:139], v[112:115]
  ds_read_b64_tr_b16 a[248:249], v2 offset:4096
  ds_read_b64_tr_b16 a[250:251], v2 offset:4608
  v_mfma_f32_16x16x32_bf16 v[116:119], a[252:255], a[140:143], v[116:119]
  v_mfma_f32_16x16x32_bf16 v[120:123], a[252:255], v[232:235], v[120:123]
  v_mfma_f32_16x16x32_bf16 v[124:127], a[252:255], v[236:239], v[124:127]
  s_waitcnt lgkmcnt(2)
  v_mfma_f32_16x16x32_bf16 v[160:163], a[240:243], a[0:3], 0
  ds_read_b64_tr_b16 a[252:253], v3 offset:4096
  ds_read_b64_tr_b16 a[254:255], v3 offset:4608
  v_mfma_f32_16x16x32_bf16 v[164:167], a[240:243], a[4:7], 0
  v_mfma_f32_16x16x32_bf16 v[168:171], a[240:243], a[144:147], 0
  s_add_u32 s65, s52, 2654592
  s_add_u32 m0, s63, 36864
  v_mfma_f32_16x16x32_bf16 v[172:175], a[240:243], a[148:151], 0
  v_mfma_f32_16x16x32_bf16 v[176:179], a[244:247], a[0:3], 0
  ds_read_b64_tr_b16 a[240:241], v2 offset:8192
  ds_read_b64_tr_b16 a[242:243], v2 offset:8704
  v_mfma_f32_16x16x32_bf16 v[180:183], a[244:247], a[4:7], 0
  buffer_load_dwordx4 v240, s[8:11], s65 offen lds
  v_mfma_f32_16x16x32_bf16 v[184:187], a[244:247], a[144:147], 0
  v_mul_f32 v16, 0xbfb8aa3b, v96
  v_mul_f32 v17, 0xbfb8aa3b, v97
  v_mfma_f32_16x16x32_bf16 v[188:191], a[244:247], a[148:151], 0
  v_exp_f32 v16, v16
  s_waitcnt lgkmcnt(2)
  v_mfma_f32_16x16x32_bf16 v[160:163], a[248:251], a[8:11], v[160:163]
  ds_read_b64_tr_b16 a[244:245], v3 offset:8192
  ds_read_b64_tr_b16 a[246:247], v3 offset:8704
  v_mfma_f32_16x16x32_bf16 v[164:167], a[248:251], a[12:15], v[164:167]
  buffer_load_dwordx4 v241, s[8:11], s65 offen offset:1024 lds
  v_add_f32 v16, 1.0, v16
  v_mfma_f32_16x16x32_bf16 v[168:171], a[248:251], a[152:155], v[168:171]
  v_rcp_f32 v16, v16
  v_mfma_f32_16x16x32_bf16 v[172:175], a[248:251], a[156:159], v[172:175]
  v_mul_f32 v96, v96, v16
  v_mul_f32 v18, 0xbfb8aa3b, v98
  v_mfma_f32_16x16x32_bf16 v[176:179], a[252:255], a[8:11], v[176:179]
  ds_read_b64_tr_b16 a[248:249], v2 offset:12288
  ds_read_b64_tr_b16 a[250:251], v2 offset:12800
  v_mfma_f32_16x16x32_bf16 v[180:183], a[252:255], a[12:15], v[180:183]
  buffer_load_dwordx4 v242, s[8:11], s65 offen offset:2048 lds
  v_mul_f32 v19, 0xbfb8aa3b, v99
  v_mfma_f32_16x16x32_bf16 v[184:187], a[252:255], a[152:155], v[184:187]
  v_exp_f32 v17, v17
  v_mfma_f32_16x16x32_bf16 v[188:191], a[252:255], a[156:159], v[188:191]
  v_add_f32 v17, 1.0, v17
  v_mul_f32 v20, 0xbfb8aa3b, v100
  s_waitcnt lgkmcnt(2)
  v_mfma_f32_16x16x32_bf16 v[160:163], a[240:243], a[16:19], v[160:163]
  ds_read_b64_tr_b16 a[252:253], v3 offset:12288
  ds_read_b64_tr_b16 a[254:255], v3 offset:12800
  v_mfma_f32_16x16x32_bf16 v[164:167], a[240:243], a[20:23], v[164:167]
  buffer_load_dwordx4 v243, s[8:11], s65 offen offset:3072 lds
  v_mul_f32 v21, 0xbfb8aa3b, v101
  v_mfma_f32_16x16x32_bf16 v[168:171], a[240:243], a[160:163], v[168:171]
  v_rcp_f32 v17, v17
  v_mfma_f32_16x16x32_bf16 v[172:175], a[240:243], a[164:167], v[172:175]
  v_mul_f32 v97, v97, v17
  v_mul_f32 v22, 0xbfb8aa3b, v102
  v_mfma_f32_16x16x32_bf16 v[176:179], a[244:247], a[16:19], v[176:179]
  ds_read_b64_tr_b16 a[240:241], v2 offset:16384
  ds_read_b64_tr_b16 a[242:243], v2 offset:16896
  v_mfma_f32_16x16x32_bf16 v[180:183], a[244:247], a[20:23], v[180:183]
  s_add_u32 s66, s52, 3834240
  s_add_u32 m0, s63, 53248
  v_mfma_f32_16x16x32_bf16 v[184:187], a[244:247], a[160:163], v[184:187]
  buffer_load_dwordx4 v240, s[8:11], s66 offen lds
  v_mul_f32 v23, 0xbfb8aa3b, v103
  v_mfma_f32_16x16x32_bf16 v[188:191], a[244:247], a[164:167], v[188:191]
  v_exp_f32 v18, v18
  s_waitcnt lgkmcnt(2)
  v_mfma_f32_16x16x32_bf16 v[160:163], a[248:251], a[24:27], v[160:163]
  ds_read_b64_tr_b16 a[244:245], v3 offset:16384
  ds_read_b64_tr_b16 a[246:247], v3 offset:16896
  v_mfma_f32_16x16x32_bf16 v[164:167], a[248:251], a[28:31], v[164:167]
  v_add_f32 v18, 1.0, v18
  v_mul_f32 v16, 0xbfb8aa3b, v104
  v_mfma_f32_16x16x32_bf16 v[168:171], a[248:251], a[168:171], v[168:171]
  buffer_load_dwordx4 v241, s[8:11], s66 offen offset:1024 lds
  v_mul_f32 v17, 0xbfb8aa3b, v105
  v_mfma_f32_16x16x32_bf16 v[172:175], a[248:251], a[172:175], v[172:175]
  v_rcp_f32 v18, v18
  v_mfma_f32_16x16x32_bf16 v[176:179], a[252:255], a[24:27], v[176:179]
  ds_read_b64_tr_b16 a[248:249], v2 offset:20480
  ds_read_b64_tr_b16 a[250:251], v2 offset:20992
  v_mfma_f32_16x16x32_bf16 v[180:183], a[252:255], a[28:31], v[180:183]
  v_mul_f32 v98, v98, v18
  v_mul_f32 v18, 0xbfb8aa3b, v106
  v_mfma_f32_16x16x32_bf16 v[184:187], a[252:255], a[168:171], v[184:187]
  buffer_load_dwordx4 v242, s[8:11], s66 offen offset:2048 lds
  v_mfma_f32_16x16x32_bf16 v[188:191], a[252:255], a[172:175], v[188:191]
  v_exp_f32 v19, v19
  s_waitcnt lgkmcnt(2)
  v_mfma_f32_16x16x32_bf16 v[160:163], a[240:243], a[32:35], v[160:163]
  ds_read_b64_tr_b16 a[252:253], v3 offset:20480
  ds_read_b64_tr_b16 a[254:255], v3 offset:20992
  v_mfma_f32_16x16x32_bf16 v[164:167], a[240:243], a[36:39], v[164:167]
  v_add_f32 v19, 1.0, v19
  v_mfma_f32_16x16x32_bf16 v[168:171], a[240:243], a[176:179], v[168:171]
  buffer_load_dwordx4 v243, s[8:11], s66 offen offset:3072 lds
  v_mfma_f32_16x16x32_bf16 v[172:175], a[240:243], a[180:183], v[172:175]
  v_rcp_f32 v19, v19
  v_mfma_f32_16x16x32_bf16 v[176:179], a[244:247], a[32:35], v[176:179]
  ds_read_b64_tr_b16 a[240:241], v2 offset:24576
  ds_read_b64_tr_b16 a[242:243], v2 offset:25088
  v_mfma_f32_16x16x32_bf16 v[180:183], a[244:247], a[36:39], v[180:183]
  v_mul_f32 v99, v99, v19
  v_mul_f32 v19, 0xbfb8aa3b, v107
  v_mfma_f32_16x16x32_bf16 v[184:187], a[244:247], a[176:179], v[184:187]
  s_add_u32 s67, s53, 2654592
  s_add_u32 m0, s64, 36864
  v_mfma_f32_16x16x32_bf16 v[188:191], a[244:247], a[180:183], v[188:191]
  v_exp_f32 v20, v20
  s_waitcnt lgkmcnt(2)
  v_mfma_f32_16x16x32_bf16 v[160:163], a[248:251], a[40:43], v[160:163]
  ds_read_b64_tr_b16 a[244:245], v3 offset:24576
  ds_read_b64_tr_b16 a[246:247], v3 offset:25088
  v_mfma_f32_16x16x32_bf16 v[164:167], a[248:251], a[44:47], v[164:167]
  buffer_load_dwordx4 v11, s[8:11], s67 offen lds
  v_add_f32 v20, 1.0, v20
  v_mfma_f32_16x16x32_bf16 v[168:171], a[248:251], a[184:187], v[168:171]
  v_rcp_f32 v20, v20
  v_mfma_f32_16x16x32_bf16 v[172:175], a[248:251], a[188:191], v[172:175]
  v_mul_f32 v100, v100, v20
  v_mul_f32 v20, 0xbfb8aa3b, v108
  v_mfma_f32_16x16x32_bf16 v[176:179], a[252:255], a[40:43], v[176:179]
  ds_read_b64_tr_b16 a[248:249], v2 offset:28672
  ds_read_b64_tr_b16 a[250:251], v2 offset:29184
  v_mfma_f32_16x16x32_bf16 v[180:183], a[252:255], a[44:47], v[180:183]
  s_add_u32 s5, s78, 0
  buffer_load_dword v95, v0, s[16:19], s5 offen
  v_mfma_f32_16x16x32_bf16 v[184:187], a[252:255], a[184:187], v[184:187]
  v_exp_f32 v21, v21
  v_mfma_f32_16x16x32_bf16 v[188:191], a[252:255], a[188:191], v[188:191]
  v_add_f32 v21, 1.0, v21
  s_waitcnt lgkmcnt(2)
  v_mfma_f32_16x16x32_bf16 v[160:163], a[240:243], a[48:51], v[160:163]
  ds_read_b64_tr_b16 a[252:253], v3 offset:28672
  ds_read_b64_tr_b16 a[254:255], v3 offset:29184
  v_mfma_f32_16x16x32_bf16 v[164:167], a[240:243], a[52:55], v[164:167]
  s_add_u32 s5, s78, 128
  buffer_load_dword v95, v0, s[16:19], s5 offen
  v_mfma_f32_16x16x32_bf16 v[168:171], a[240:243], a[192:195], v[168:171]
  s_add_u32 s6, s68, 0
  buffer_store_dwordx4 v[36:39], v1, s[24:27], s6 offen offset:3072 sc1
  v_mfma_f32_16x16x32_bf16 v[172:175], a[240:243], a[196:199], v[172:175]
  v_rcp_f32 v21, v21
  v_mfma_f32_16x16x32_bf16 v[176:179], a[244:247], a[48:51], v[176:179]
  ds_read_b64_tr_b16 a[240:241], v2 offset:32768
  ds_read_b64_tr_b16 a[242:243], v2 offset:33280
  v_mfma_f32_16x16x32_bf16 v[180:183], a[244:247], a[52:55], v[180:183]
  v_mul_f32 v101, v101, v21
  v_mul_f32 v21, 0xbfb8aa3b, v109
  v_mfma_f32_16x16x32_bf16 v[184:187], a[244:247], a[192:195], v[184:187]
  v_exp_f32 v22, v22
  v_mfma_f32_16x16x32_bf16 v[188:191], a[244:247], a[196:199], v[188:191]
  v_add_f32 v22, 1.0, v22
  s_waitcnt lgkmcnt(2)
  v_mfma_f32_16x16x32_bf16 v[160:163], a[248:251], a[56:59], v[160:163]
  ds_read_b64_tr_b16 a[244:245], v3 offset:32768
  ds_read_b64_tr_b16 a[246:247], v3 offset:33280
  v_mfma_f32_16x16x32_bf16 v[164:167], a[248:251], a[60:63], v[164:167]
  v_rcp_f32 v22, v22
  v_mfma_f32_16x16x32_bf16 v[168:171], a[248:251], a[200:203], v[168:171]
  v_mul_f32 v102, v102, v22
  v_mul_f32 v22, 0xbfb8aa3b, v110
  v_mfma_f32_16x16x32_bf16 v[172:175], a[248:251], a[204:207], v[172:175]
  v_exp_f32 v23, v23
  v_mfma_f32_16x16x32_bf16 v[176:179], a[252:255], a[56:59], v[176:179]
  v_add_f32 v23, 1.0, v23
  v_mfma_f32_16x16x32_bf16 v[180:183], a[252:255], a[60:63], v[180:183]
  v_rcp_f32 v23, v23
  v_mfma_f32_16x16x32_bf16 v[184:187], a[252:255], a[200:203], v[184:187]
  v_mfma_f32_16x16x32_bf16 v[188:191], a[252:255], a[204:207], v[188:191]
  s_waitcnt vmcnt(28) lgkmcnt(0)
  s_barrier
  ds_read_b128 v[48:51], v5 offset:0
  ds_read_b128 v[52:55], v5 offset:1024
  v_add_u32 v2, 110592, v6
  v_xor_b32 v3, 32, v2
  v_mfma_f32_16x16x32_bf16 v[160:163], a[240:243], a[64:67], v[160:163]
  ds_read_b64_tr_b16 a[248:249], v2 offset:0
  ds_read_b64_tr_b16 a[250:251], v2 offset:512
  v_mfma_f32_16x16x32_bf16 v[164:167], a[240:243], a[68:71], v[164:167]
  ds_read_b64_tr_b16 a[252:253], v3 offset:0
  ds_read_b64_tr_b16 a[254:255], v3 offset:512
  v_mfma_f32_16x16x32_bf16 v[168:171], a[240:243], a[208:211], v[168:171]
  v_mul_f32 v103, v103, v23
  v_mul_f32 v23, 0xbfb8aa3b, v111
  v_mfma_f32_16x16x32_bf16 v[172:175], a[240:243], a[212:215], v[172:175]
  v_exp_f32 v16, v16
  v_mfma_f32_16x16x32_bf16 v[176:179], a[244:247], a[64:67], v[176:179]
  ds_read_b64_tr_b16 a[240:241], v2 offset:4096
  ds_read_b64_tr_b16 a[242:243], v2 offset:4608
  v_mfma_f32_16x16x32_bf16 v[180:183], a[244:247], a[68:71], v[180:183]
  v_add_f32 v16, 1.0, v16
  v_mfma_f32_16x16x32_bf16 v[184:187], a[244:247], a[208:211], v[184:187]
  v_rcp_f32 v16, v16
  v_mfma_f32_16x16x32_bf16 v[188:191], a[244:247], a[212:215], v[188:191]
  v_mul_f32 v104, v104, v16
  v_mul_f32 v16, 0xbfb8aa3b, v112
  s_waitcnt lgkmcnt(2)
  v_mfma_f32_16x16x32_bf16 v[160:163], a[248:251], a[72:75], v[160:163]
  ds_read_b64_tr_b16 a[244:245], v3 offset:4096
  ds_read_b64_tr_b16 a[246:247], v3 offset:4608
  v_mfma_f32_16x16x32_bf16 v[164:167], a[248:251], a[76:79], v[164:167]
  v_exp_f32 v17, v17
  v_mfma_f32_16x16x32_bf16 v[168:171], a[248:251], a[216:219], v[168:171]
  s_add_u32 s65, s52, 384
  s_add_u32 m0, s63, 73728
  v_mfma_f32_16x16x32_bf16 v[172:175], a[248:251], a[220:223], v[172:175]
  v_add_f32 v17, 1.0, v17
  v_mfma_f32_16x16x32_bf16 v[176:179], a[252:255], a[72:75], v[176:179]
  ds_read_b64_tr_b16 a[248:249], v2 offset:8192
  ds_read_b64_tr_b16 a[250:251], v2 offset:8704
  v_mfma_f32_16x16x32_bf16 v[180:183], a[252:255], a[76:79], v[180:183]
  buffer_load_dwordx4 v240, s[12:15], s65 offen lds
  s_waitcnt lgkmcnt(10)
  s_bitcmp1_b32 s48, 0
  s_cbranch_scc0 K1_nosw1
  v_swap_b32 v40, v48
  v_swap_b32 v41, v49
  v_swap_b32 v42, v50
  v_swap_b32 v43, v51
  v_swap_b32 v44, v52
  v_swap_b32 v45, v53
  v_swap_b32 v46, v54
  v_swap_b32 v47, v55
K1_nosw1:
  v_mfma_f32_16x16x32_bf16 v[184:187], a[252:255], a[216:219], v[184:187]
  v_rcp_f32 v17, v17
  v_mfma_f32_16x16x32_bf16 v[188:191], a[252:255], a[220:223], v[188:191]
  v_mul_f32 v105, v105, v17
  v_mul_f32 v17, 0xbfb8aa3b, v113
  s_waitcnt lgkmcnt(2)
  v_mfma_f32_16x16x32_bf16 v[160:163], a[240:243], a[80:83], v[160:163]
  ds_read_b64_tr_b16 a[252:253], v3 offset:8192
  ds_read_b64_tr_b16 a[254:255], v3 offset:8704
  v_mfma_f32_16x16x32_bf16 v[164:167], a[240:243], a[84:87], v[164:167]
  buffer_load_dwordx4 v241, s[12:15], s65 offen offset:1024 lds
  v_mfma_f32_16x16x32_bf16 v[168:171], a[240:243], a[224:227], v[168:171]
  v_exp_f32 v18, v18
  v_mfma_f32_16x16x32_bf16 v[172:175], a[240:243], a[228:231], v[172:175]
  v_add_f32 v18, 1.0, v18
  s_waitcnt vmcnt(27)
  v_readfirstlane_b32 s88, v10
  s_nop 3
  s_bitcmp1_b32 s88, s73
  s_cbranch_scc0 K1_spinc
K1_spinc_done:
  v_mfma_f32_16x16x32_bf16 v[176:179], a[244:247], a[80:83], v[176:179]
  ds_read_b64_tr_b16 a[240:241], v2 offset:12288
  ds_read_b64_tr_b16 a[242:243], v2 offset:12800
  v_mfma_f32_16x16x32_bf16 v[180:183], a[244:247], a[84:87], v[180:183]
  buffer_load_dwordx4 v242, s[12:15], s65 offen offset:2048 lds
  v_mfma_f32_16x16x32_bf16 v[184:187], a[244:247], a[224:227], v[184:187]
  v_rcp_f32 v18, v18
  v_mfma_f32_16x16x32_bf16 v[188:191], a[244:247], a[228:231], v[188:191]
  v_mul_f32 v106, v106, v18
  v_mul_f32 v18, 0xbfb8aa3b, v114
  s_waitcnt lgkmcnt(2)
  v_mfma_f32_16x16x32_bf16 v[160:163], a[248:251], a[88:91], v[160:163]
  ds_read_b64_tr_b16 a[244:245], v3 offset:12288
  ds_read_b64_tr_b16 a[246:247], v3 offset:12800
  v_mfma_f32_16x16x32_bf16 v[164:167], a[248:251], a[92:95], v[164:167]
  buffer_load_dwordx4 v243, s[12:15], s65 offen offset:3072 lds
  v_mfma_f32_16x16x32_bf16 v[168:171], a[248:251], a[232:235], v[168:171]
  v_exp_f32 v19, v19
  v_mfma_f32_16x16x32_bf16 v[172:175], a[248:251], a[236:239], v[172:175]
  v_add_f32 v19, 1.0, v19
  v_mfma_f32_16x16x32_bf16 v[176:179], a[252:255], a[88:91], v[176:179]
  ds_read_b64_tr_b16 a[248:249], v2 offset:16384
  ds_read_b64_tr_b16 a[250:251], v2 offset:16896
  v_mfma_f32_16x16x32_bf16 v[180:183], a[252:255], a[92:95], v[180:183]
  s_add_u32 s66, s52, 1180032
  s_add_u32 m0, s63, 90112
  v_mfma_f32_16x16x32_bf16 v[184:187], a[252:255], a[232:235], v[184:187]
  buffer_load_dwordx4 v240, s[12:15], s66 offen lds
  v_mfma_f32_16x16x32_bf16 v[188:191], a[252:255], a[236:239], v[188:191]
  v_rcp_f32 v19, v19
  s_waitcnt lgkmcnt(2)
  v_mfma_f32_16x16x32_bf16 v[160:163], a[240:243], a[96:99], v[160:163]
  ds_read_b64_tr_b16 a[252:253], v3 offset:16384
  ds_read_b64_tr_b16 a[254:255], v3 offset:16896
  v_mfma_f32_16x16x32_bf16 v[164:167], a[240:243], a[100:103], v[164:167]
  v_mul_f32 v107, v107, v19
  v_mul_f32 v19, 0xbfb8aa3b, v115
  v_mfma_f32_16x16x32_bf16 v[168:171], a[240:243], v[192:195], v[168:171]
  buffer_load_dwordx4 v241, s[12:15], s66 offen offset:1024 lds
  v_mfma_f32_16x16x32_bf16 v[172:175], a[240:243], v[196:199], v[172:175]
  v_exp_f32 v20, v20
  v_mfma_f32_16x16x32_bf16 v[176:179], a[244:247], a[96:99], v[176:179]
  ds_read_b64_tr_b16 a[240:241], v2 offset:20480
  ds_read_b64_tr_b16 a[242:243], v2 offset:20992
  v_mfma_f32_16x16x32_bf16 v[180:183], a[244:247], a[100:103], v[180:183]
  v_add_f32 v20, 1.0, v20
  v_mfma_f32_16x16x32_bf16 v[184:187], a[244:247], v[192:195], v[184:187]
  buffer_load_dwordx4 v242, s[12:15], s66 offen offset:2048 lds
  v_mfma_f32_16x16x32_bf16 v[188:191], a[244:247], v[196:199], v[188:191]
  v_rcp_f32 v20, v20
  s_waitcnt lgkmcnt(2)
  v_mfma_f32_16x16x32_bf16 v[160:163], a[248:251], a[104:107], v[160:163]
  ds_read_b64_tr_b16 a[244:245], v3 offset:20480
  ds_read_b64_tr_b16 a[246:247], v3 offset:20992
  v_mfma_f32_16x16x32_bf16 v[164:167], a[248:251], a[108:111], v[164:167]
  v_mul_f32 v108, v108, v20
  v_mul_f32 v20, 0xbfb8aa3b, v116
  v_mfma_f32_16x16x32_bf16 v[168:171], a[248:251], v[200:203], v[168:171]
  buffer_load_dwordx4 v243, s[12:15], s66 offen offset:3072 lds
  v_mfma_f32_16x16x32_bf16 v[172:175], a[248:251], v[204:207], v[172:175]
  v_exp_f32 v21, v21
  v_mfma_f32_16x16x32_bf16 v[176:179], a[252:255], a[104:107], v[176:179]
  ds_read_b64_tr_b16 a[248:249], v2 offset:24576
  ds_read_b64_tr_b16 a[250:251], v2 offset:25088
  v_mfma_f32_16x16x32_bf16 v[180:183], a[252:255], a[108:111], v[180:183]
  v_add_f32 v21, 1.0, v21
  v_mfma_f32_16x16x32_bf16 v[184:187], a[252:255], v[200:203], v[184:187]
  s_add_u32 s67, s53, 384
  s_add_u32 m0, s64, 73728
  v_mfma_f32_16x16x32_bf16 v[188:191], a[252:255], v[204:207], v[188:191]
  v_rcp_f32 v21, v21
  s_waitcnt lgkmcnt(2)
  v_mfma_f32_16x16x32_bf16 v[160:163], a[240:243], a[112:115], v[160:163]
  ds_read_b64_tr_b16 a[252:253], v3 offset:24576
  ds_read_b64_tr_b16 a[254:255], v3 offset:25088
  v_mfma_f32_16x16x32_bf16 v[164:167], a[240:243], a[116:119], v[164:167]
  buffer_load_dwordx4 v11, s[12:15], s67 offen lds
  v_mul_f32 v109, v109, v21
  v_mfma_f32_16x16x32_bf16 v[168:171], a[240:243], v[208:211], v[168:171]
  v_exp_f32 v22, v22
  v_mfma_f32_16x16x32_bf16 v[172:175], a[240:243], v[212:215], v[172:175]
  v_add_f32 v22, 1.0, v22
  v_mul_f32 v21, 0xbfb8aa3b, v117
  v_mfma_f32_16x16x32_bf16 v[176:179], a[244:247], a[112:115], v[176:179]
  ds_read_b64_tr_b16 a[240:241], v2 offset:28672
  ds_read_b64_tr_b16 a[242:243], v2 offset:29184
  v_mfma_f32_16x16x32_bf16 v[180:183], a[244:247], a[116:119], v[180:183]
  s_add_u32 s5, s78, 256
  buffer_load_dword v95, v0, s[16:19], s5 offen
  v_mfma_f32_16x16x32_bf16 v[184:187], a[244:247], v[208:211], v[184:187]
  s_getpc_b64 s[4:5]
K1_pc3:
  s_sub_u32 s4, s4, K1_pc3-K1_pc
  s_subb_u32 s5, s5, 0
  s_mov_b32 s20, s4
  s_and_b32 s21, s5, 0xffff
  s_mov_b32 s22, K1_codeend-K1_pc
  s_mov_b32 s23, 0x20000
  v_mfma_f32_16x16x32_bf16 v[188:191], a[244:247], v[212:215], v[188:191]
  v_rcp_f32 v22, v22
  s_waitcnt lgkmcnt(2)
  v_mfma_f32_16x16x32_bf16 v[160:163], a[248:251], a[120:123], v[160:163]
  ds_read_b64_tr_b16 a[244:245], v3 offset:28672
  ds_read_b64_tr_b16 a[246:247], v3 offset:29184
  s_add_u32 s5, s78, 384
  v_mfma_f32_16x16x32_bf16 v[164:167], a[248:251], a[124:127], v[164:167]
  buffer_load_dword v95, v0, s[16:19], s5 offen
  s_lshr_b32 s88, s2, 3
  v_mfma_f32_16x16x32_bf16 v[168:171], a[248:251], v[216:219], v[168:171]
  s_mul_i32 s88, s88, 20
  s_add_u32 s6, s68, 4096
  v_mfma_f32_16x16x32_bf16 v[172:175], a[248:251], v[220:223], v[172:175]
  buffer_store_dwordx4 v[40:43], v1, s[24:27], s6 offen offset:0 sc1
  v_mul_f32 v110, v110, v22
  v_mfma_f32_16x16x32_bf16 v[176:179], a[252:255], a[120:123], v[176:179]
  ds_read_b64_tr_b16 a[248:249], v2 offset:32768
  ds_read_b64_tr_b16 a[250:251], v2 offset:33280
  v_mfma_f32_16x16x32_bf16 v[180:183], a[252:255], a[124:127], v[180:183]
  v_lshrrev_b32 v88, 4, v1
  v_mul_f32 v22, 0xbfb8aa3b, v118
  v_mfma_f32_16x16x32_bf16 v[184:187], a[252:255], v[216:219], v[184:187]
  v_add_u32 v89, s88, v88
  v_mfma_f32_16x16x32_bf16 v[188:191], a[252:255], v[220:223], v[188:191]
  v_exp_f32 v23, v23
  s_waitcnt lgkmcnt(2)
  v_mfma_f32_16x16x32_bf16 v[160:163], a[240:243], a[128:131], v[160:163]
  ds_read_b64_tr_b16 a[252:253], v3 offset:32768
  ds_read_b64_tr_b16 a[254:255], v3 offset:33280
  v_mfma_f32_16x16x32_bf16 v[164:167], a[240:243], a[132:135], v[164:167]
  v_lshlrev_b32 v89, 7, v89
  v_add_f32 v23, 1.0, v23
  v_mfma_f32_16x16x32_bf16 v[168:171], a[240:243], v[224:227], v[168:171]
  v_mov_b32 v90, 0x7ff00000
  v_mfma_f32_16x16x32_bf16 v[172:175], a[240:243], v[228:231], v[172:175]
  v_rcp_f32 v23, v23
  v_mfma_f32_16x16x32_bf16 v[176:179], a[244:247], a[128:131], v[176:179]
  v_cmp_gt_u32 vcc, 20, v88
  v_mul_f32 v111, v111, v23
  v_mfma_f32_16x16x32_bf16 v[180:183], a[244:247], a[132:135], v[180:183]
  v_exp_f32 v16, v16
  v_mfma_f32_16x16x32_bf16 v[184:187], a[244:247], v[224:227], v[184:187]
  s_nop 1
  v_mfma_f32_16x16x32_bf16 v[188:191], a[244:247], v[228:231], v[188:191]
  s_waitcnt vmcnt(27) lgkmcnt(0)
  s_barrier
  v_mov_b32 v2, v6
  v_xor_b32 v3, 32, v2
  v_mfma_f32_16x16x32_bf16 v[160:163], a[248:251], a[136:139], v[160:163]
  ds_read_b64_tr_b16 a[240:241], v2 offset:0
  ds_read_b64_tr_b16 a[242:243], v2 offset:512
  ds_read_b64_tr_b16 a[244:245], v3 offset:0
  v_mfma_f32_16x16x32_bf16 v[164:167], a[248:251], a[140:143], v[164:167]
  ds_read_b64_tr_b16 a[246:247], v3 offset:512
  v_cndmask_b32 v89, v90, v89, vcc
  v_mfma_f32_16x16x32_bf16 v[168:171], a[248:251], v[232:235], v[168:171]
  v_add_f32 v16, 1.0, v16
  v_mul_f32 v23, 0xbfb8aa3b, v119
  v_mfma_f32_16x16x32_bf16 v[172:175], a[248:251], v[236:239], v[172:175]
  v_rcp_f32 v16, v16
  v_mfma_f32_16x16x32_bf16 v[176:179], a[252:255], a[136:139], v[176:179]
  ds_read_b64_tr_b16 a[248:249], v2 offset:4096
  ds_read_b64_tr_b16 a[250:251], v2 offset:4608
  v_mfma_f32_16x16x32_bf16 v[180:183], a[252:255], a[140:143], v[180:183]
  s_cmp_eq_u32 s48, 0
  s_cselect_b32 s88, 0, 0x7ff00000
  v_mul_f32 v112, v112, v16
  v_mfma_f32_16x16x32_bf16 v[184:187], a[252:255], v[232:235], v[184:187]
  buffer_load_dword v95, v89, s[20:23], s88 offen
  v_mul_f32 v16, 0xbfb8aa3b, v120
  v_mfma_f32_16x16x32_bf16 v[188:191], a[252:255], v[236:239], v[188:191]
  v_exp_f32 v17, v17
  s_waitcnt lgkmcnt(2)
  v_mfma_f32_16x16x32_bf16 v[128:131], a[240:243], a[0:3], 0
  ds_read_b64_tr_b16 a[252:253], v3 offset:4096
  ds_read_b64_tr_b16 a[254:255], v3 offset:4608
  v_mfma_f32_16x16x32_bf16 v[132:135], a[240:243], a[4:7], 0
  v_add_f32 v17, 1.0, v17
  v_mfma_f32_16x16x32_bf16 v[136:139], a[240:243], a[144:147], 0
  s_add_u32 s65, s52, 2654592
  s_add_u32 m0, s63, 110592
  v_mfma_f32_16x16x32_bf16 v[140:143], a[240:243], a[148:151], 0
  v_rcp_f32 v17, v17
  v_mfma_f32_16x16x32_bf16 v[144:147], a[244:247], a[0:3], 0
  ds_read_b64_tr_b16 a[240:241], v2 offset:8192
  ds_read_b64_tr_b16 a[242:243], v2 offset:8704
  v_mfma_f32_16x16x32_bf16 v[148:151], a[244:247], a[4:7], 0
  buffer_load_dwordx4 v240, s[12:15], s65 offen lds
  v_mul_f32 v113, v113, v17
  v_mfma_f32_16x16x32_bf16 v[152:155], a[244:247], a[144:147], 0
  v_exp_f32 v18, v18
  v_mfma_f32_16x16x32_bf16 v[156:159], a[244:247], a[148:151], 0
  v_add_f32 v18, 1.0, v18
  v_mul_f32 v17, 0xbfb8aa3b, v121
  s_waitcnt lgkmcnt(2)
  v_mfma_f32_16x16x32_bf16 v[128:131], a[248:251], a[8:11], v[128:131]
  ds_read_b64_tr_b16 a[244:245], v3 offset:8192
  ds_read_b64_tr_b16 a[246:247], v3 offset:8704
  v_mfma_f32_16x16x32_bf16 v[132:135], a[248:251], a[12:15], v[132:135]
  buffer_load_dwordx4 v241, s[12:15], s65 offen offset:1024 lds
  v_mfma_f32_16x16x32_bf16 v[136:139], a[248:251], a[152:155], v[136:139]
  v_rcp_f32 v18, v18
  v_mfma_f32_16x16x32_bf16 v[140:143], a[248:251], a[156:159], v[140:143]
  v_mul_f32 v114, v114, v18
  v_mul_f32 v18, 0xbfb8aa3b, v122
  v_mfma_f32_16x16x32_bf16 v[144:147], a[252:255], a[8:11], v[144:147]
  ds_read_b64_tr_b16 a[248:249], v2 offset:12288
  ds_read_b64_tr_b16 a[250:251], v2 offset:12800
  v_mfma_f32_16x16x32_bf16 v[148:151], a[252:255], a[12:15], v[148:151]
  buffer_load_dwordx4 v242, s[12:15], s65 offen offset:2048 lds
  v_mfma_f32_16x16x32_bf16 v[152:155], a[252:255], a[152:155], v[152:155]
  v_exp_f32 v19, v19
  v_mfma_f32_16x16x32_bf16 v[156:159], a[252:255], a[156:159], v[156:159]
  v_add_f32 v19, 1.0, v19
  s_waitcnt lgkmcnt(2)
  v_mfma_f32_16x16x32_bf16 v[128:131], a[240:243], a[16:19], v[128:131]
  ds_read_b64_tr_b16 a[252:253], v3 offset:12288
  ds_read_b64_tr_b16 a[254:255], v3 offset:12800
  v_mfma_f32_16x16x32_bf16 v[132:135], a[240:243], a[20:23], v[132:135]
  buffer_load_dwordx4 v243, s[12:15], s65 offen offset:3072 lds
  v_mfma_f32_16x16x32_bf16 v[136:139], a[240:243], a[160:163], v[136:139]
  v_rcp_f32 v19, v19
  v_mfma_f32_16x16x32_bf16 v[140:143], a[240:243], a[164:167], v[140:143]
  v_mul_f32 v115, v115, v19
  v_mul_f32 v19, 0xbfb8aa3b, v123
  v_mfma_f32_16x16x32_bf16 v[144:147], a[244:247], a[16:19], v[144:147]
  ds_read_b64_tr_b16 a[240:241], v2 offset:16384
  ds_read_b64_tr_b16 a[242:243], v2 offset:16896
  v_mfma_f32_16x16x32_bf16 v[148:151], a[244:247], a[20:23], v[148:151]
  s_add_u32 s66, s52, 3834240
  s_add_u32 m0, s63, 126976
  v_mfma_f32_16x16x32_bf16 v[152:155], a[244:247], a[160:163], v[152:155]
  buffer_load_dwordx4 v240, s[12:15], s66 offen lds
  v_mfma_f32_16x16x32_bf16 v[156:159], a[244:247], a[164:167], v[156:159]
  v_exp_f32 v20, v20
  s_waitcnt lgkmcnt(2)
  v_mfma_f32_16x16x32_bf16 v[128:131], a[248:251], a[24:27], v[128:131]
  ds_read_b64_tr_b16 a[244:245], v3 offset:16384
  ds_read_b64_tr_b16 a[246:247], v3 offset:16896
  v_mfma_f32_16x16x32_bf16 v[132:135], a[248:251], a[28:31], v[132:135]
  v_add_f32 v20, 1.0, v20
  v_mfma_f32_16x16x32_bf16 v[136:139], a[248:251], a[168:171], v[136:139]
  buffer_load_dwordx4 v241, s[12:15], s66 offen offset:1024 lds
  v_mfma_f32_16x16x32_bf16 v[140:143], a[248:251], a[172:175], v[140:143]
  v_rcp_f32 v20, v20
  v_mfma_f32_16x16x32_bf16 v[144:147], a[252:255], a[24:27], v[144:147]
  ds_read_b64_tr_b16 a[248:249], v2 offset:20480
  ds_read_b64_tr_b16 a[250:251], v2 offset:20992
  v_mfma_f32_16x16x32_bf16 v[148:151], a[252:255], a[28:31], v[148:151]
  v_mul_f32 v116, v116, v20
  v_mul_f32 v20, 0xbfb8aa3b, v124
  v_mfma_f32_16x16x32_bf16 v[152:155], a[252:255], a[168:171], v[152:155]
  buffer_load_dwordx4 v242, s[12:15], s66 offen offset:2048 lds
  v_mfma_f32_16x16x32_bf16 v[156:159], a[252:255], a[172:175], v[156:159]
  v_exp_f32 v21, v21
  s_waitcnt lgkmcnt(2)
  v_mfma_f32_16x16x32_bf16 v[128:131], a[240:243], a[32:35], v[128:131]
  ds_read_b64_tr_b16 a[252:253], v3 offset:20480
  ds_read_b64_tr_b16 a[254:255], v3 offset:20992
  v_mfma_f32_16x16x32_bf16 v[132:135], a[240:243], a[36:39], v[132:135]
  v_add_f32 v21, 1.0, v21
  v_mfma_f32_16x16x32_bf16 v[136:139], a[240:243], a[176:179], v[136:139]
  buffer_load_dwordx4 v243, s[12:15], s66 offen offset:3072 lds
  v_mfma_f32_16x16x32_bf16 v[140:143], a[240:243], a[180:183], v[140:143]
  v_rcp_f32 v21, v21
  v_mfma_f32_16x16x32_bf16 v[144:147], a[244:247], a[32:35], v[144:147]
  ds_read_b64_tr_b16 a[240:241], v2 offset:24576
  ds_read_b64_tr_b16 a[242:243], v2 offset:25088
  v_mfma_f32_16x16x32_bf16 v[148:151], a[244:247], a[36:39], v[148:151]
  v_mul_f32 v117, v117, v21
  v_mul_f32 v21, 0xbfb8aa3b, v125
  v_mfma_f32_16x16x32_bf16 v[152:155], a[244:247], a[176:179], v[152:155]
  s_add_u32 s67, s53, 2654592
  s_add_u32 m0, s64, 110592
  v_mfma_f32_16x16x32_bf16 v[156:159], a[244:247], a[180:183], v[156:159]
  v_exp_f32 v22, v22
  s_waitcnt lgkmcnt(2)
  v_mfma_f32_16x16x32_bf16 v[128:131], a[248:251], a[40:43], v[128:131]
  ds_read_b64_tr_b16 a[244:245], v3 offset:24576
  ds_read_b64_tr_b16 a[246:247], v3 offset:25088
  v_mfma_f32_16x16x32_bf16 v[132:135], a[248:251], a[44:47], v[132:135]
  buffer_load_dwordx4 v11, s[12:15], s67 offen lds
  v_add_f32 v22, 1.0, v22
  v_mfma_f32_16x16x32_bf16 v[136:139], a[248:251], a[184:187], v[136:139]
  v_rcp_f32 v22, v22
  v_mfma_f32_16x16x32_bf16 v[140:143], a[248:251], a[188:191], v[140:143]
  v_mul_f32 v118, v118, v22
  v_mul_f32 v22, 0xbfb8aa3b, v126
  v_mfma_f32_16x16x32_bf16 v[144:147], a[252:255], a[40:43], v[144:147]
  ds_read_b64_tr_b16 a[248:249], v2 offset:28672
  ds_read_b64_tr_b16 a[250:251], v2 offset:29184
  v_mfma_f32_16x16x32_bf16 v[148:151], a[252:255], a[44:47], v[148:151]
  v_exp_f32 v23, v23
  v_mfma_f32_16x16x32_bf16 v[152:155], a[252:255], a[184:187], v[152:155]
  v_add_f32 v23, 1.0, v23
  v_mul_f32 v96, v96, v160
  v_mfma_f32_16x16x32_bf16 v[156:159], a[252:255], a[188:191], v[156:159]
  v_rcp_f32 v23, v23
  s_waitcnt lgkmcnt(2)
  v_mfma_f32_16x16x32_bf16 v[128:131], a[240:243], a[48:51], v[128:131]
  ds_read_b64_tr_b16 a[252:253], v3 offset:28672
  ds_read_b64_tr_b16 a[254:255], v3 offset:29184
  v_mfma_f32_16x16x32_bf16 v[132:135], a[240:243], a[52:55], v[132:135]
  v_mul_f32 v119, v119, v23
  v_mul_f32 v23, 0xbfb8aa3b, v127
  v_mfma_f32_16x16x32_bf16 v[136:139], a[240:243], a[192:195], v[136:139]
  s_add_u32 s6, s68, 4096
  buffer_store_dwordx4 v[44:47], v1, s[24:27], s6 offen offset:1024 sc1
  v_mfma_f32_16x16x32_bf16 v[140:143], a[240:243], a[196:199], v[140:143]
  v_exp_f32 v16, v16
  v_mfma_f32_16x16x32_bf16 v[144:147], a[244:247], a[48:51], v[144:147]
  ds_read_b64_tr_b16 a[240:241], v2 offset:32768
  ds_read_b64_tr_b16 a[242:243], v2 offset:33280
  v_mfma_f32_16x16x32_bf16 v[148:151], a[244:247], a[52:55], v[148:151]
  v_add_f32 v16, 1.0, v16
  v_mul_f32 v97, v97, v161
  v_mfma_f32_16x16x32_bf16 v[152:155], a[244:247], a[192:195], v[152:155]
  v_rcp_f32 v16, v16
  v_mfma_f32_16x16x32_bf16 v[156:159], a[244:247], a[196:199], v[156:159]
  v_mul_f32 v120, v120, v16
  v_cvt_pk_bf16_f32 v56, v96, v97
  s_waitcnt lgkmcnt(2)
  v_mfma_f32_16x16x32_bf16 v[128:131], a[248:251], a[56:59], v[128:131]
  ds_read_b64_tr_b16 a[244:245], v3 offset:32768
  ds_read_b64_tr_b16 a[246:247], v3 offset:33280
  v_mfma_f32_16x16x32_bf16 v[132:135], a[248:251], a[60:63], v[132:135]
  v_exp_f32 v17, v17
  v_mfma_f32_16x16x32_bf16 v[136:139], a[248:251], a[200:203], v[136:139]
  v_add_f32 v17, 1.0, v17
  v_mul_f32 v98, v98, v162
  v_mfma_f32_16x16x32_bf16 v[140:143], a[248:251], a[204:207], v[140:143]
  v_rcp_f32 v17, v17
  v_mfma_f32_16x16x32_bf16 v[144:147], a[252:255], a[56:59], v[144:147]
  v_mul_f32 v121, v121, v17
  v_mul_f32 v99, v99, v163
  v_mfma_f32_16x16x32_bf16 v[148:151], a[252:255], a[60:63], v[148:151]
  v_exp_f32 v18, v18
  v_mfma_f32_16x16x32_bf16 v[152:155], a[252:255], a[200:203], v[152:155]
  v_mfma_f32_16x16x32_bf16 v[156:159], a[252:255], a[204:207], v[156:159]
  s_waitcnt vmcnt(26) lgkmcnt(0)
  s_barrier
  v_add_u32 v2, 36864, v6
  v_xor_b32 v3, 32, v2
  v_mfma_f32_16x16x32_bf16 v[128:131], a[240:243], a[64:67], v[128:131]
  ds_read_b64_tr_b16 a[248:249], v2 offset:0
  ds_read_b64_tr_b16 a[250:251], v2 offset:512
  v_mfma_f32_16x16x32_bf16 v[132:135], a[240:243], a[68:71], v[132:135]
  ds_read_b64_tr_b16 a[252:253], v3 offset:0
  ds_read_b64_tr_b16 a[254:255], v3 offset:512
  v_mfma_f32_16x16x32_bf16 v[136:139], a[240:243], a[208:211], v[136:139]
  v_add_f32 v18, 1.0, v18
  v_cvt_pk_bf16_f32 v57, v98, v99
  v_mfma_f32_16x16x32_bf16 v[140:143], a[240:243], a[212:215], v[140:143]
  v_rcp_f32 v18, v18
  v_mfma_f32_16x16x32_bf16 v[144:147], a[244:247], a[64:67], v[144:147]
  ds_read_b64_tr_b16 a[240:241], v2 offset:4096
  ds_read_b64_tr_b16 a[242:243], v2 offset:4608
  v_mfma_f32_16x16x32_bf16 v[148:151], a[244:247], a[68:71], v[148:151]
  v_mul_f32 v122, v122, v18
  v_mul_f32 v112, v112, v176
  v_mfma_f32_16x16x32_bf16 v[152:155], a[244:247], a[208:211], v[152:155]
  v_exp_f32 v19, v19
  v_mfma_f32_16x16x32_bf16 v[156:159], a[244:247], a[212:215], v[156:159]
  v_add_f32 v19, 1.0, v19
  v_mul_f32 v113, v113, v177
  s_waitcnt lgkmcnt(2)
  v_mfma_f32_16x16x32_bf16 v[128:131], a[248:251], a[72:75], v[128:131]
  ds_read_b64_tr_b16 a[244:245], v3 offset:4096
  ds_read_b64_tr_b16 a[246:247], v3 offset:4608
  v_mfma_f32_16x16x32_bf16 v[132:135], a[248:251], a[76:79], v[132:135]
  v_rcp_f32 v19, v19
  v_mfma_f32_16x16x32_bf16 v[136:139], a[248:251], a[216:219], v[136:139]
  s_add_u32 s65, s54, 0
  s_add_u32 m0, s63, 0
  v_mfma_f32_16x16x32_bf16 v[140:143], a[248:251], a[220:223], v[140:143]
  v_mul_f32 v123, v123, v19
  v_cvt_pk_bf16_f32 v58, v112, v113
  v_mfma_f32_16x16x32_bf16 v[144:147], a[252:255], a[72:75], v[144:147]
  ds_read_b64_tr_b16 a[248:249], v2 offset:8192
  ds_read_b64_tr_b16 a[250:251], v2 offset:8704
  v_mfma_f32_16x16x32_bf16 v[148:151], a[252:255], a[76:79], v[148:151]
  buffer_load_dwordx4 v244, s[8:11], s65 offen lds
  v_mul_f32 v114, v114, v178
  v_mfma_f32_16x16x32_bf16 v[152:155], a[252:255], a[216:219], v[152:155]
  v_exp_f32 v20, v20
  v_mfma_f32_16x16x32_bf16 v[156:159], a[252:255], a[220:223], v[156:159]
  v_add_f32 v20, 1.0, v20
  v_mul_f32 v115, v115, v179
  s_waitcnt lgkmcnt(2)
  v_mfma_f32_16x16x32_bf16 v[128:131], a[240:243], a[80:83], v[128:131]
  ds_read_b64_tr_b16 a[252:253], v3 offset:8192
  ds_read_b64_tr_b16 a[254:255], v3 offset:8704
  v_mfma_f32_16x16x32_bf16 v[132:135], a[240:243], a[84:87], v[132:135]
  buffer_load_dwordx4 v245, s[8:11], s65 offen offset:1024 lds
  v_cvt_pk_bf16_f32 v59, v114, v115
  v_mfma_f32_16x16x32_bf16 v[136:139], a[240:243], a[224:227], v[136:139]
  v_rcp_f32 v20, v20
  v_mfma_f32_16x16x32_bf16 v[140:143], a[240:243], a[228:231], v[140:143]
  v_mul_f32 v124, v124, v20
  v_mul_f32 v100, v100, v164
  v_mfma_f32_16x16x32_bf16 v[144:147], a[244:247], a[80:83], v[144:147]
  ds_read_b64_tr_b16 a[240:241], v2 offset:12288
  ds_read_b64_tr_b16 a[242:243], v2 offset:12800
  v_mfma_f32_16x16x32_bf16 v[148:151], a[244:247], a[84:87], v[148:151]
  buffer_load_dwordx4 v246, s[8:11], s65 offen offset:2048 lds
  v_mul_f32 v101, v101, v165
  v_mfma_f32_16x16x32_bf16 v[152:155], a[244:247], a[224:227], v[152:155]
  v_exp_f32 v21, v21
  v_mfma_f32_16x16x32_bf16 v[156:159], a[244:247], a[228:231], v[156:159]
  v_add_f32 v21, 1.0, v21
  v_cvt_pk_bf16_f32 v60, v100, v101
  s_waitcnt lgkmcnt(2)
  v_mfma_f32_16x16x32_bf16 v[128:131], a[248:251], a[88:91], v[128:131]
  ds_read_b64_tr_b16 a[244:245], v3 offset:12288
  ds_read_b64_tr_b16 a[246:247], v3 offset:12800
  v_mfma_f32_16x16x32_bf16 v[132:135], a[248:251], a[92:95], v[132:135]
  buffer_load_dwordx4 v247, s[8:11], s65 offen offset:3072 lds
  v_mul_f32 v102, v102, v166
  v_mfma_f32_16x16x32_bf16 v[136:139], a[248:251], a[232:235], v[136:139]
  v_rcp_f32 v21, v21
  v_mfma_f32_16x16x32_bf16 v[140:143], a[248:251], a[236:239], v[140:143]
  v_mul_f32 v125, v125, v21
  v_mul_f32 v103, v103, v167
  v_mfma_f32_16x16x32_bf16 v[144:147], a[252:255], a[88:91], v[144:147]
  ds_read_b64_tr_b16 a[248:249], v2 offset:16384
  ds_read_b64_tr_b16 a[250:251], v2 offset:16896
  v_mfma_f32_16x16x32_bf16 v[148:151], a[252:255], a[92:95], v[148:151]
  s_add_u32 s66, s54, 2359296
  s_add_u32 m0, s63, 16384
  v_mfma_f32_16x16x32_bf16 v[152:155], a[252:255], a[232:235], v[152:155]
  buffer_load_dwordx4 v244, s[8:11], s66 offen lds
  v_cvt_pk_bf16_f32 v61, v102, v103
  v_mfma_f32_16x16x32_bf16 v[156:159], a[252:255], a[236:239], v[156:159]
  v_exp_f32 v22, v22
  s_waitcnt lgkmcnt(2)
  v_mfma_f32_16x16x32_bf16 v[128:131], a[240:243], a[96:99], v[128:131]
  ds_read_b64_tr_b16 a[252:253], v3 offset:16384
  ds_read_b64_tr_b16 a[254:255], v3 offset:16896
  v_mfma_f32_16x16x32_bf16 v[132:135], a[240:243], a[100:103], v[132:135]
  v_add_f32 v22, 1.0, v22
  v_mul_f32 v116, v116, v180
  v_mfma_f32_16x16x32_bf16 v[136:139], a[240:243], v[192:195], v[136:139]
  buffer_load_dwordx4 v245, s[8:11], s66 offen offset:1024 lds
  v_mul_f32 v117, v117, v181
  v_mfma_f32_16x16x32_bf16 v[140:143], a[240:243], v[196:199], v[140:143]
  v_rcp_f32 v22, v22
  v_mfma_f32_16x16x32_bf16 v[144:147], a[244:247], a[96:99], v[144:147]
  ds_read_b64_tr_b16 a[240:241], v2 offset:20480
  ds_read_b64_tr_b16 a[242:243], v2 offset:20992
  v_mfma_f32_16x16x32_bf16 v[148:151], a[244:247], a[100:103], v[148:151]
  v_mul_f32 v126, v126, v22
  v_cvt_pk_bf16_f32 v62, v116, v117
  v_mfma_f32_16x16x32_bf16 v[152:155], a[244:247], v[192:195], v[152:155]
  buffer_load_dwordx4 v246, s[8:11], s66 offen offset:2048 lds
  v_mul_f32 v118, v118, v182
  v_mfma_f32_16x16x32_bf16 v[156:159], a[244:247], v[196:199], v[156:159]
  v_exp_f32 v23, v23
  s_waitcnt lgkmcnt(2)
  v_mfma_f32_16x16x32_bf16 v[128:131], a[248:251], a[104:107], v[128:131]
  ds_read_b64_tr_b16 a[244:245], v3 offset:20480
  ds_read_b64_tr_b16 a[246:247], v3 offset:20992
  v_mfma_f32_16x16x32_bf16 v[132:135], a[248:251], a[108:111], v[132:135]
  v_add_f32 v23, 1.0, v23
  v_mul_f32 v119, v119, v183
  v_mfma_f32_16x16x32_bf16 v[136:139], a[248:251], v[200:203], v[136:139]
  buffer_load_dwordx4 v247, s[8:11], s66 offen offset:3072 lds
  v_cvt_pk_bf16_f32 v63, v118, v119
  v_mfma_f32_16x16x32_bf16 v[140:143], a[248:251], v[204:207], v[140:143]
  v_rcp_f32 v23, v23
  v_mfma_f32_16x16x32_bf16 v[144:147], a[252:255], a[104:107], v[144:147]
  ds_read_b64_tr_b16 a[248:249], v2 offset:24576
  ds_read_b64_tr_b16 a[250:251], v2 offset:25088
  v_mfma_f32_16x16x32_bf16 v[148:151], a[252:255], a[108:111], v[148:151]
  v_mul_f32 v127, v127, v23
  v_mul_f32 v104, v104, v168
  v_mfma_f32_16x16x32_bf16 v[152:155], a[252:255], v[200:203], v[152:155]
  s_add_u32 s67, s55, 0
  s_add_u32 m0, s64, 0
  v_mfma_f32_16x16x32_bf16 v[156:159], a[252:255], v[204:207], v[156:159]
  v_mul_f32 v105, v105, v169
  v_cvt_pk_bf16_f32 v104, v104, v105
  s_waitcnt lgkmcnt(2)
  v_mfma_f32_16x16x32_bf16 v[128:131], a[240:243], a[112:115], v[128:131]
  ds_read_b64_tr_b16 a[252:253], v3 offset:24576
  ds_read_b64_tr_b16 a[254:255], v3 offset:25088
  v_mfma_f32_16x16x32_bf16 v[132:135], a[240:243], a[116:119], v[132:135]
  buffer_load_dwordx4 v244, s[8:11], s67 offen lds
  v_mul_f32 v106, v106, v170
  v_mfma_f32_16x16x32_bf16 v[136:139], a[240:243], v[208:211], v[136:139]
  v_mul_f32 v107, v107, v171
  v_cvt_pk_bf16_f32 v105, v106, v107
  v_mfma_f32_16x16x32_bf16 v[140:143], a[240:243], v[212:215], v[140:143]
  v_mul_f32 v120, v120, v184
  v_mul_f32 v121, v121, v185
  v_mfma_f32_16x16x32_bf16 v[144:147], a[244:247], a[112:115], v[144:147]
  ds_read_b64_tr_b16 a[240:241], v2 offset:28672
  ds_read_b64_tr_b16 a[242:243], v2 offset:29184
  v_mfma_f32_16x16x32_bf16 v[148:151], a[244:247], a[116:119], v[148:151]
  v_cvt_pk_bf16_f32 v106, v120, v121
  v_mul_f32 v122, v122, v186
  v_mfma_f32_16x16x32_bf16 v[152:155], a[244:247], v[208:211], v[152:155]
  v_mul_f32 v123, v123, v187
  v_cvt_pk_bf16_f32 v107, v122, v123
  v_mfma_f32_16x16x32_bf16 v[156:159], a[244:247], v[212:215], v[156:159]
  ds_write_b128 v4, v[104:107] offset:0
  v_mul_f32 v108, v108, v172
  s_waitcnt lgkmcnt(3)
  v_mfma_f32_16x16x32_bf16 v[128:131], a[248:251], a[120:123], v[128:131]
  ds_read_b64_tr_b16 a[244:245], v3 offset:28672
  ds_read_b64_tr_b16 a[246:247], v3 offset:29184
  v_mfma_f32_16x16x32_bf16 v[132:135], a[248:251], a[124:127], v[132:135]
  v_mul_f32 v109, v109, v173
  v_cvt_pk_bf16_f32 v108, v108, v109
  v_mfma_f32_16x16x32_bf16 v[136:139], a[248:251], v[216:219], v[136:139]
  s_add_u32 s6, s68, 4096
  buffer_store_dwordx4 v[48:51], v1, s[24:27], s6 offen offset:2048 sc1
  v_mfma_f32_16x16x32_bf16 v[140:143], a[248:251], v[220:223], v[140:143]
  v_mul_f32 v110, v110, v174
  v_mul_f32 v111, v111, v175
  v_mfma_f32_16x16x32_bf16 v[144:147], a[252:255], a[120:123], v[144:147]
  ds_read_b64_tr_b16 a[248:249], v2 offset:32768
  ds_read_b64_tr_b16 a[250:251], v2 offset:33280
  v_mfma_f32_16x16x32_bf16 v[148:151], a[252:255], a[124:127], v[148:151]
  v_cvt_pk_bf16_f32 v109, v110, v111
  v_mul_f32 v124, v124, v188
  v_mfma_f32_16x16x32_bf16 v[152:155], a[252:255], v[216:219], v[152:155]
  v_mul_f32 v125, v125, v189
  v_cvt_pk_bf16_f32 v110, v124, v125
  v_mfma_f32_16x16x32_bf16 v[156:159], a[252:255], v[220:223], v[156:159]
  v_mul_f32 v126, v126, v190
  v_mul_f32 v127, v127, v191
  s_waitcnt lgkmcnt(2)
  v_mfma_f32_16x16x32_bf16 v[128:131], a[240:243], a[128:131], v[128:131]
  ds_read_b64_tr_b16 a[252:253], v3 offset:32768
  ds_read_b64_tr_b16 a[254:255], v3 offset:33280
  v_mfma_f32_16x16x32_bf16 v[132:135], a[240:243], a[132:135], v[132:135]
  v_cvt_pk_bf16_f32 v111, v126, v127
  ds_write_b128 v4, v[108:111] offset:1024
  v_mfma_f32_16x16x32_bf16 v[136:139], a[240:243], v[224:227], v[136:139]
  v_mfma_f32_16x16x32_bf16 v[140:143], a[240:243], v[228:231], v[140:143]
  v_mfma_f32_16x16x32_bf16 v[144:147], a[244:247], a[128:131], v[144:147]
  v_mfma_f32_16x16x32_bf16 v[148:151], a[244:247], a[132:135], v[148:151]
  v_mfma_f32_16x16x32_bf16 v[152:155], a[244:247], v[224:227], v[152:155]
  v_mfma_f32_16x16x32_bf16 v[156:159], a[244:247], v[228:231], v[156:159]
  s_waitcnt vmcnt(24) lgkmcnt(0)
  s_barrier
  v_add_u32 v2, 73728, v6
  v_xor_b32 v3, 32, v2
  v_mfma_f32_16x16x32_bf16 v[128:131], a[248:251], a[136:139], v[128:131]
  ds_read_b64_tr_b16 a[240:241], v2 offset:0
  ds_read_b64_tr_b16 a[242:243], v2 offset:512
  v_mfma_f32_16x16x32_bf16 v[132:135], a[248:251], a[140:143], v[132:135]
  ds_read_b64_tr_b16 a[244:245], v3 offset:0
  ds_read_b64_tr_b16 a[246:247], v3 offset:512
  v_mfma_f32_16x16x32_bf16 v[136:139], a[248:251], v[232:235], v[136:139]
  v_mfma_f32_16x16x32_bf16 v[140:143], a[248:251], v[236:239], v[140:143]
  v_mfma_f32_16x16x32_bf16 v[144:147], a[252:255], a[136:139], v[144:147]
  ds_read_b64_tr_b16 a[248:249], v2 offset:4096
  ds_read_b64_tr_b16 a[250:251], v2 offset:4608
  v_mfma_f32_16x16x32_bf16 v[148:151], a[252:255], a[140:143], v[148:151]
  v_mfma_f32_16x16x32_bf16 v[152:155], a[252:255], v[232:235], v[152:155]
  v_mfma_f32_16x16x32_bf16 v[156:159], a[252:255], v[236:239], v[156:159]
  s_waitcnt lgkmcnt(2)
  v_mfma_f32_16x16x32_bf16 v[160:163], a[240:243], a[0:3], 0
  ds_read_b64_tr_b16 a[252:253], v3 offset:4096
  ds_read_b64_tr_b16 a[254:255], v3 offset:4608
  v_mfma_f32_16x16x32_bf16 v[164:167], a[240:243], a[4:7], 0
  v_mfma_f32_16x16x32_bf16 v[168:171], a[240:243], a[144:147], 0
  s_add_u32 s65, s54, 0
  s_add_u32 m0, s63, 36864
  v_mfma_f32_16x16x32_bf16 v[172:175], a[240:243], a[148:151], 0
  v_mfma_f32_16x16x32_bf16 v[176:179], a[244:247], a[0:3], 0
  ds_read_b64_tr_b16 a[240:241], v2 offset:8192
  ds_read_b64_tr_b16 a[242:243], v2 offset:8704
  v_mfma_f32_16x16x32_bf16 v[180:183], a[244:247], a[4:7], 0
  buffer_load_dwordx4 v244, s[12:15], s65 offen lds
  v_mfma_f32_16x16x32_bf16 v[184:187], a[244:247], a[144:147], 0
  v_mul_f32 v16, 0xbfb8aa3b, v128
  v_mul_f32 v17, 0xbfb8aa3b, v129
  v_mfma_f32_16x16x32_bf16 v[188:191], a[244:247], a[148:151], 0
  v_exp_f32 v16, v16
  s_waitcnt lgkmcnt(2)
  v_mfma_f32_16x16x32_bf16 v[160:163], a[248:251], a[8:11], v[160:163]
  ds_read_b64_tr_b16 a[244:245], v3 offset:8192
  ds_read_b64_tr_b16 a[246:247], v3 offset:8704
  v_mfma_f32_16x16x32_bf16 v[164:167], a[248:251], a[12:15], v[164:167]
  buffer_load_dwordx4 v245, s[12:15], s65 offen offset:1024 lds
  v_add_f32 v16, 1.0, v16
  v_mfma_f32_16x16x32_bf16 v[168:171], a[248:251], a[152:155], v[168:171]
  v_rcp_f32 v16, v16
  v_mfma_f32_16x16x32_bf16 v[172:175], a[248:251], a[156:159], v[172:175]
  v_mul_f32 v128, v128, v16
  v_mul_f32 v18, 0xbfb8aa3b, v130
  v_mfma_f32_16x16x32_bf16 v[176:179], a[252:255], a[8:11], v[176:179]
  ds_read_b64_tr_b16 a[248:249], v2 offset:12288
  ds_read_b64_tr_b16 a[250:251], v2 offset:12800
  v_mfma_f32_16x16x32_bf16 v[180:183], a[252:255], a[12:15], v[180:183]
  buffer_load_dwordx4 v246, s[12:15], s65 offen offset:2048 lds
  v_mul_f32 v19, 0xbfb8aa3b, v131
  v_mfma_f32_16x16x32_bf16 v[184:187], a[252:255], a[152:155], v[184:187]
  v_exp_f32 v17, v17
  v_mfma_f32_16x16x32_bf16 v[188:191], a[252:255], a[156:159], v[188:191]
  v_add_f32 v17, 1.0, v17
  v_mul_f32 v20, 0xbfb8aa3b, v132
  s_waitcnt lgkmcnt(2)
  v_mfma_f32_16x16x32_bf16 v[160:163], a[240:243], a[16:19], v[160:163]
  ds_read_b64_tr_b16 a[252:253], v3 offset:12288
  ds_read_b64_tr_b16 a[254:255], v3 offset:12800
  v_mfma_f32_16x16x32_bf16 v[164:167], a[240:243], a[20:23], v[164:167]
  buffer_load_dwordx4 v247, s[12:15], s65 offen offset:3072 lds
  v_mul_f32 v21, 0xbfb8aa3b, v133
  v_mfma_f32_16x16x32_bf16 v[168:171], a[240:243], a[160:163], v[168:171]
  v_rcp_f32 v17, v17
  v_mfma_f32_16x16x32_bf16 v[172:175], a[240:243], a[164:167], v[172:175]
  v_mul_f32 v129, v129, v17
  v_mul_f32 v22, 0xbfb8aa3b, v134
  v_mfma_f32_16x16x32_bf16 v[176:179], a[244:247], a[16:19], v[176:179]
  ds_read_b64_tr_b16 a[240:241], v2 offset:16384
  ds_read_b64_tr_b16 a[242:243], v2 offset:16896
  v_mfma_f32_16x16x32_bf16 v[180:183], a[244:247], a[20:23], v[180:183]
  s_add_u32 s66, s54, 2359296
  s_add_u32 m0, s63, 53248
  v_mfma_f32_16x16x32_bf16 v[184:187], a[244:247], a[160:163], v[184:187]
  buffer_load_dwordx4 v244, s[12:15], s66 offen lds
  v_mul_f32 v23, 0xbfb8aa3b, v135
  v_mfma_f32_16x16x32_bf16 v[188:191], a[244:247], a[164:167], v[188:191]
  v_exp_f32 v18, v18
  s_waitcnt lgkmcnt(2)
  v_mfma_f32_16x16x32_bf16 v[160:163], a[248:251], a[24:27], v[160:163]
  ds_read_b64_tr_b16 a[244:245], v3 offset:16384
  ds_read_b64_tr_b16 a[246:247], v3 offset:16896
  v_mfma_f32_16x16x32_bf16 v[164:167], a[248:251], a[28:31], v[164:167]
  v_add_f32 v18, 1.0, v18
  v_mul_f32 v16, 0xbfb8aa3b, v136
  v_mfma_f32_16x16x32_bf16 v[168:171], a[248:251], a[168:171], v[168:171]
  buffer_load_dwordx4 v245, s[12:15], s66 offen offset:1024 lds
  v_mul_f32 v17, 0xbfb8aa3b, v137
  v_mfma_f32_16x16x32_bf16 v[172:175], a[248:251], a[172:175], v[172:175]
  v_rcp_f32 v18, v18
  v_mfma_f32_16x16x32_bf16 v[176:179], a[252:255], a[24:27], v[176:179]
  ds_read_b64_tr_b16 a[248:249], v2 offset:20480
  ds_read_b64_tr_b16 a[250:251], v2 offset:20992
  v_mfma_f32_16x16x32_bf16 v[180:183], a[252:255], a[28:31], v[180:183]
  v_mul_f32 v130, v130, v18
  v_mul_f32 v18, 0xbfb8aa3b, v138
  v_mfma_f32_16x16x32_bf16 v[184:187], a[252:255], a[168:171], v[184:187]
  buffer_load_dwordx4 v246, s[12:15], s66 offen offset:2048 lds
  v_mfma_f32_16x16x32_bf16 v[188:191], a[252:255], a[172:175], v[188:191]
  v_exp_f32 v19, v19
  s_waitcnt lgkmcnt(2)
  v_mfma_f32_16x16x32_bf16 v[160:163], a[240:243], a[32:35], v[160:163]
  ds_read_b64_tr_b16 a[252:253], v3 offset:20480
  ds_read_b64_tr_b16 a[254:255], v3 offset:20992
  v_mfma_f32_16x16x32_bf16 v[164:167], a[240:243], a[36:39], v[164:167]
  v_add_f32 v19, 1.0, v19
  v_mfma_f32_16x16x32_bf16 v[168:171], a[240:243], a[176:179], v[168:171]
  buffer_load_dwordx4 v247, s[12:15], s66 offen offset:3072 lds
  v_mfma_f32_16x16x32_bf16 v[172:175], a[240:243], a[180:183], v[172:175]
  v_rcp_f32 v19, v19
  v_mfma_f32_16x16x32_bf16 v[176:179], a[244:247], a[32:35], v[176:179]
  ds_read_b64_tr_b16 a[240:241], v2 offset:24576
  ds_read_b64_tr_b16 a[242:243], v2 offset:25088
  v_mfma_f32_16x16x32_bf16 v[180:183], a[244:247], a[36:39], v[180:183]
  v_mul_f32 v131, v131, v19
  v_mul_f32 v19, 0xbfb8aa3b, v139
  v_mfma_f32_16x16x32_bf16 v[184:187], a[244:247], a[176:179], v[184:187]
  s_add_u32 s67, s55, 0
  s_add_u32 m0, s64, 36864
  v_mfma_f32_16x16x32_bf16 v[188:191], a[244:247], a[180:183], v[188:191]
  v_exp_f32 v20, v20
  s_waitcnt lgkmcnt(2)
  v_mfma_f32_16x16x32_bf16 v[160:163], a[248:251], a[40:43], v[160:163]
  ds_read_b64_tr_b16 a[244:245], v3 offset:24576
  ds_read_b64_tr_b16 a[246:247], v3 offset:25088
  v_mfma_f32_16x16x32_bf16 v[164:167], a[248:251], a[44:47], v[164:167]
  buffer_load_dwordx4 v244, s[12:15], s67 offen lds
  v_add_f32 v20, 1.0, v20
  v_mfma_f32_16x16x32_bf16 v[168:171], a[248:251], a[184:187], v[168:171]
  v_rcp_f32 v20, v20
  v_mfma_f32_16x16x32_bf16 v[172:175], a[248:251], a[188:191], v[172:175]
  v_mul_f32 v132, v132, v20
  v_mul_f32 v20, 0xbfb8aa3b, v140
  v_mfma_f32_16x16x32_bf16 v[176:179], a[252:255], a[40:43], v[176:179]
  ds_read_b64_tr_b16 a[248:249], v2 offset:28672
  ds_read_b64_tr_b16 a[250:251], v2 offset:29184
  v_mfma_f32_16x16x32_bf16 v[180:183], a[252:255], a[44:47], v[180:183]
  v_exp_f32 v21, v21
  v_mfma_f32_16x16x32_bf16 v[184:187], a[252:255], a[184:187], v[184:187]
  v_add_f32 v21, 1.0, v21
  v_mfma_f32_16x16x32_bf16 v[188:191], a[252:255], a[188:191], v[188:191]
  v_rcp_f32 v21, v21
  s_waitcnt lgkmcnt(2)
  v_mfma_f32_16x16x32_bf16 v[160:163], a[240:243], a[48:51], v[160:163]
  ds_read_b64_tr_b16 a[252:253], v3 offset:28672
  ds_read_b64_tr_b16 a[254:255], v3 offset:29184
  v_mfma_f32_16x16x32_bf16 v[164:167], a[240:243], a[52:55], v[164:167]
  v_mul_f32 v133, v133, v21
  v_mul_f32 v21, 0xbfb8aa3b, v141
  v_mfma_f32_16x16x32_bf16 v[168:171], a[240:243], a[192:195], v[168:171]
  s_add_u32 s6, s68, 4096
  buffer_store_dwordx4 v[52:55], v1, s[24:27], s6 offen offset:3072 sc1
  v_mfma_f32_16x16x32_bf16 v[172:175], a[240:243], a[196:199], v[172:175]
  v_exp_f32 v22, v22
  v_mfma_f32_16x16x32_bf16 v[176:179], a[244:247], a[48:51], v[176:179]
  ds_read_b64_tr_b16 a[240:241], v2 offset:32768
  ds_read_b64_tr_b16 a[242:243], v2 offset:33280
  v_mfma_f32_16x16x32_bf16 v[180:183], a[244:247], a[52:55], v[180:183]
  v_add_f32 v22, 1.0, v22
  v_mfma_f32_16x16x32_bf16 v[184:187], a[244:247], a[192:195], v[184:187]
  v_rcp_f32 v22, v22
  v_mfma_f32_16x16x32_bf16 v[188:191], a[244:247], a[196:199], v[188:191]
  v_mul_f32 v134, v134, v22
  v_mul_f32 v22, 0xbfb8aa3b, v142
  s_waitcnt lgkmcnt(2)
  v_mfma_f32_16x16x32_bf16 v[160:163], a[248:251], a[56:59], v[160:163]
  ds_read_b64_tr_b16 a[244:245], v3 offset:32768
  ds_read_b64_tr_b16 a[246:247], v3 offset:33280
  v_mfma_f32_16x16x32_bf16 v[164:167], a[248:251], a[60:63], v[164:167]
  v_exp_f32 v23, v23
  v_mfma_f32_16x16x32_bf16 v[168:171], a[248:251], a[200:203], v[168:171]
  v_add_f32 v23, 1.0, v23
  v_mfma_f32_16x16x32_bf16 v[172:175], a[248:251], a[204:207], v[172:175]
  v_rcp_f32 v23, v23
  v_mfma_f32_16x16x32_bf16 v[176:179], a[252:255], a[56:59], v[176:179]
  v_mul_f32 v135, v135, v23
  v_mul_f32 v23, 0xbfb8aa3b, v143
  v_mfma_f32_16x16x32_bf16 v[180:183], a[252:255], a[60:63], v[180:183]
  v_exp_f32 v16, v16
  v_mfma_f32_16x16x32_bf16 v[184:187], a[252:255], a[200:203], v[184:187]
  v_mfma_f32_16x16x32_bf16 v[188:191], a[252:255], a[204:207], v[188:191]
  s_waitcnt vmcnt(21) lgkmcnt(0)
  s_barrier
  ds_read_b128 v[64:67], v5 offset:0
  ds_read_b128 v[68:71], v5 offset:1024
  v_add_u32 v2, 110592, v6
  v_xor_b32 v3, 32, v2
  v_mfma_f32_16x16x32_bf16 v[160:163], a[240:243], a[64:67], v[160:163]
  ds_read_b64_tr_b16 a[248:249], v2 offset:0
  ds_read_b64_tr_b16 a[250:251], v2 offset:512
  v_mfma_f32_16x16x32_bf16 v[164:167], a[240:243], a[68:71], v[164:167]
  ds_read_b64_tr_b16 a[252:253], v3 offset:0
  ds_read_b64_tr_b16 a[254:255], v3 offset:512
  v_mfma_f32_16x16x32_bf16 v[168:171], a[240:243], a[208:211], v[168:171]
  v_add_f32 v16, 1.0, v16
  v_mfma_f32_16x16x32_bf16 v[172:175], a[240:243], a[212:215], v[172:175]
  v_rcp_f32 v16, v16
  v_mfma_f32_16x16x32_bf16 v[176:179], a[244:247], a[64:67], v[176:179]
  ds_read_b64_tr_b16 a[240:241], v2 offset:4096
  ds_read_b64_tr_b16 a[242:243], v2 offset:4608
  v_mfma_f32_16x16x32_bf16 v[180:183], a[244:247], a[68:71], v[180:183]
  v_mul_f32 v136, v136, v16
  v_mul_f32 v16, 0xbfb8aa3b, v144
  v_mfma_f32_16x16x32_bf16 v[184:187], a[244:247], a[208:211], v[184:187]
  v_exp_f32 v17, v17
  v_mfma_f32_16x16x32_bf16 v[188:191], a[244:247], a[212:215], v[188:191]
  v_add_f32 v17, 1.0, v17
  s_waitcnt lgkmcnt(2)
  v_mfma_f32_16x16x32_bf16 v[160:163], a[248:251], a[72:75], v[160:163]
  ds_read_b64_tr_b16 a[244:245], v3 offset:4096
  ds_read_b64_tr_b16 a[246:247], v3 offset:4608
  v_mfma_f32_16x16x32_bf16 v[164:167], a[248:251], a[76:79], v[164:167]
  v_rcp_f32 v17, v17
  v_mfma_f32_16x16x32_bf16 v[168:171], a[248:251], a[216:219], v[168:171]
  s_add_u32 s65, s56, 0
  s_add_u32 m0, s63, 73728
  v_mfma_f32_16x16x32_bf16 v[172:175], a[248:251], a[220:223], v[172:175]
  v_mul_f32 v137, v137, v17
  v_mul_f32 v17, 0xbfb8aa3b, v145
  v_mfma_f32_16x16x32_bf16 v[176:179], a[252:255], a[72:75], v[176:179]
  ds_read_b64_tr_b16 a[248:249], v2 offset:8192
  ds_read_b64_tr_b16 a[250:251], v2 offset:8704
  v_mfma_f32_16x16x32_bf16 v[180:183], a[252:255], a[76:79], v[180:183]
  buffer_load_dwordx4 v248, s[16:19], s65 offen lds
  s_waitcnt lgkmcnt(10)
  s_bitcmp1_b32 s48, 0
  s_cbranch_scc0 K1_nosw2
  v_swap_b32 v56, v64
  v_swap_b32 v57, v65
  v_swap_b32 v58, v66
  v_swap_b32 v59, v67
  v_swap_b32 v60, v68
  v_swap_b32 v61, v69
  v_swap_b32 v62, v70
  v_swap_b32 v63, v71
K1_nosw2:
  v_mfma_f32_16x16x32_bf16 v[184:187], a[252:255], a[216:219], v[184:187]
  v_exp_f32 v18, v18
  v_mfma_f32_16x16x32_bf16 v[188:191], a[252:255], a[220:223], v[188:191]
  v_add_f32 v18, 1.0, v18
  s_waitcnt lgkmcnt(2)
  v_mfma_f32_16x16x32_bf16 v[160:163], a[240:243], a[80:83], v[160:163]
  ds_read_b64_tr_b16 a[252:253], v3 offset:8192
  ds_read_b64_tr_b16 a[254:255], v3 offset:8704
  v_mfma_f32_16x16x32_bf16 v[164:167], a[240:243], a[84:87], v[164:167]
  buffer_load_dwordx4 v249, s[16:19], s65 offen offset:1024 lds
  v_mfma_f32_16x16x32_bf16 v[168:171], a[240:243], a[224:227], v[168:171]
  v_rcp_f32 v18, v18
  v_mfma_f32_16x16x32_bf16 v[172:175], a[240:243], a[228:231], v[172:175]
  v_mul_f32 v138, v138, v18
  v_mul_f32 v18, 0xbfb8aa3b, v146
  v_mfma_f32_16x16x32_bf16 v[176:179], a[244:247], a[80:83], v[176:179]
  ds_read_b64_tr_b16 a[240:241], v2 offset:12288
  ds_read_b64_tr_b16 a[242:243], v2 offset:12800
  v_mfma_f32_16x16x32_bf16 v[180:183], a[244:247], a[84:87], v[180:183]
  buffer_load_dwordx4 v250, s[16:19], s65 offen offset:2048 lds
  v_mfma_f32_16x16x32_bf16 v[184:187], a[244:247], a[224:227], v[184:187]
  v_exp_f32 v19, v19
  v_mfma_f32_16x16x32_bf16 v[188:191], a[244:247], a[228:231], v[188:191]
  v_add_f32 v19, 1.0, v19
  s_waitcnt lgkmcnt(2)
  v_mfma_f32_16x16x32_bf16 v[160:163], a[248:251], a[88:91], v[160:163]
  ds_read_b64_tr_b16 a[244:245], v3 offset:12288
  ds_read_b64_tr_b16 a[246:247], v3 offset:12800
  v_mfma_f32_16x16x32_bf16 v[164:167], a[248:251], a[92:95], v[164:167]
  buffer_load_dwordx4 v251, s[16:19], s65 offen offset:3072 lds
  v_mfma_f32_16x16x32_bf16 v[168:171], a[248:251], a[232:235], v[168:171]
  v_rcp_f32 v19, v19
  v_mfma_f32_16x16x32_bf16 v[172:175], a[248:251], a[236:239], v[172:175]
  v_mul_f32 v139, v139, v19
  v_mul_f32 v19, 0xbfb8aa3b, v147
  v_mfma_f32_16x16x32_bf16 v[176:179], a[252:255], a[88:91], v[176:179]
  ds_read_b64_tr_b16 a[248:249], v2 offset:16384
  ds_read_b64_tr_b16 a[250:251], v2 offset:16896
  v_mfma_f32_16x16x32_bf16 v[180:183], a[252:255], a[92:95], v[180:183]
  s_add_u32 s66, s56, 147456
  s_add_u32 m0, s63, 90112
  v_mfma_f32_16x16x32_bf16 v[184:187], a[252:255], a[232:235], v[184:187]
  buffer_load_dwordx4 v248, s[16:19], s66 offen lds
  v_mfma_f32_16x16x32_bf16 v[188:191], a[252:255], a[236:239], v[188:191]
  v_exp_f32 v20, v20
  s_waitcnt lgkmcnt(2)
  v_mfma_f32_16x16x32_bf16 v[160:163], a[240:243], a[96:99], v[160:163]
  ds_read_b64_tr_b16 a[252:253], v3 offset:16384
  ds_read_b64_tr_b16 a[254:255], v3 offset:16896
  v_mfma_f32_16x16x32_bf16 v[164:167], a[240:243], a[100:103], v[164:167]
  v_add_f32 v20, 1.0, v20
  v_mfma_f32_16x16x32_bf16 v[168:171], a[240:243], v[192:195], v[168:171]
  buffer_load_dwordx4 v249, s[16:19], s66 offen offset:1024 lds
  v_mfma_f32_16x16x32_bf16 v[172:175], a[240:243], v[196:199], v[172:175]
  v_rcp_f32 v20, v20
  v_mfma_f32_16x16x32_bf16 v[176:179], a[244:247], a[96:99], v[176:179]
  ds_read_b64_tr_b16 a[240:241], v2 offset:20480
  ds_read_b64_tr_b16 a[242:243], v2 offset:20992
  v_mfma_f32_16x16x32_bf16 v[180:183], a[244:247], a[100:103], v[180:183]
  v_mul_f32 v140, v140, v20
  v_mul_f32 v20, 0xbfb8aa3b, v148
  v_mfma_f32_16x16x32_bf16 v[184:187], a[244:247], v[192:195], v[184:187]
  buffer_load_dwordx4 v250, s[16:19], s66 offen offset:2048 lds
  v_mfma_f32_16x16x32_bf16 v[188:191], a[244:247], v[196:199], v[188:191]
  v_exp_f32 v21, v21
  s_waitcnt lgkmcnt(2)
  v_mfma_f32_16x16x32_bf16 v[160:163], a[248:251], a[104:107], v[160:163]
  ds_read_b64_tr_b16 a[244:245], v3 offset:20480
  ds_read_b64_tr_b16 a[246:247], v3 offset:20992
  v_mfma_f32_16x16x32_bf16 v[164:167], a[248:251], a[108:111], v[164:167]
  v_add_f32 v21, 1.0, v21
  v_mfma_f32_16x16x32_bf16 v[168:171], a[248:251], v[200:203], v[168:171]
  buffer_load_dwordx4 v251, s[16:19], s66 offen offset:3072 lds
  v_mfma_f32_16x16x32_bf16 v[172:175], a[248:251], v[204:207], v[172:175]
  v_rcp_f32 v21, v21
  v_mfma_f32_16x16x32_bf16 v[176:179], a[252:255], a[104:107], v[176:179]
  ds_read_b64_tr_b16 a[248:249], v2 offset:24576
  ds_read_b64_tr_b16 a[250:251], v2 offset:25088
  v_mfma_f32_16x16x32_bf16 v[180:183], a[252:255], a[108:111], v[180:183]
  v_mul_f32 v141, v141, v21
  v_mul_f32 v21, 0xbfb8aa3b, v149
  v_mfma_f32_16x16x32_bf16 v[184:187], a[252:255], v[200:203], v[184:187]
  s_add_u32 s67, s57, 0
  s_add_u32 m0, s64, 73728
  v_mfma_f32_16x16x32_bf16 v[188:191], a[252:255], v[204:207], v[188:191]
  v_exp_f32 v22, v22
  s_waitcnt lgkmcnt(2)
  v_mfma_f32_16x16x32_bf16 v[160:163], a[240:243], a[112:115], v[160:163]
  ds_read_b64_tr_b16 a[252:253], v3 offset:24576
  ds_read_b64_tr_b16 a[254:255], v3 offset:25088
  v_mfma_f32_16x16x32_bf16 v[164:167], a[240:243], a[116:119], v[164:167]
  buffer_load_dwordx4 v248, s[16:19], s67 offen lds
  v_add_f32 v22, 1.0, v22
  v_mfma_f32_16x16x32_bf16 v[168:171], a[240:243], v[208:211], v[168:171]
  v_rcp_f32 v22, v22
  v_mfma_f32_16x16x32_bf16 v[172:175], a[240:243], v[212:215], v[172:175]
  v_mul_f32 v142, v142, v22
  v_mul_f32 v22, 0xbfb8aa3b, v150
  v_mfma_f32_16x16x32_bf16 v[176:179], a[244:247], a[112:115], v[176:179]
  ds_read_b64_tr_b16 a[240:241], v2 offset:28672
  ds_read_b64_tr_b16 a[242:243], v2 offset:29184
  v_mfma_f32_16x16x32_bf16 v[180:183], a[244:247], a[116:119], v[180:183]
  v_exp_f32 v23, v23
  v_mfma_f32_16x16x32_bf16 v[184:187], a[244:247], v[208:211], v[184:187]
  v_add_f32 v23, 1.0, v23
  v_mfma_f32_16x16x32_bf16 v[188:191], a[244:247], v[212:215], v[188:191]
  v_rcp_f32 v23, v23
  s_waitcnt lgkmcnt(2)
  v_mfma_f32_16x16x32_bf16 v[160:163], a[248:251], a[120:123], v[160:163]
  ds_read_b64_tr_b16 a[244:245], v3 offset:28672
  ds_read_b64_tr_b16 a[246:247], v3 offset:29184
  v_mfma_f32_16x16x32_bf16 v[164:167], a[248:251], a[124:127], v[164:167]
  v_mul_f32 v143, v143, v23
  v_mul_f32 v23, 0xbfb8aa3b, v151
  v_mfma_f32_16x16x32_bf16 v[168:171], a[248:251], v[216:219], v[168:171]
  s_add_u32 s6, s68, 8192
  buffer_store_dwordx4 v[56:59], v1, s[24:27], s6 offen offset:0 sc1
  v_mfma_f32_16x16x32_bf16 v[172:175], a[248:251], v[220:223], v[172:175]
  v_exp_f32 v16, v16
  v_mfma_f32_16x16x32_bf16 v[176:179], a[252:255], a[120:123], v[176:179]
  ds_read_b64_tr_b16 a[248:249], v2 offset:32768
  ds_read_b64_tr_b16 a[250:251], v2 offset:33280
  v_mfma_f32_16x16x32_bf16 v[180:183], a[252:255], a[124:127], v[180:183]
  v_add_f32 v16, 1.0, v16
  v_mfma_f32_16x16x32_bf16 v[184:187], a[252:255], v[216:219], v[184:187]
  v_rcp_f32 v16, v16
  v_mfma_f32_16x16x32_bf16 v[188:191], a[252:255], v[220:223], v[188:191]
  v_mul_f32 v144, v144, v16
  v_mul_f32 v16, 0xbfb8aa3b, v152
  s_waitcnt lgkmcnt(2)
  v_mfma_f32_16x16x32_bf16 v[160:163], a[240:243], a[128:131], v[160:163]
  ds_read_b64_tr_b16 a[252:253], v3 offset:32768
  ds_read_b64_tr_b16 a[254:255], v3 offset:33280
  v_mfma_f32_16x16x32_bf16 v[164:167], a[240:243], a[132:135], v[164:167]
  v_exp_f32 v17, v17
  v_mfma_f32_16x16x32_bf16 v[168:171], a[240:243], v[224:227], v[168:171]
  v_add_f32 v17, 1.0, v17
  v_mfma_f32_16x16x32_bf16 v[172:175], a[240:243], v[228:231], v[172:175]
  v_rcp_f32 v17, v17
  v_mfma_f32_16x16x32_bf16 v[176:179], a[244:247], a[128:131], v[176:179]
  v_mul_f32 v145, v145, v17
  v_mul_f32 v17, 0xbfb8aa3b, v153
  v_mfma_f32_16x16x32_bf16 v[180:183], a[244:247], a[132:135], v[180:183]
  v_exp_f32 v18, v18
  v_mfma_f32_16x16x32_bf16 v[184:187], a[244:247], v[224:227], v[184:187]
  s_add_u32 s6, s68, 8192
  buffer_store_dwordx4 v[60:63], v1, s[24:27], s6 offen offset:1024 sc1
  v_mfma_f32_16x16x32_bf16 v[188:191], a[244:247], v[228:231], v[188:191]
  s_waitcnt vmcnt(22) lgkmcnt(0)
  s_barrier
  v_mov_b32 v2, v7
  v_xor_b32 v3, 32, v2
  v_mfma_f32_16x16x32_bf16 v[160:163], a[248:251], a[136:139], v[160:163]
  ds_read_b64_tr_b16 a[144:145], v2 offset:0
  ds_read_b64_tr_b16 a[146:147], v2 offset:256
  v_mfma_f32_16x16x32_bf16 v[164:167], a[248:251], a[140:143], v[164:167]
  ds_read_b64_tr_b16 a[148:149], v3 offset:0
  ds_read_b64_tr_b16 a[150:151], v3 offset:256
  v_mfma_f32_16x16x32_bf16 v[168:171], a[248:251], v[232:235], v[168:171]
  ds_read_b64_tr_b16 a[152:153], v2 offset:2048
  ds_read_b64_tr_b16 a[154:155], v2 offset:2304
  v_mfma_f32_16x16x32_bf16 v[172:175], a[248:251], v[236:239], v[172:175]
  v_add_f32 v18, 1.0, v18
  v_mfma_f32_16x16x32_bf16 v[176:179], a[252:255], a[136:139], v[176:179]
  ds_read_b64_tr_b16 a[156:157], v3 offset:2048
  ds_read_b64_tr_b16 a[158:159], v3 offset:2304
  v_mfma_f32_16x16x32_bf16 v[180:183], a[252:255], a[140:143], v[180:183]
  ds_read_b64_tr_b16 a[160:161], v2 offset:4096
  ds_read_b64_tr_b16 a[162:163], v2 offset:4352
  v_mfma_f32_16x16x32_bf16 v[184:187], a[252:255], v[232:235], v[184:187]
  ds_read_b64_tr_b16 a[164:165], v3 offset:4096
  ds_read_b64_tr_b16 a[166:167], v3 offset:4352
  v_mfma_f32_16x16x32_bf16 v[188:191], a[252:255], v[236:239], v[188:191]
  v_rcp_f32 v18, v18
  s_waitcnt lgkmcnt(6)
  v_mfma_f32_16x16x32_bf16 v[96:99], a[144:147], a[0:3], 0
  ds_read_b64_tr_b16 a[168:169], v2 offset:6144
  ds_read_b64_tr_b16 a[170:171], v2 offset:6400
  v_mfma_f32_16x16x32_bf16 v[100:103], a[144:147], a[4:7], 0
  v_mul_f32 v146, v146, v18
  v_mul_f32 v18, 0xbfb8aa3b, v154
  v_mfma_f32_16x16x32_bf16 v[104:107], a[148:151], a[0:3], 0
  ds_read_b64_tr_b16 a[172:173], v3 offset:6144
  ds_read_b64_tr_b16 a[174:175], v3 offset:6400
  v_mfma_f32_16x16x32_bf16 v[108:111], a[148:151], a[4:7], 0
  s_add_u32 s65, s56, 128
  s_add_u32 m0, s63, 110592
  v_mfma_f32_16x16x32_bf16 v[96:99], a[152:155], a[8:11], v[96:99]
  ds_read_b64_tr_b16 a[144:145], v2 offset:8192
  ds_read_b64_tr_b16 a[146:147], v2 offset:8448
  v_mfma_f32_16x16x32_bf16 v[100:103], a[152:155], a[12:15], v[100:103]
  buffer_load_dwordx4 v248, s[16:19], s65 offen lds
  s_waitcnt lgkmcnt(6)
  v_mfma_f32_16x16x32_bf16 v[104:107], a[156:159], a[8:11], v[104:107]
  ds_read_b64_tr_b16 a[148:149], v3 offset:8192
  ds_read_b64_tr_b16 a[150:151], v3 offset:8448
  v_mfma_f32_16x16x32_bf16 v[108:111], a[156:159], a[12:15], v[108:111]
  v_exp_f32 v19, v19
  v_mfma_f32_16x16x32_bf16 v[96:99], a[160:163], a[16:19], v[96:99]
  ds_read_b64_tr_b16 a[152:153], v2 offset:10240
  ds_read_b64_tr_b16 a[154:155], v2 offset:10496
  v_mfma_f32_16x16x32_bf16 v[100:103], a[160:163], a[20:23], v[100:103]
  buffer_load_dwordx4 v249, s[16:19], s65 offen offset:1024 lds
  v_add_f32 v19, 1.0, v19
  v_mfma_f32_16x16x32_bf16 v[104:107], a[164:167], a[16:19], v[104:107]
  ds_read_b64_tr_b16 a[156:157], v3 offset:10240
  ds_read_b64_tr_b16 a[158:159], v3 offset:10496
  v_mfma_f32_16x16x32_bf16 v[108:111], a[164:167], a[20:23], v[108:111]
  v_rcp_f32 v19, v19
  s_waitcnt lgkmcnt(6)
  v_mfma_f32_16x16x32_bf16 v[96:99], a[168:171], a[24:27], v[96:99]
  ds_read_b64_tr_b16 a[160:161], v2 offset:12288
  ds_read_b64_tr_b16 a[162:163], v2 offset:12544
  v_mfma_f32_16x16x32_bf16 v[100:103], a[168:171], a[28:31], v[100:103]
  buffer_load_dwordx4 v250, s[16:19], s65 offen offset:2048 lds
  v_mul_f32 v147, v147, v19
  v_mfma_f32_16x16x32_bf16 v[104:107], a[172:175], a[24:27], v[104:107]
  ds_read_b64_tr_b16 a[164:165], v3 offset:12288
  ds_read_b64_tr_b16 a[166:167], v3 offset:12544
  v_mfma_f32_16x16x32_bf16 v[108:111], a[172:175], a[28:31], v[108:111]
  v_exp_f32 v20, v20
  v_mfma_f32_16x16x32_bf16 v[96:99], a[144:147], a[32:35], v[96:99]
  ds_read_b64_tr_b16 a[168:169], v2 offset:14336
  ds_read_b64_tr_b16 a[170:171], v2 offset:14592
  v_mfma_f32_16x16x32_bf16 v[100:103], a[144:147], a[36:39], v[100:103]
  buffer_load_dwordx4 v251, s[16:19], s65 offen offset:3072 lds
  v_add_f32 v20, 1.0, v20
  s_waitcnt lgkmcnt(6)
  v_mfma_f32_16x16x32_bf16 v[104:107], a[148:151], a[32:35], v[104:107]
  ds_read_b64_tr_b16 a[172:173], v3 offset:14336
  ds_read_b64_tr_b16 a[174:175], v3 offset:14592
  v_mfma_f32_16x16x32_bf16 v[108:111], a[148:151], a[36:39], v[108:111]
  v_rcp_f32 v20, v20
  v_mfma_f32_16x16x32_bf16 v[96:99], a[152:155], a[40:43], v[96:99]
  ds_read_b64_tr_b16 a[144:145], v2 offset:16384
  ds_read_b64_tr_b16 a[146:147], v2 offset:16640
  v_mfma_f32_16x16x32_bf16 v[100:103], a[152:155], a[44:47], v[100:103]
  s_add_u32 s66, s56, 147584
  s_add_u32 m0, s63, 126976
  v_mfma_f32_16x16x32_bf16 v[104:107], a[156:159], a[40:43], v[104:107]
  ds_read_b64_tr_b16 a[148:149], v3 offset:16384
  ds_read_b64_tr_b16 a[150:151], v3 offset:16640
  v_mfma_f32_16x16x32_bf16 v[108:111], a[156:159], a[44:47], v[108:111]
  buffer_load_dwordx4 v248, s[16:19], s66 offen lds
  v_mul_f32 v148, v148, v20
  s_waitcnt lgkmcnt(6)
  v_mfma_f32_16x16x32_bf16 v[96:99], a[160:163], a[48:51], v[96:99]
  ds_read_b64_tr_b16 a[152:153], v2 offset:18432
  ds_read_b64_tr_b16 a[154:155], v2 offset:18688
  v_mfma_f32_16x16x32_bf16 v[100:103], a[160:163], a[52:55], v[100:103]
  v_exp_f32 v21, v21
  v_mfma_f32_16x16x32_bf16 v[104:107], a[164:167], a[48:51], v[104:107]
  ds_read_b64_tr_b16 a[156:157], v3 offset:18432
  ds_read_b64_tr_b16 a[158:159], v3 offset:18688
  v_mfma_f32_16x16x32_bf16 v[108:111], a[164:167], a[52:55], v[108:111]
  buffer_load_dwordx4 v249, s[16:19], s66 offen offset:1024 lds
  v_add_f32 v21, 1.0, v21
  v_mfma_f32_16x16x32_bf16 v[96:99], a[168:171], a[56:59], v[96:99]
  ds_read_b64_tr_b16 a[160:161], v2 offset:20480
  ds_read_b64_tr_b16 a[162:163], v2 offset:20736
  v_mfma_f32_16x16x32_bf16 v[100:103], a[168:171], a[60:63], v[100:103]
  v_rcp_f32 v21, v21
  s_waitcnt lgkmcnt(6)
  v_mfma_f32_16x16x32_bf16 v[104:107], a[172:175], a[56:59], v[104:107]
  ds_read_b64_tr_b16 a[164:165], v3 offset:20480
  ds_read_b64_tr_b16 a[166:167], v3 offset:20736
  v_mfma_f32_16x16x32_bf16 v[108:111], a[172:175], a[60:63], v[108:111]
  buffer_load_dwordx4 v250, s[16:19], s66 offen offset:2048 lds
  v_mul_f32 v149, v149, v21
  v_mfma_f32_16x16x32_bf16 v[96:99], a[144:147], a[64:67], v[96:99]
  ds_read_b64_tr_b16 a[168:169], v2 offset:22528
  ds_read_b64_tr_b16 a[170:171], v2 offset:22784
  v_mfma_f32_16x16x32_bf16 v[100:103], a[144:147], a[68:71], v[100:103]
  v_exp_f32 v22, v22
  v_mfma_f32_16x16x32_bf16 v[104:107], a[148:151], a[64:67], v[104:107]
  ds_read_b64_tr_b16 a[172:173], v3 offset:22528
  ds_read_b64_tr_b16 a[174:175], v3 offset:22784
  v_mfma_f32_16x16x32_bf16 v[108:111], a[148:151], a[68:71], v[108:111]
  buffer_load_dwordx4 v251, s[16:19], s66 offen offset:3072 lds
  v_add_f32 v22, 1.0, v22
  s_waitcnt lgkmcnt(6)
  v_mfma_f32_16x16x32_bf16 v[96:99], a[152:155], a[72:75], v[96:99]
  ds_read_b64_tr_b16 a[144:145], v2 offset:24576
  ds_read_b64_tr_b16 a[146:147], v2 offset:24832
  v_mfma_f32_16x16x32_bf16 v[100:103], a[152:155], a[76:79], v[100:103]
  v_rcp_f32 v22, v22
  v_mfma_f32_16x16x32_bf16 v[104:107], a[156:159], a[72:75], v[104:107]
  ds_read_b64_tr_b16 a[148:149], v3 offset:24576
  ds_read_b64_tr_b16 a[150:151], v3 offset:24832
  v_mfma_f32_16x16x32_bf16 v[108:111], a[156:159], a[76:79], v[108:111]
  s_add_u32 s67, s57, 128
  s_add_u32 m0, s64, 110592
  v_mfma_f32_16x16x32_bf16 v[96:99], a[160:163], a[80:83], v[96:99]
  ds_read_b64_tr_b16 a[152:153], v2 offset:26624
  ds_read_b64_tr_b16 a[154:155], v2 offset:26880
  v_mfma_f32_16x16x32_bf16 v[100:103], a[160:163], a[84:87], v[100:103]
  buffer_load_dwordx4 v248, s[16:19], s67 offen lds
  v_mul_f32 v150, v150, v22
  s_waitcnt lgkmcnt(6)
  v_mfma_f32_16x16x32_bf16 v[104:107], a[164:167], a[80:83], v[104:107]
  ds_read_b64_tr_b16 a[156:157], v3 offset:26624
  ds_read_b64_tr_b16 a[158:159], v3 offset:26880
  v_mfma_f32_16x16x32_bf16 v[108:111], a[164:167], a[84:87], v[108:111]
  v_exp_f32 v23, v23
  v_mfma_f32_16x16x32_bf16 v[96:99], a[168:171], a[88:91], v[96:99]
  ds_read_b64_tr_b16 a[160:161], v2 offset:28672
  ds_read_b64_tr_b16 a[162:163], v2 offset:28928
  v_mfma_f32_16x16x32_bf16 v[100:103], a[168:171], a[92:95], v[100:103]
  v_add_f32 v23, 1.0, v23
  v_mul_f32 v19, 0xbfb8aa3b, v155
  v_mfma_f32_16x16x32_bf16 v[104:107], a[172:175], a[88:91], v[104:107]
  ds_read_b64_tr_b16 a[164:165], v3 offset:28672
  ds_read_b64_tr_b16 a[166:167], v3 offset:28928
  v_mfma_f32_16x16x32_bf16 v[108:111], a[172:175], a[92:95], v[108:111]
  v_rcp_f32 v23, v23
  s_waitcnt lgkmcnt(6)
  v_mfma_f32_16x16x32_bf16 v[96:99], a[144:147], a[96:99], v[96:99]
  ds_read_b64_tr_b16 a[168:169], v2 offset:30720
  ds_read_b64_tr_b16 a[170:171], v2 offset:30976
  v_mfma_f32_16x16x32_bf16 v[100:103], a[144:147], a[100:103], v[100:103]
  v_mul_f32 v151, v151, v23
  v_mul_f32 v20, 0xbfb8aa3b, v156
  v_mfma_f32_16x16x32_bf16 v[104:107], a[148:151], a[96:99], v[104:107]
  ds_read_b64_tr_b16 a[172:173], v3 offset:30720
  ds_read_b64_tr_b16 a[174:175], v3 offset:30976
  v_mfma_f32_16x16x32_bf16 v[108:111], a[148:151], a[100:103], v[108:111]
  s_add_u32 s6, s68, 8192
  buffer_store_dwordx4 v[64:67], v1, s[24:27], s6 offen offset:2048 sc1
  v_mfma_f32_16x16x32_bf16 v[96:99], a[152:155], a[104:107], v[96:99]
  ds_read_b64_tr_b16 a[144:145], v2 offset:32768
  ds_read_b64_tr_b16 a[146:147], v2 offset:33024
  v_mfma_f32_16x16x32_bf16 v[100:103], a[152:155], a[108:111], v[100:103]
  v_exp_f32 v16, v16
  s_waitcnt lgkmcnt(6)
  v_mfma_f32_16x16x32_bf16 v[104:107], a[156:159], a[104:107], v[104:107]
  ds_read_b64_tr_b16 a[148:149], v3 offset:32768
  ds_read_b64_tr_b16 a[150:151], v3 offset:33024
  v_mfma_f32_16x16x32_bf16 v[108:111], a[156:159], a[108:111], v[108:111]
  v_add_f32 v16, 1.0, v16
  v_mul_f32 v21, 0xbfb8aa3b, v157
  v_mfma_f32_16x16x32_bf16 v[96:99], a[160:163], a[112:115], v[96:99]
  ds_read_b64_tr_b16 a[152:153], v2 offset:34816
  ds_read_b64_tr_b16 a[154:155], v2 offset:35072
  v_mfma_f32_16x16x32_bf16 v[100:103], a[160:163], a[116:119], v[100:103]
  v_rcp_f32 v16, v16
  v_mfma_f32_16x16x32_bf16 v[104:107], a[164:167], a[112:115], v[104:107]
  ds_read_b64_tr_b16 a[156:157], v3 offset:34816
  ds_read_b64_tr_b16 a[158:159], v3 offset:35072
  v_mfma_f32_16x16x32_bf16 v[108:111], a[164:167], a[116:119], v[108:111]
  v_mul_f32 v152, v152, v16
  v_mul_f32 v22, 0xbfb8aa3b, v158
  s_waitcnt lgkmcnt(6)
  v_mfma_f32_16x16x32_bf16 v[96:99], a[168:171], a[120:123], v[96:99]
  v_mul_f32 v23, 0xbfb8aa3b, v159
  v_mfma_f32_16x16x32_bf16 v[100:103], a[168:171], a[124:127], v[100:103]
  v_exp_f32 v17, v17
  v_mfma_f32_16x16x32_bf16 v[104:107], a[172:175], a[120:123], v[104:107]
  s_add_u32 s6, s68, 8192
  buffer_store_dwordx4 v[68:71], v1, s[24:27], s6 offen offset:3072 sc1
  v_mfma_f32_16x16x32_bf16 v[108:111], a[172:175], a[124:127], v[108:111]
  v_add_f32 v17, 1.0, v17
  v_mul_f32 v128, v128, v160
  v_mfma_f32_16x16x32_bf16 v[96:99], a[144:147], a[128:131], v[96:99]
  v_mfma_f32_16x16x32_bf16 v[100:103], a[144:147], a[132:135], v[100:103]
  s_waitcnt vmcnt(23) lgkmcnt(0)
  s_barrier
  v_add_u32 v2, 36864, v7
  v_xor_b32 v3, 32, v2
  v_mfma_f32_16x16x32_bf16 v[104:107], a[148:151], a[128:131], v[104:107]
  ds_read_b64_tr_b16 a[160:161], v2 offset:0
  ds_read_b64_tr_b16 a[162:163], v2 offset:256
  v_mfma_f32_16x16x32_bf16 v[108:111], a[148:151], a[132:135], v[108:111]
  ds_read_b64_tr_b16 a[164:165], v3 offset:0
  ds_read_b64_tr_b16 a[166:167], v3 offset:256
  v_mfma_f32_16x16x32_bf16 v[96:99], a[152:155], a[136:139], v[96:99]
  ds_read_b64_tr_b16 a[168:169], v2 offset:2048
  ds_read_b64_tr_b16 a[170:171], v2 offset:2304
  v_mfma_f32_16x16x32_bf16 v[100:103], a[152:155], a[140:143], v[100:103]
  ds_read_b64_tr_b16 a[172:173], v3 offset:2048
  ds_read_b64_tr_b16 a[174:175], v3 offset:2304
  v_mfma_f32_16x16x32_bf16 v[104:107], a[156:159], a[136:139], v[104:107]
  ds_read_b64_tr_b16 a[144:145], v2 offset:4096
  ds_read_b64_tr_b16 a[146:147], v2 offset:4352
  v_mfma_f32_16x16x32_bf16 v[108:111], a[156:159], a[140:143], v[108:111]
  ds_read_b64_tr_b16 a[148:149], v3 offset:4096
  ds_read_b64_tr_b16 a[150:151], v3 offset:4352
  s_waitcnt lgkmcnt(6)
  v_mfma_f32_16x16x32_bf16 v[192:195], a[160:163], a[0:3], 0
  ds_read_b64_tr_b16 a[152:153], v2 offset:6144
  ds_read_b64_tr_b16 a[154:155], v2 offset:6400
  v_mfma_f32_16x16x32_bf16 v[196:199], a[160:163], a[4:7], 0
  v_rcp_f32 v17, v17
  v_mfma_f32_16x16x32_bf16 v[200:203], a[164:167], a[0:3], 0
  ds_read_b64_tr_b16 a[156:157], v3 offset:6144
  ds_read_b64_tr_b16 a[158:159], v3 offset:6400
  v_mfma_f32_16x16x32_bf16 v[204:207], a[164:167], a[4:7], 0
  s_add_u32 s65, s56, 256
  s_add_u32 m0, s63, 0
  v_mfma_f32_16x16x32_bf16 v[192:195], a[168:171], a[8:11], v[192:195]
  ds_read_b64_tr_b16 a[160:161], v2 offset:8192
  ds_read_b64_tr_b16 a[162:163], v2 offset:8448
  v_mfma_f32_16x16x32_bf16 v[196:199], a[168:171], a[12:15], v[196:199]
  buffer_load_dwordx4 v248, s[16:19], s65 offen lds
  v_mul_f32 v153, v153, v17
  s_waitcnt lgkmcnt(6)
  v_mfma_f32_16x16x32_bf16 v[200:203], a[172:175], a[8:11], v[200:203]
  ds_read_b64_tr_b16 a[164:165], v3 offset:8192
  ds_read_b64_tr_b16 a[166:167], v3 offset:8448
  v_mfma_f32_16x16x32_bf16 v[204:207], a[172:175], a[12:15], v[204:207]
  v_exp_f32 v18, v18
  v_mfma_f32_16x16x32_bf16 v[192:195], a[144:147], a[16:19], v[192:195]
  ds_read_b64_tr_b16 a[168:169], v2 offset:10240
  ds_read_b64_tr_b16 a[170:171], v2 offset:10496
  v_mfma_f32_16x16x32_bf16 v[196:199], a[144:147], a[20:23], v[196:199]
  buffer_load_dwordx4 v249, s[16:19], s65 offen offset:1024 lds
  v_add_f32 v18, 1.0, v18
  v_mfma_f32_16x16x32_bf16 v[200:203], a[148:151], a[16:19], v[200:203]
  ds_read_b64_tr_b16 a[172:173], v3 offset:10240
  ds_read_b64_tr_b16 a[174:175], v3 offset:10496
  v_mfma_f32_16x16x32_bf16 v[204:207], a[148:151], a[20:23], v[204:207]
  v_rcp_f32 v18, v18
  s_waitcnt lgkmcnt(6)
  v_mfma_f32_16x16x32_bf16 v[192:195], a[152:155], a[24:27], v[192:195]
  ds_read_b64_tr_b16 a[144:145], v2 offset:12288
  ds_read_b64_tr_b16 a[146:147], v2 offset:12544
  v_mfma_f32_16x16x32_bf16 v[196:199], a[152:155], a[28:31], v[196:199]
  buffer_load_dwordx4 v250, s[16:19], s65 offen offset:2048 lds
  v_mul_f32 v154, v154, v18
  v_mfma_f32_16x16x32_bf16 v[200:203], a[156:159], a[24:27], v[200:203]
  ds_read_b64_tr_b16 a[148:149], v3 offset:12288
  ds_read_b64_tr_b16 a[150:151], v3 offset:12544
  v_mfma_f32_16x16x32_bf16 v[204:207], a[156:159], a[28:31], v[204:207]
  v_exp_f32 v19, v19
  v_mfma_f32_16x16x32_bf16 v[192:195], a[160:163], a[32:35], v[192:195]
  ds_read_b64_tr_b16 a[152:153], v2 offset:14336
  ds_read_b64_tr_b16 a[154:155], v2 offset:14592
  v_mfma_f32_16x16x32_bf16 v[196:199], a[160:163], a[36:39], v[196:199]
  buffer_load_dwordx4 v251, s[16:19], s65 offen offset:3072 lds
  v_add_f32 v19, 1.0, v19
  s_waitcnt lgkmcnt(6)
  v_mfma_f32_16x16x32_bf16 v[200:203], a[164:167], a[32:35], v[200:203]
  ds_read_b64_tr_b16 a[156:157], v3 offset:14336
  ds_read_b64_tr_b16 a[158:159], v3 offset:14592
  v_mfma_f32_16x16x32_bf16 v[204:207], a[164:167], a[36:39], v[204:207]
  v_rcp_f32 v19, v19
  v_mfma_f32_16x16x32_bf16 v[192:195], a[168:171], a[40:43], v[192:195]
  ds_read_b64_tr_b16 a[160:161], v2 offset:16384
  ds_read_b64_tr_b16 a[162:163], v2 offset:16640
  v_mfma_f32_16x16x32_bf16 v[196:199], a[168:171], a[44:47], v[196:199]
  s_add_u32 s66, s56, 147712
  s_add_u32 m0, s63, 16384
  v_mfma_f32_16x16x32_bf16 v[200:203], a[172:175], a[40:43], v[200:203]
  ds_read_b64_tr_b16 a[164:165], v3 offset:16384
  ds_read_b64_tr_b16 a[166:167], v3 offset:16640
  v_mfma_f32_16x16x32_bf16 v[204:207], a[172:175], a[44:47], v[204:207]
  buffer_load_dwordx4 v248, s[16:19], s66 offen lds
  v_mul_f32 v155, v155, v19
  s_waitcnt lgkmcnt(6)
  v_mfma_f32_16x16x32_bf16 v[192:195], a[144:147], a[48:51], v[192:195]
  ds_read_b64_tr_b16 a[168:169], v2 offset:18432
  ds_read_b64_tr_b16 a[170:171], v2 offset:18688
  v_mfma_f32_16x16x32_bf16 v[196:199], a[144:147], a[52:55], v[196:199]
  v_exp_f32 v20, v20
  v_mfma_f32_16x16x32_bf16 v[200:203], a[148:151], a[48:51], v[200:203]
  ds_read_b64_tr_b16 a[172:173], v3 offset:18432
  ds_read_b64_tr_b16 a[174:175], v3 offset:18688
  v_mfma_f32_16x16x32_bf16 v[204:207], a[148:151], a[52:55], v[204:207]
  buffer_load_dwordx4 v249, s[16:19], s66 offen offset:1024 lds
  v_add_f32 v20, 1.0, v20
  v_mfma_f32_16x16x32_bf16 v[192:195], a[152:155], a[56:59], v[192:195]
  ds_read_b64_tr_b16 a[144:145], v2 offset:20480
  ds_read_b64_tr_b16 a[146:147], v2 offset:20736
  v_mfma_f32_16x16x32_bf16 v[196:199], a[152:155], a[60:63], v[196:199]
  v_rcp_f32 v20, v20
  s_waitcnt lgkmcnt(6)
  v_mfma_f32_16x16x32_bf16 v[200:203], a[156:159], a[56:59], v[200:203]
  ds_read_b64_tr_b16 a[148:149], v3 offset:20480
  ds_read_b64_tr_b16 a[150:151], v3 offset:20736
  v_mfma_f32_16x16x32_bf16 v[204:207], a[156:159], a[60:63], v[204:207]
  buffer_load_dwordx4 v250, s[16:19], s66 offen offset:2048 lds
  v_mul_f32 v156, v156, v20
  v_mfma_f32_16x16x32_bf16 v[192:195], a[160:163], a[64:67], v[192:195]
  ds_read_b64_tr_b16 a[152:153], v2 offset:22528
  ds_read_b64_tr_b16 a[154:155], v2 offset:22784
  v_mfma_f32_16x16x32_bf16 v[196:199], a[160:163], a[68:71], v[196:199]
  v_exp_f32 v21, v21
  v_mfma_f32_16x16x32_bf16 v[200:203], a[164:167], a[64:67], v[200:203]
  ds_read_b64_tr_b16 a[156:157], v3 offset:22528
  ds_read_b64_tr_b16 a[158:159], v3 offset:22784
  v_mfma_f32_16x16x32_bf16 v[204:207], a[164:167], a[68:71], v[204:207]
  buffer_load_dwordx4 v251, s[16:19], s66 offen offset:3072 lds
  v_add_f32 v21, 1.0, v21
  s_waitcnt lgkmcnt(6)
  v_mfma_f32_16x16x32_bf16 v[192:195], a[168:171], a[72:75], v[192:195]
  ds_read_b64_tr_b16 a[160:161], v2 offset:24576
  ds_read_b64_tr_b16 a[162:163], v2 offset:24832
  v_mfma_f32_16x16x32_bf16 v[196:199], a[168:171], a[76:79], v[196:199]
  v_rcp_f32 v21, v21
  v_mfma_f32_16x16x32_bf16 v[200:203], a[172:175], a[72:75], v[200:203]
  ds_read_b64_tr_b16 a[164:165], v3 offset:24576
  ds_read_b64_tr_b16 a[166:167], v3 offset:24832
  v_mfma_f32_16x16x32_bf16 v[204:207], a[172:175], a[76:79], v[204:207]
  s_add_u32 s67, s57, 256
  s_add_u32 m0, s64, 0
  v_mfma_f32_16x16x32_bf16 v[192:195], a[144:147], a[80:83], v[192:195]
  ds_read_b64_tr_b16 a[168:169], v2 offset:26624
  ds_read_b64_tr_b16 a[170:171], v2 offset:26880
  v_mfma_f32_16x16x32_bf16 v[196:199], a[144:147], a[84:87], v[196:199]
  buffer_load_dwordx4 v248, s[16:19], s67 offen lds
  v_mul_f32 v157, v157, v21
  s_waitcnt lgkmcnt(6)
  v_mfma_f32_16x16x32_bf16 v[200:203], a[148:151], a[80:83], v[200:203]
  ds_read_b64_tr_b16 a[172:173], v3 offset:26624
  ds_read_b64_tr_b16 a[174:175], v3 offset:26880
  v_mfma_f32_16x16x32_bf16 v[204:207], a[148:151], a[84:87], v[204:207]
  v_exp_f32 v22, v22
  v_mfma_f32_16x16x32_bf16 v[192:195], a[152:155], a[88:91], v[192:195]
  ds_read_b64_tr_b16 a[144:145], v2 offset:28672
  ds_read_b64_tr_b16 a[146:147], v2 offset:28928
  v_mfma_f32_16x16x32_bf16 v[196:199], a[152:155], a[92:95], v[196:199]
  v_add_f32 v22, 1.0, v22
  v_mul_f32 v129, v129, v161
  v_mfma_f32_16x16x32_bf16 v[200:203], a[156:159], a[88:91], v[200:203]
  ds_read_b64_tr_b16 a[148:149], v3 offset:28672
  ds_read_b64_tr_b16 a[150:151], v3 offset:28928
  v_mfma_f32_16x16x32_bf16 v[204:207], a[156:159], a[92:95], v[204:207]
  v_rcp_f32 v22, v22
  s_waitcnt lgkmcnt(6)
  v_mfma_f32_16x16x32_bf16 v[192:195], a[160:163], a[96:99], v[192:195]
  ds_read_b64_tr_b16 a[152:153], v2 offset:30720
  ds_read_b64_tr_b16 a[154:155], v2 offset:30976
  v_mfma_f32_16x16x32_bf16 v[196:199], a[160:163], a[100:103], v[196:199]
  v_mul_f32 v158, v158, v22
  v_cvt_pk_bf16_f32 v72, v128, v129
  v_mfma_f32_16x16x32_bf16 v[200:203], a[164:167], a[96:99], v[200:203]
  ds_read_b64_tr_b16 a[156:157], v3 offset:30720
  ds_read_b64_tr_b16 a[158:159], v3 offset:30976
  v_mfma_f32_16x16x32_bf16 v[204:207], a[164:167], a[100:103], v[204:207]
  v_exp_f32 v23, v23
  v_mfma_f32_16x16x32_bf16 v[192:195], a[168:171], a[104:107], v[192:195]
  ds_read_b64_tr_b16 a[160:161], v2 offset:32768
  ds_read_b64_tr_b16 a[162:163], v2 offset:33024
  v_mfma_f32_16x16x32_bf16 v[196:199], a[168:171], a[108:111], v[196:199]
  v_add_f32 v23, 1.0, v23
  v_mul_f32 v130, v130, v162
  s_waitcnt lgkmcnt(6)
  v_mfma_f32_16x16x32_bf16 v[200:203], a[172:175], a[104:107], v[200:203]
  ds_read_b64_tr_b16 a[164:165], v3 offset:32768
  ds_read_b64_tr_b16 a[166:167], v3 offset:33024
  v_mfma_f32_16x16x32_bf16 v[204:207], a[172:175], a[108:111], v[204:207]
  v_rcp_f32 v23, v23
  v_mfma_f32_16x16x32_bf16 v[192:195], a[144:147], a[112:115], v[192:195]
  ds_read_b64_tr_b16 a[168:169], v2 offset:34816
  ds_read_b64_tr_b16 a[170:171], v2 offset:35072
  v_mfma_f32_16x16x32_bf16 v[196:199], a[144:147], a[116:119], v[196:199]
  v_mul_f32 v159, v159, v23
  v_mul_f32 v131, v131, v163
  v_mfma_f32_16x16x32_bf16 v[200:203], a[148:151], a[112:115], v[200:203]
  ds_read_b64_tr_b16 a[172:173], v3 offset:34816
  ds_read_b64_tr_b16 a[174:175], v3 offset:35072
  v_mfma_f32_16x16x32_bf16 v[204:207], a[148:151], a[116:119], v[204:207]
  v_cvt_pk_bf16_f32 v73, v130, v131
  v_mul_f32 v144, v144, v176
  s_waitcnt lgkmcnt(6)
  v_mfma_f32_16x16x32_bf16 v[192:195], a[152:155], a[120:123], v[192:195]
  v_mul_f32 v145, v145, v177
  v_mfma_f32_16x16x32_bf16 v[196:199], a[152:155], a[124:127], v[196:199]
  v_cvt_pk_bf16_f32 v74, v144, v145
  v_mul_f32 v146, v146, v178
  v_mfma_f32_16x16x32_bf16 v[200:203], a[156:159], a[120:123], v[200:203]
  v_mul_f32 v147, v147, v179
  v_cvt_pk_bf16_f32 v75, v146, v147
  v_mfma_f32_16x16x32_bf16 v[204:207], a[156:159], a[124:127], v[204:207]
  v_mul_f32 v132, v132, v164
  v_mul_f32 v133, v133, v165
  v_mul_f32 v150, v150, v182
  v_mul_f32 v151, v151, v183
  v_mul_f32 v148, v148, v180
  v_mul_f32 v149, v149, v181
  v_mul_f32 v134, v134, v166
  v_mul_f32 v135, v135, v167
  v_cvt_pk_bf16_f32 v76, v132, v133
  v_cvt_pk_bf16_f32 v77, v134, v135
  v_cvt_pk_bf16_f32 v78, v148, v149
  v_cvt_pk_bf16_f32 v79, v150, v151
  v_mul_f32 v158, v158, v190
  v_mul_f32 v159, v159, v191
  v_mul_f32 v156, v156, v188
  v_mul_f32 v157, v157, v189
  v_mul_f32 v142, v142, v174
  v_mul_f32 v143, v143, v175
  v_mul_f32 v140, v140, v172
  v_mul_f32 v141, v141, v173
  v_cvt_pk_bf16_f32 v140, v140, v141
  v_cvt_pk_bf16_f32 v141, v142, v143
  v_cvt_pk_bf16_f32 v142, v156, v157
  v_cvt_pk_bf16_f32 v143, v158, v159
  v_mul_f32 v154, v154, v186
  v_mul_f32 v155, v155, v187
  v_mul_f32 v152, v152, v184
  v_mul_f32 v153, v153, v185
  v_mul_f32 v138, v138, v170
  v_mul_f32 v139, v139, v171
  v_mul_f32 v136, v136, v168
  v_mul_f32 v137, v137, v169
  v_cvt_pk_bf16_f32 v136, v136, v137
  v_cvt_pk_bf16_f32 v137, v138, v139
  v_cvt_pk_bf16_f32 v138, v152, v153
  v_cvt_pk_bf16_f32 v139, v154, v155
  ds_write_b128 v4, v[136:139] offset:0
  ds_write_b128 v4, v[140:143] offset:1024
  v_mfma_f32_16x16x32_bf16 v[192:195], a[160:163], a[128:131], v[192:195]
  v_mfma_f32_16x16x32_bf16 v[196:199], a[160:163], a[132:135], v[196:199]
  s_waitcnt vmcnt(22) lgkmcnt(0)
  s_barrier
  ds_read_b128 v[80:83], v5 offset:0
  ds_read_b128 v[84:87], v5 offset:1024
  v_add_u32 v2, 73728, v8
  v_xor_b32 v3, 32, v2
  v_xor_b32 v4, 64, v2
  v_xor_b32 v5, 0x60, v2
  v_mfma_f32_16x16x32_bf16 v[200:203], a[164:167], a[128:131], v[200:203]
  ds_read_b64_tr_b16 a[144:145], v2 offset:0
  ds_read_b64_tr_b16 a[146:147], v2 offset:2048
  v_mfma_f32_16x16x32_bf16 v[204:207], a[164:167], a[132:135], v[204:207]
  ds_read_b64_tr_b16 a[148:149], v3 offset:0
  ds_read_b64_tr_b16 a[150:151], v3 offset:2048
  v_mfma_f32_16x16x32_bf16 v[192:195], a[168:171], a[136:139], v[192:195]
  ds_read_b64_tr_b16 a[152:153], v4 offset:0
  ds_read_b64_tr_b16 a[154:155], v4 offset:2048
  v_mfma_f32_16x16x32_bf16 v[196:199], a[168:171], a[140:143], v[196:199]
  ds_read_b64_tr_b16 a[156:157], v5 offset:0
  ds_read_b64_tr_b16 a[158:159], v5 offset:2048
  v_mfma_f32_16x16x32_bf16 v[200:203], a[172:175], a[136:139], v[200:203]
  ds_read_b64_tr_b16 a[160:161], v2 offset:4096
  ds_read_b64_tr_b16 a[162:163], v2 offset:6144
  v_mfma_f32_16x16x32_bf16 v[204:207], a[172:175], a[140:143], v[204:207]
  ds_read_b64_tr_b16 a[164:165], v3 offset:4096
  ds_read_b64_tr_b16 a[166:167], v3 offset:6144
  s_waitcnt lgkmcnt(6)
  v_mfma_f32_16x16x32_bf16 v[128:131], a[144:147], v[24:27], 0
  ds_read_b64_tr_b16 a[168:169], v4 offset:4096
  ds_read_b64_tr_b16 a[170:171], v4 offset:6144
  v_mfma_f32_16x16x32_bf16 v[132:135], a[144:147], v[28:31], 0
  v_mul_f32 v16, 0xbfb8aa3b, v96
  v_mul_f32 v17, 0xbfb8aa3b, v97
  v_mfma_f32_16x16x32_bf16 v[136:139], a[148:151], v[24:27], 0
  ds_read_b64_tr_b16 a[172:173], v5 offset:4096
  ds_read_b64_tr_b16 a[174:175], v5 offset:6144
  v_mfma_f32_16x16x32_bf16 v[140:143], a[148:151], v[28:31], 0
  s_add_u32 s65, s56, 384
  s_add_u32 m0, s63, 36864
  v_mfma_f32_16x16x32_bf16 v[144:147], a[152:155], v[24:27], 0
  ds_read_b64_tr_b16 a[144:145], v2 offset:8192
  ds_read_b64_tr_b16 a[146:147], v2 offset:10240
  v_mfma_f32_16x16x32_bf16 v[148:151], a[152:155], v[28:31], 0
  buffer_load_dwordx4 v248, s[16:19], s65 offen lds
  v_mul_f32 v18, 0xbfb8aa3b, v98
  s_waitcnt lgkmcnt(15)
  s_bitcmp1_b32 s48, 0
  s_cbranch_scc0 K1_nosw3
  v_swap_b32 v72, v80
  v_swap_b32 v73, v81
  v_swap_b32 v74, v82
  v_swap_b32 v75, v83
  v_swap_b32 v76, v84
  v_swap_b32 v77, v85
  v_swap_b32 v78, v86
  v_swap_b32 v79, v87
K1_nosw3:
  s_waitcnt lgkmcnt(6)
  v_mfma_f32_16x16x32_bf16 v[152:155], a[156:159], v[24:27], 0
  ds_read_b64_tr_b16 a[148:149], v3 offset:8192
  ds_read_b64_tr_b16 a[150:151], v3 offset:10240
  v_mfma_f32_16x16x32_bf16 v[156:159], a[156:159], v[28:31], 0
  v_exp_f32 v16, v16
  v_mfma_f32_16x16x32_bf16 v[128:131], a[160:163], v[32:35], v[128:131]
  ds_read_b64_tr_b16 a[152:153], v4 offset:8192
  ds_read_b64_tr_b16 a[154:155], v4 offset:10240
  v_mfma_f32_16x16x32_bf16 v[132:135], a[160:163], v[36:39], v[132:135]
  buffer_load_dwordx4 v249, s[16:19], s65 offen offset:1024 lds
  v_add_f32 v16, 1.0, v16
  v_mfma_f32_16x16x32_bf16 v[136:139], a[164:167], v[32:35], v[136:139]
  ds_read_b64_tr_b16 a[156:157], v5 offset:8192
  ds_read_b64_tr_b16 a[158:159], v5 offset:10240
  v_mfma_f32_16x16x32_bf16 v[140:143], a[164:167], v[36:39], v[140:143]
  v_rcp_f32 v16, v16
  s_waitcnt lgkmcnt(6)
  v_mfma_f32_16x16x32_bf16 v[144:147], a[168:171], v[32:35], v[144:147]
  ds_read_b64_tr_b16 a[160:161], v2 offset:12288
  ds_read_b64_tr_b16 a[162:163], v2 offset:14336
  v_mfma_f32_16x16x32_bf16 v[148:151], a[168:171], v[36:39], v[148:151]
  buffer_load_dwordx4 v250, s[16:19], s65 offen offset:2048 lds
  v_mul_f32 v96, v96, v16
  v_mfma_f32_16x16x32_bf16 v[152:155], a[172:175], v[32:35], v[152:155]
  ds_read_b64_tr_b16 a[164:165], v3 offset:12288
  ds_read_b64_tr_b16 a[166:167], v3 offset:14336
  v_mfma_f32_16x16x32_bf16 v[156:159], a[172:175], v[36:39], v[156:159]
  v_exp_f32 v17, v17
  v_mfma_f32_16x16x32_bf16 v[128:131], a[144:147], v[40:43], v[128:131]
  ds_read_b64_tr_b16 a[168:169], v4 offset:12288
  ds_read_b64_tr_b16 a[170:171], v4 offset:14336
  v_mfma_f32_16x16x32_bf16 v[132:135], a[144:147], v[44:47], v[132:135]
  buffer_load_dwordx4 v251, s[16:19], s65 offen offset:3072 lds
  v_add_f32 v17, 1.0, v17
  s_waitcnt lgkmcnt(6)
  v_mfma_f32_16x16x32_bf16 v[136:139], a[148:151], v[40:43], v[136:139]
  ds_read_b64_tr_b16 a[172:173], v5 offset:12288
  ds_read_b64_tr_b16 a[174:175], v5 offset:14336
  v_mfma_f32_16x16x32_bf16 v[140:143], a[148:151], v[44:47], v[140:143]
  v_rcp_f32 v17, v17
  v_mfma_f32_16x16x32_bf16 v[144:147], a[152:155], v[40:43], v[144:147]
  ds_read_b64_tr_b16 a[144:145], v2 offset:16384
  ds_read_b64_tr_b16 a[146:147], v2 offset:18432
  v_mfma_f32_16x16x32_bf16 v[148:151], a[152:155], v[44:47], v[148:151]
  s_add_u32 s66, s56, 147840
  s_add_u32 m0, s63, 53248
  v_mfma_f32_16x16x32_bf16 v[152:155], a[156:159], v[40:43], v[152:155]
  ds_read_b64_tr_b16 a[148:149], v3 offset:16384
  ds_read_b64_tr_b16 a[150:151], v3 offset:18432
  v_mfma_f32_16x16x32_bf16 v[156:159], a[156:159], v[44:47], v[156:159]
  buffer_load_dwordx4 v248, s[16:19], s66 offen lds
  v_mul_f32 v97, v97, v17
  s_waitcnt lgkmcnt(6)
  v_mfma_f32_16x16x32_bf16 v[128:131], a[160:163], v[48:51], v[128:131]
  ds_read_b64_tr_b16 a[152:153], v4 offset:16384
  ds_read_b64_tr_b16 a[154:155], v4 offset:18432
  v_mfma_f32_16x16x32_bf16 v[132:135], a[160:163], v[52:55], v[132:135]
  v_exp_f32 v18, v18
  v_mfma_f32_16x16x32_bf16 v[136:139], a[164:167], v[48:51], v[136:139]
  ds_read_b64_tr_b16 a[156:157], v5 offset:16384
  ds_read_b64_tr_b16 a[158:159], v5 offset:18432
  v_mfma_f32_16x16x32_bf16 v[140:143], a[164:167], v[52:55], v[140:143]
  buffer_load_dwordx4 v249, s[16:19], s66 offen offset:1024 lds
  v_add_f32 v18, 1.0, v18
  v_mfma_f32_16x16x32_bf16 v[144:147], a[168:171], v[48:51], v[144:147]
  ds_read_b64_tr_b16 a[160:161], v2 offset:20480
  ds_read_b64_tr_b16 a[162:163], v2 offset:22528
  v_mfma_f32_16x16x32_bf16 v[148:151], a[168:171], v[52:55], v[148:151]
  v_rcp_f32 v18, v18
  s_waitcnt lgkmcnt(6)
  v_mfma_f32_16x16x32_bf16 v[152:155], a[172:175], v[48:51], v[152:155]
  ds_read_b64_tr_b16 a[164:165], v3 offset:20480
  ds_read_b64_tr_b16 a[166:167], v3 offset:22528
  v_mfma_f32_16x16x32_bf16 v[156:159], a[172:175], v[52:55], v[156:159]
  buffer_load_dwordx4 v250, s[16:19], s66 offen offset:2048 lds
  v_mul_f32 v98, v98, v18
  v_mfma_f32_16x16x32_bf16 v[128:131], a[144:147], v[56:59], v[128:131]
  ds_read_b64_tr_b16 a[168:169], v4 offset:20480
  ds_read_b64_tr_b16 a[170:171], v4 offset:22528
  v_mfma_f32_16x16x32_bf16 v[132:135], a[144:147], v[60:63], v[132:135]
  v_mul_f32 v19, 0xbfb8aa3b, v99
  v_mul_f32 v20, 0xbfb8aa3b, v100
  v_mfma_f32_16x16x32_bf16 v[136:139], a[148:151], v[56:59], v[136:139]
  ds_read_b64_tr_b16 a[172:173], v5 offset:20480
  ds_read_b64_tr_b16 a[174:175], v5 offset:22528
  v_mfma_f32_16x16x32_bf16 v[140:143], a[148:151], v[60:63], v[140:143]
  buffer_load_dwordx4 v251, s[16:19], s66 offen offset:3072 lds
  v_mul_f32 v21, 0xbfb8aa3b, v101
  s_waitcnt lgkmcnt(6)
  v_mfma_f32_16x16x32_bf16 v[144:147], a[152:155], v[56:59], v[144:147]
  ds_read_b64_tr_b16 a[144:145], v2 offset:24576
  ds_read_b64_tr_b16 a[146:147], v2 offset:26624
  v_mfma_f32_16x16x32_bf16 v[148:151], a[152:155], v[60:63], v[148:151]
  v_exp_f32 v19, v19
  v_mfma_f32_16x16x32_bf16 v[152:155], a[156:159], v[56:59], v[152:155]
  ds_read_b64_tr_b16 a[148:149], v3 offset:24576
  ds_read_b64_tr_b16 a[150:151], v3 offset:26624
  v_mfma_f32_16x16x32_bf16 v[156:159], a[156:159], v[60:63], v[156:159]
  s_add_u32 s67, s57, 384
  s_add_u32 m0, s64, 36864
  v_mfma_f32_16x16x32_bf16 v[128:131], a[160:163], v[64:67], v[128:131]
  ds_read_b64_tr_b16 a[152:153], v4 offset:24576
  ds_read_b64_tr_b16 a[154:155], v4 offset:26624
  v_mfma_f32_16x16x32_bf16 v[132:135], a[160:163], v[68:71], v[132:135]
  buffer_load_dwordx4 v248, s[16:19], s67 offen lds
  v_add_f32 v19, 1.0, v19
  s_waitcnt lgkmcnt(6)
  v_mfma_f32_16x16x32_bf16 v[136:139], a[164:167], v[64:67], v[136:139]
  ds_read_b64_tr_b16 a[156:157], v5 offset:24576
  ds_read_b64_tr_b16 a[158:159], v5 offset:26624
  v_mfma_f32_16x16x32_bf16 v[140:143], a[164:167], v[68:71], v[140:143]
  v_rcp_f32 v19, v19
  v_mfma_f32_16x16x32_bf16 v[144:147], a[168:171], v[64:67], v[144:147]
  ds_read_b64_tr_b16 a[160:161], v2 offset:28672
  ds_read_b64_tr_b16 a[162:163], v2 offset:30720
  v_mfma_f32_16x16x32_bf16 v[148:151], a[168:171], v[68:71], v[148:151]
  s_add_u32 s6, s68, 12288
  buffer_store_dwordx4 v[72:75], v1, s[24:27], s6 offen offset:0 sc1
  v_mfma_f32_16x16x32_bf16 v[152:155], a[172:175], v[64:67], v[152:155]
  ds_read_b64_tr_b16 a[164:165], v3 offset:28672
  ds_read_b64_tr_b16 a[166:167], v3 offset:30720
  v_mfma_f32_16x16x32_bf16 v[156:159], a[172:175], v[68:71], v[156:159]
  v_mul_f32 v99, v99, v19
  v_mul_f32 v22, 0xbfb8aa3b, v102
  s_waitcnt lgkmcnt(6)
  v_mfma_f32_16x16x32_bf16 v[128:131], a[144:147], v[72:75], v[128:131]
  ds_read_b64_tr_b16 a[168:169], v4 offset:28672
  ds_read_b64_tr_b16 a[170:171], v4 offset:30720
  v_mfma_f32_16x16x32_bf16 v[132:135], a[144:147], v[76:79], v[132:135]
  v_exp_f32 v20, v20
  v_mfma_f32_16x16x32_bf16 v[136:139], a[148:151], v[72:75], v[136:139]
  ds_read_b64_tr_b16 a[172:173], v5 offset:28672
  ds_read_b64_tr_b16 a[174:175], v5 offset:30720
  v_mfma_f32_16x16x32_bf16 v[140:143], a[148:151], v[76:79], v[140:143]
  v_add_f32 v20, 1.0, v20
  v_mul_f32 v23, 0xbfb8aa3b, v103
  v_mfma_f32_16x16x32_bf16 v[144:147], a[152:155], v[72:75], v[144:147]
  ds_read_b64_tr_b16 a[144:145], v2 offset:32768
  ds_read_b64_tr_b16 a[146:147], v2 offset:34816
  v_mfma_f32_16x16x32_bf16 v[148:151], a[152:155], v[76:79], v[148:151]
  s_add_u32 s6, s68, 12288
  buffer_store_dwordx4 v[76:79], v1, s[24:27], s6 offen offset:1024 sc1
  s_waitcnt lgkmcnt(6)
  v_mfma_f32_16x16x32_bf16 v[152:155], a[156:159], v[72:75], v[152:155]
  ds_read_b64_tr_b16 a[148:149], v3 offset:32768
  ds_read_b64_tr_b16 a[150:151], v3 offset:34816
  v_mfma_f32_16x16x32_bf16 v[156:159], a[156:159], v[76:79], v[156:159]
  v_rcp_f32 v20, v20
  v_mfma_f32_16x16x32_bf16 v[128:131], a[160:163], v[80:83], v[128:131]
  ds_read_b64_tr_b16 a[152:153], v4 offset:32768
  ds_read_b64_tr_b16 a[154:155], v4 offset:34816
  v_mfma_f32_16x16x32_bf16 v[132:135], a[160:163], v[84:87], v[132:135]
  v_mul_f32 v100, v100, v20
  v_mul_f32 v16, 0xbfb8aa3b, v104
  v_mfma_f32_16x16x32_bf16 v[136:139], a[164:167], v[80:83], v[136:139]
  ds_read_b64_tr_b16 a[156:157], v5 offset:32768
  ds_read_b64_tr_b16 a[158:159], v5 offset:34816
  v_mfma_f32_16x16x32_bf16 v[140:143], a[164:167], v[84:87], v[140:143]
  v_exp_f32 v21, v21
  v_exp_f32 v22, v22
  s_nop 0
  v_add_f32 v22, 1.0, v22
  v_rcp_f32 v22, v22
  s_nop 0
  v_mul_f32 v102, v102, v22
  v_mul_f32 v22, 0xbfb8aa3b, v110
  v_exp_f32 v22, v22
  s_nop 0
  v_add_f32 v22, 1.0, v22
  v_rcp_f32 v22, v22
  s_nop 0
  v_mul_f32 v110, v110, v22
  v_mul_f32 v110, v110, v206
  v_exp_f32 v23, v23
  s_nop 0
  v_add_f32 v23, 1.0, v23
  v_rcp_f32 v23, v23
  s_nop 0
  v_mul_f32 v103, v103, v23
  v_mul_f32 v23, 0xbfb8aa3b, v111
  v_exp_f32 v23, v23
  s_nop 0
  v_add_f32 v23, 1.0, v23
  v_rcp_f32 v23, v23
  s_nop 0
  v_mul_f32 v111, v111, v23
  v_mul_f32 v111, v111, v207
  v_mul_f32 v20, 0xbfb8aa3b, v108
  v_exp_f32 v20, v20
  s_nop 0
  v_add_f32 v20, 1.0, v20
  v_rcp_f32 v20, v20
  s_nop 0
  v_mul_f32 v108, v108, v20
  v_mul_f32 v108, v108, v204
  v_add_f32 v21, 1.0, v21
  v_rcp_f32 v21, v21
  s_nop 0
  v_mul_f32 v101, v101, v21
  v_mul_f32 v21, 0xbfb8aa3b, v109
  v_exp_f32 v21, v21
  s_nop 0
  v_add_f32 v21, 1.0, v21
  v_rcp_f32 v21, v21
  s_nop 0
  v_mul_f32 v109, v109, v21
  v_mul_f32 v109, v109, v205
  v_mul_f32 v102, v102, v198
  v_mul_f32 v103, v103, v199
  v_mul_f32 v100, v100, v196
  v_mul_f32 v101, v101, v197
  v_mul_f32 v18, 0xbfb8aa3b, v106
  v_exp_f32 v18, v18
  s_nop 0
  v_add_f32 v18, 1.0, v18
  v_rcp_f32 v18, v18
  s_nop 0
  v_mul_f32 v106, v106, v18
  v_mul_f32 v106, v106, v202
  v_mul_f32 v19, 0xbfb8aa3b, v107
  v_exp_f32 v19, v19
  s_nop 0
  v_add_f32 v19, 1.0, v19
  v_rcp_f32 v19, v19
  s_nop 0
  v_mul_f32 v107, v107, v19
  v_mul_f32 v107, v107, v203
  v_exp_f32 v16, v16
  s_nop 0
  v_add_f32 v16, 1.0, v16
  v_rcp_f32 v16, v16
  s_nop 0
  v_mul_f32 v104, v104, v16
  v_mul_f32 v104, v104, v200
  v_mul_f32 v17, 0xbfb8aa3b, v105
  v_exp_f32 v17, v17
  s_nop 0
  v_add_f32 v17, 1.0, v17
  v_rcp_f32 v17, v17
  s_nop 0
  v_mul_f32 v105, v105, v17
  v_mul_f32 v105, v105, v201
  v_mul_f32 v98, v98, v194
  v_mul_f32 v99, v99, v195
  v_mul_f32 v96, v96, v192
  v_mul_f32 v97, v97, v193
  v_cvt_pk_bf16_f32 v88, v96, v97
  v_cvt_pk_bf16_f32 v89, v98, v99
  v_cvt_pk_bf16_f32 v90, v104, v105
  v_cvt_pk_bf16_f32 v91, v106, v107
  v_cvt_pk_bf16_f32 v92, v100, v101
  v_cvt_pk_bf16_f32 v93, v102, v103
  v_cvt_pk_bf16_f32 v94, v108, v109
  v_cvt_pk_bf16_f32 v95, v110, v111
  s_waitcnt lgkmcnt(6)
  v_mfma_f32_16x16x32_bf16 v[144:147], a[168:171], v[80:83], v[144:147]
  s_add_u32 s6, s68, 12288
  buffer_store_dwordx4 v[80:83], v1, s[24:27], s6 offen offset:2048 sc1
  v_mfma_f32_16x16x32_bf16 v[148:151], a[168:171], v[84:87], v[148:151]
  v_mfma_f32_16x16x32_bf16 v[152:155], a[172:175], v[80:83], v[152:155]
  v_mfma_f32_16x16x32_bf16 v[156:159], a[172:175], v[84:87], v[156:159]
  v_mfma_f32_16x16x32_bf16 v[128:131], a[144:147], v[88:91], v[128:131]
  v_mfma_f32_16x16x32_bf16 v[132:135], a[144:147], v[92:95], v[132:135]
  s_waitcnt vmcnt(23) lgkmcnt(0)
  s_barrier
  v_add_u32 v2, 110592, v8
  v_xor_b32 v3, 32, v2
  v_xor_b32 v4, 64, v2
  v_xor_b32 v5, 0x60, v2
  v_mfma_f32_16x16x32_bf16 v[136:139], a[148:151], v[88:91], v[136:139]
  ds_read_b64_tr_b16 a[160:161], v2 offset:0
  ds_read_b64_tr_b16 a[162:163], v2 offset:2048
  v_mfma_f32_16x16x32_bf16 v[140:143], a[148:151], v[92:95], v[140:143]
  ds_read_b64_tr_b16 a[164:165], v3 offset:0
  ds_read_b64_tr_b16 a[166:167], v3 offset:2048
  v_mfma_f32_16x16x32_bf16 v[144:147], a[152:155], v[88:91], v[144:147]
  ds_read_b64_tr_b16 a[168:169], v4 offset:0
  ds_read_b64_tr_b16 a[170:171], v4 offset:2048
  ds_read_b64_tr_b16 a[172:173], v5 offset:0
  v_mfma_f32_16x16x32_bf16 v[148:151], a[152:155], v[92:95], v[148:151]
  ds_read_b64_tr_b16 a[174:175], v5 offset:2048
  s_add_u32 s6, s68, 12288
  buffer_store_dwordx4 v[84:87], v1, s[24:27], s6 offen offset:3072 sc1
  v_mfma_f32_16x16x32_bf16 v[152:155], a[156:159], v[88:91], v[152:155]
  ds_read_b64_tr_b16 a[144:145], v2 offset:4096
  ds_read_b64_tr_b16 a[146:147], v2 offset:6144
  v_mfma_f32_16x16x32_bf16 v[156:159], a[156:159], v[92:95], v[156:159]
  ds_read_b64_tr_b16 a[148:149], v3 offset:4096
  ds_read_b64_tr_b16 a[150:151], v3 offset:6144
  s_waitcnt lgkmcnt(6)
  v_mfma_f32_16x16x32_bf16 v[160:163], a[160:163], v[24:27], 0
  ds_read_b64_tr_b16 a[152:153], v4 offset:4096
  ds_read_b64_tr_b16 a[154:155], v4 offset:6144
  v_mfma_f32_16x16x32_bf16 v[164:167], a[160:163], v[28:31], 0
  v_bfe_u32 v20, v1, 4, 4
  s_and_b32 s4, s48, 1
  v_mfma_f32_16x16x32_bf16 v[168:171], a[164:167], v[24:27], 0
  ds_read_b64_tr_b16 a[156:157], v5 offset:4096
  ds_read_b64_tr_b16 a[158:159], v5 offset:6144
  v_mfma_f32_16x16x32_bf16 v[172:175], a[164:167], v[28:31], 0
  s_lshl_b32 s4, s4, 4
  v_add_u32 v20, s4, v20
  v_mfma_f32_16x16x32_bf16 v[176:179], a[168:171], v[24:27], 0
  ds_read_b64_tr_b16 a[160:161], v2 offset:8192
  ds_read_b64_tr_b16 a[162:163], v2 offset:10240
  v_mfma_f32_16x16x32_bf16 v[180:183], a[168:171], v[28:31], 0
  s_lshl_b32 s4, s82, 5
  v_add_u32 v21, s4, v20
  s_waitcnt lgkmcnt(6)
  v_mfma_f32_16x16x32_bf16 v[184:187], a[172:175], v[24:27], 0
  ds_read_b64_tr_b16 a[164:165], v3 offset:8192
  ds_read_b64_tr_b16 a[166:167], v3 offset:10240
  v_mfma_f32_16x16x32_bf16 v[188:191], a[172:175], v[28:31], 0
  s_add_u32 s6, s68, 16384
  buffer_store_dwordx4 v[88:91], v1, s[24:27], s6 offen offset:0 sc1
  v_mfma_f32_16x16x32_bf16 v[160:163], a[144:147], v[32:35], v[160:163]
  ds_read_b64_tr_b16 a[168:169], v4 offset:8192
  ds_read_b64_tr_b16 a[170:171], v4 offset:10240
  v_mfma_f32_16x16x32_bf16 v[164:167], a[144:147], v[36:39], v[164:167]
  v_cvt_f32_u32 v21, v21
  s_mov_b32 s4, 0x3ae38e39
  s_cmp_eq_u32 s81, 1
  s_cselect_b32 s4, 0xbae38e39, s4
  s_cselect_b32 s5, 0, 0x3e800000
  v_mfma_f32_16x16x32_bf16 v[168:171], a[148:151], v[32:35], v[168:171]
  ds_read_b64_tr_b16 a[172:173], v5 offset:8192
  ds_read_b64_tr_b16 a[174:175], v5 offset:10240
  v_mfma_f32_16x16x32_bf16 v[172:175], a[148:151], v[36:39], v[172:175]
  v_mul_f32 v21, s4, v21
  v_mov_b32 v22, s5
  v_mul_f32 v16, 0x42000000, v21
  v_fract_f32 v16, v16
  v_lshrrev_b32 v20, 8, v1
  v_lshlrev_b32 v20, 3, v20
  s_lshr_b32 s4, s48, 1
  s_mul_i32 s4, s4, 288
  v_add_u32 v20, s4, v20
  v_cvt_f32_u32 v20, v20
  v_mov_b32 v23, v20
  v_fma_f32 v192, v23, v21, v22
  v_fract_f32 v192, v192
  v_add_f32 v23, 1.0, v20
  v_fma_f32 v193, v23, v21, v22
  v_fract_f32 v193, v193
  v_add_f32 v23, 2.0, v20
  v_fma_f32 v194, v23, v21, v22
  v_fract_f32 v194, v194
  v_add_f32 v23, 3.0, v20
  v_fma_f32 v195, v23, v21, v22
  v_fract_f32 v195, v195
  v_add_f32 v23, 4.0, v20
  v_fma_f32 v196, v23, v21, v22
  v_fract_f32 v196, v196
  v_add_f32 v23, 5.0, v20
  v_fma_f32 v197, v23, v21, v22
  v_fract_f32 v197, v197
  v_add_f32 v23, 6.0, v20
  v_fma_f32 v198, v23, v21, v22
  v_fract_f32 v198, v198
  v_add_f32 v23, 7.0, v20
  v_fma_f32 v199, v23, v21, v22
  v_fract_f32 v199, v199
  s_lshr_b32 s4, s48, 1
  s_mul_i32 s4, s4, 18432
  s_and_b32 s5, s48, 1
  s_lshl_b32 s5, s5, 10
  s_add_u32 s4, s4, s5
  s_add_u32 s4, s4, 73728
  v_add_u32 v17, s4, v1
  v_add_u32 v18, 73728, v1
  s_nop 0
  s_waitcnt lgkmcnt(6)
  v_mfma_f32_16x16x32_bf16 v[176:179], a[152:155], v[32:35], v[176:179]
  ds_read_b64_tr_b16 a[144:145], v2 offset:12288
  ds_read_b64_tr_b16 a[146:147], v2 offset:14336
  v_mfma_f32_16x16x32_bf16 v[180:183], a[152:155], v[36:39], v[180:183]
  v_cos_f32 v19, v16
  v_mfma_f32_16x16x32_bf16 v[184:187], a[156:159], v[32:35], v[184:187]
  ds_read_b64_tr_b16 a[148:149], v3 offset:12288
  ds_read_b64_tr_b16 a[150:151], v3 offset:14336
  v_mfma_f32_16x16x32_bf16 v[188:191], a[156:159], v[36:39], v[188:191]
  v_add_f32 v19, v19, v19
  v_add_f32 v200, v192, v16
  v_mfma_f32_16x16x32_bf16 v[160:163], a[160:163], v[40:43], v[160:163]
  ds_read_b64_tr_b16 a[152:153], v4 offset:12288
  ds_read_b64_tr_b16 a[154:155], v4 offset:14336
  v_mfma_f32_16x16x32_bf16 v[164:167], a[160:163], v[44:47], v[164:167]
  s_add_u32 s6, s68, 16384
  buffer_store_dwordx4 v[92:95], v1, s[24:27], s6 offen offset:1024 sc1
  s_waitcnt lgkmcnt(6)
  v_mfma_f32_16x16x32_bf16 v[168:171], a[164:167], v[40:43], v[168:171]
  ds_read_b64_tr_b16 a[156:157], v5 offset:12288
  ds_read_b64_tr_b16 a[158:159], v5 offset:14336
  v_mfma_f32_16x16x32_bf16 v[172:175], a[164:167], v[44:47], v[172:175]
  v_add_f32 v201, v193, v16
  v_add_f32 v202, v194, v16
  v_mfma_f32_16x16x32_bf16 v[176:179], a[168:171], v[40:43], v[176:179]
  ds_read_b64_tr_b16 a[160:161], v2 offset:16384
  ds_read_b64_tr_b16 a[162:163], v2 offset:18432
  v_mfma_f32_16x16x32_bf16 v[180:183], a[168:171], v[44:47], v[180:183]
  v_add_f32 v203, v195, v16
  v_add_f32 v204, v196, v16
  v_mfma_f32_16x16x32_bf16 v[184:187], a[172:175], v[40:43], v[184:187]
  ds_read_b64_tr_b16 a[164:165], v3 offset:16384
  ds_read_b64_tr_b16 a[166:167], v3 offset:18432
  v_mfma_f32_16x16x32_bf16 v[188:191], a[172:175], v[44:47], v[188:191]
  v_add_f32 v205, v197, v16
  v_add_f32 v206, v198, v16
  s_waitcnt lgkmcnt(6)
  v_mfma_f32_16x16x32_bf16 v[160:163], a[144:147], v[48:51], v[160:163]
  ds_read_b64_tr_b16 a[168:169], v4 offset:16384
  ds_read_b64_tr_b16 a[170:171], v4 offset:18432
  v_mfma_f32_16x16x32_bf16 v[164:167], a[144:147], v[52:55], v[164:167]
  v_add_f32 v207, v199, v16
  v_mfma_f32_16x16x32_bf16 v[168:171], a[148:151], v[48:51], v[168:171]
  ds_read_b64_tr_b16 a[172:173], v5 offset:16384
  ds_read_b64_tr_b16 a[174:175], v5 offset:18432
  v_mfma_f32_16x16x32_bf16 v[172:175], a[148:151], v[52:55], v[172:175]
  v_sin_f32 v192, v192
  v_mfma_f32_16x16x32_bf16 v[176:179], a[152:155], v[48:51], v[176:179]
  ds_read_b64_tr_b16 a[144:145], v2 offset:20480
  ds_read_b64_tr_b16 a[146:147], v2 offset:22528
  v_mfma_f32_16x16x32_bf16 v[180:183], a[152:155], v[52:55], v[180:183]
  v_sin_f32 v193, v193
  s_waitcnt lgkmcnt(6)
  v_mfma_f32_16x16x32_bf16 v[184:187], a[156:159], v[48:51], v[184:187]
  ds_read_b64_tr_b16 a[148:149], v3 offset:20480
  ds_read_b64_tr_b16 a[150:151], v3 offset:22528
  v_mfma_f32_16x16x32_bf16 v[188:191], a[156:159], v[52:55], v[188:191]
  v_sin_f32 v194, v194
  v_mfma_f32_16x16x32_bf16 v[160:163], a[160:163], v[56:59], v[160:163]
  ds_read_b64_tr_b16 a[152:153], v4 offset:20480
  ds_read_b64_tr_b16 a[154:155], v4 offset:22528
  v_mfma_f32_16x16x32_bf16 v[164:167], a[160:163], v[60:63], v[164:167]
  v_sin_f32 v195, v195
  v_mfma_f32_16x16x32_bf16 v[168:171], a[164:167], v[56:59], v[168:171]
  ds_read_b64_tr_b16 a[156:157], v5 offset:20480
  ds_read_b64_tr_b16 a[158:159], v5 offset:22528
  v_mfma_f32_16x16x32_bf16 v[172:175], a[164:167], v[60:63], v[172:175]
  v_sin_f32 v196, v196
  s_waitcnt lgkmcnt(6)
  v_mfma_f32_16x16x32_bf16 v[176:179], a[168:171], v[56:59], v[176:179]
  ds_read_b64_tr_b16 a[160:161], v2 offset:24576
  ds_read_b64_tr_b16 a[162:163], v2 offset:26624
  v_mfma_f32_16x16x32_bf16 v[180:183], a[168:171], v[60:63], v[180:183]
  v_sin_f32 v197, v197
  v_mfma_f32_16x16x32_bf16 v[184:187], a[172:175], v[56:59], v[184:187]
  ds_read_b64_tr_b16 a[164:165], v3 offset:24576
  ds_read_b64_tr_b16 a[166:167], v3 offset:26624
  v_mfma_f32_16x16x32_bf16 v[188:191], a[172:175], v[60:63], v[188:191]
  v_sin_f32 v198, v198
  v_mfma_f32_16x16x32_bf16 v[160:163], a[144:147], v[64:67], v[160:163]
  ds_read_b64_tr_b16 a[168:169], v4 offset:24576
  ds_read_b64_tr_b16 a[170:171], v4 offset:26624
  v_mfma_f32_16x16x32_bf16 v[164:167], a[144:147], v[68:71], v[164:167]
  v_sin_f32 v199, v199
  s_waitcnt lgkmcnt(6)
  v_mfma_f32_16x16x32_bf16 v[168:171], a[148:151], v[64:67], v[168:171]
  ds_read_b64_tr_b16 a[172:173], v5 offset:24576
  ds_read_b64_tr_b16 a[174:175], v5 offset:26624
  v_mfma_f32_16x16x32_bf16 v[172:175], a[148:151], v[68:71], v[172:175]
  v_cvt_pk_bf16_f32 v20, v192, v193
  v_cvt_pk_bf16_f32 v21, v194, v195
  v_mfma_f32_16x16x32_bf16 v[176:179], a[152:155], v[64:67], v[176:179]
  ds_read_b64_tr_b16 a[144:145], v2 offset:28672
  ds_read_b64_tr_b16 a[146:147], v2 offset:30720
  v_mfma_f32_16x16x32_bf16 v[180:183], a[152:155], v[68:71], v[180:183]
  v_cvt_pk_bf16_f32 v22, v196, v197
  v_cvt_pk_bf16_f32 v23, v198, v199
  v_mfma_f32_16x16x32_bf16 v[184:187], a[156:159], v[64:67], v[184:187]
  ds_read_b64_tr_b16 a[148:149], v3 offset:28672
  ds_read_b64_tr_b16 a[150:151], v3 offset:30720
  v_mfma_f32_16x16x32_bf16 v[188:191], a[156:159], v[68:71], v[188:191]
  ds_write_b128 v17, v[20:23] offset:0
  s_waitcnt vmcnt(2)
  v_mov_b32 v13, 1
  buffer_store_dword v13, v12, s[24:27], 0 offen sc1
  s_waitcnt lgkmcnt(7)
  v_mfma_f32_16x16x32_bf16 v[160:163], a[160:163], v[72:75], v[160:163]
  ds_read_b64_tr_b16 a[152:153], v4 offset:28672
  ds_read_b64_tr_b16 a[154:155], v4 offset:30720
  v_mfma_f32_16x16x32_bf16 v[164:167], a[160:163], v[76:79], v[164:167]
  v_sin_f32 v200, v200
  v_mfma_f32_16x16x32_bf16 v[168:171], a[164:167], v[72:75], v[168:171]
  ds_read_b64_tr_b16 a[156:157], v5 offset:28672
  ds_read_b64_tr_b16 a[158:159], v5 offset:30720
  v_mfma_f32_16x16x32_bf16 v[172:175], a[164:167], v[76:79], v[172:175]
  v_sin_f32 v201, v201
  v_mfma_f32_16x16x32_bf16 v[176:179], a[168:171], v[72:75], v[176:179]
  ds_read_b64_tr_b16 a[160:161], v2 offset:32768
  ds_read_b64_tr_b16 a[162:163], v2 offset:34816
  v_mfma_f32_16x16x32_bf16 v[180:183], a[168:171], v[76:79], v[180:183]
  v_sin_f32 v202, v202
  s_waitcnt lgkmcnt(7)
  v_mfma_f32_16x16x32_bf16 v[184:187], a[172:175], v[72:75], v[184:187]
  ds_read_b64_tr_b16 a[164:165], v3 offset:32768
  ds_read_b64_tr_b16 a[166:167], v3 offset:34816
  v_mfma_f32_16x16x32_bf16 v[188:191], a[172:175], v[76:79], v[188:191]
  v_sin_f32 v203, v203
  v_mfma_f32_16x16x32_bf16 v[160:163], a[144:147], v[80:83], v[160:163]
  ds_read_b64_tr_b16 a[168:169], v4 offset:32768
  ds_read_b64_tr_b16 a[170:171], v4 offset:34816
  v_mfma_f32_16x16x32_bf16 v[164:167], a[144:147], v[84:87], v[164:167]
  v_sin_f32 v204, v204
  v_mfma_f32_16x16x32_bf16 v[168:171], a[148:151], v[80:83], v[168:171]
  ds_read_b64_tr_b16 a[172:173], v5 offset:32768
  ds_read_b64_tr_b16 a[174:175], v5 offset:34816
  v_mfma_f32_16x16x32_bf16 v[172:175], a[148:151], v[84:87], v[172:175]
  v_sin_f32 v205, v205
  s_waitcnt lgkmcnt(6)
  v_mfma_f32_16x16x32_bf16 v[176:179], a[152:155], v[80:83], v[176:179]
  v_cvt_pk_bf16_f32 v20, v200, v201
  v_mfma_f32_16x16x32_bf16 v[180:183], a[152:155], v[84:87], v[180:183]
  v_sin_f32 v206, v206
  v_mfma_f32_16x16x32_bf16 v[184:187], a[156:159], v[80:83], v[184:187]
  v_sin_f32 v207, v207
  v_mfma_f32_16x16x32_bf16 v[188:191], a[156:159], v[84:87], v[188:191]
  v_cvt_pk_bf16_f32 v21, v202, v203
  v_cvt_pk_bf16_f32 v22, v204, v205
  v_mfma_f32_16x16x32_bf16 v[160:163], a[160:163], v[88:91], v[160:163]
  v_mfma_f32_16x16x32_bf16 v[164:167], a[160:163], v[92:95], v[164:167]
  s_waitcnt vmcnt(16) lgkmcnt(0)
  s_barrier
  v_mov_b32 v2, v8
  v_xor_b32 v3, 32, v2
  v_xor_b32 v4, 64, v2
  v_xor_b32 v5, 0x60, v2
  v_mfma_f32_16x16x32_bf16 v[168:171], a[164:167], v[88:91], v[168:171]
  ds_read_b64_tr_b16 a[144:145], v2 offset:0
  ds_read_b64_tr_b16 a[146:147], v2 offset:2048
  v_mfma_f32_16x16x32_bf16 v[172:175], a[164:167], v[92:95], v[172:175]
  ds_read_b64_tr_b16 a[148:149], v3 offset:0
  ds_read_b64_tr_b16 a[150:151], v3 offset:2048
  v_mfma_f32_16x16x32_bf16 v[176:179], a[168:171], v[88:91], v[176:179]
  ds_read_b64_tr_b16 a[152:153], v4 offset:0
  ds_read_b64_tr_b16 a[154:155], v4 offset:2048
  v_mfma_f32_16x16x32_bf16 v[180:183], a[168:171], v[92:95], v[180:183]
  ds_read_b64_tr_b16 a[156:157], v5 offset:0
  ds_read_b64_tr_b16 a[158:159], v5 offset:2048
  v_mfma_f32_16x16x32_bf16 v[184:187], a[172:175], v[88:91], v[184:187]
  ds_read_b64_tr_b16 a[160:161], v2 offset:4096
  ds_read_b64_tr_b16 a[162:163], v2 offset:6144
  v_mfma_f32_16x16x32_bf16 v[188:191], a[172:175], v[92:95], v[188:191]
  ds_read_b64_tr_b16 a[164:165], v3 offset:4096
  ds_read_b64_tr_b16 a[166:167], v3 offset:6144
  s_waitcnt vmcnt(1)
  v_mov_b32 v13, 2
  buffer_store_dword v13, v12, s[24:27], 0 offen sc1
  s_waitcnt lgkmcnt(6)
  v_mfma_f32_16x16x32_bf16 v[208:211], a[144:147], v[24:27], 0
  ds_read_b64_tr_b16 a[168:169], v4 offset:4096
  ds_read_b64_tr_b16 a[170:171], v4 offset:6144
  v_mfma_f32_16x16x32_bf16 v[212:215], a[144:147], v[28:31], 0
  v_cvt_pk_bf16_f32 v23, v206, v207
  ds_write_b128 v17, v[20:23] offset:2048
  v_mfma_f32_16x16x32_bf16 v[216:219], a[148:151], v[24:27], 0
  ds_read_b64_tr_b16 a[172:173], v5 offset:4096
  ds_read_b64_tr_b16 a[174:175], v5 offset:6144
  v_mfma_f32_16x16x32_bf16 v[220:223], a[148:151], v[28:31], 0
  s_add_u32 s65, s60, 0
  s_add_u32 m0, s63, 110592
  v_mfma_f32_16x16x32_bf16 v[224:227], a[152:155], v[24:27], 0
  ds_read_b64_tr_b16 a[144:145], v2 offset:8192
  ds_read_b64_tr_b16 a[146:147], v2 offset:10240
  v_mfma_f32_16x16x32_bf16 v[228:231], a[152:155], v[28:31], 0
  buffer_load_dwordx4 v252, s[16:19], s65 offen lds
  v_fma_f32 v192, v19, v200, -v192
  s_waitcnt lgkmcnt(7)
  v_mfma_f32_16x16x32_bf16 v[232:235], a[156:159], v[24:27], 0
  ds_read_b64_tr_b16 a[148:149], v3 offset:8192
  ds_read_b64_tr_b16 a[150:151], v3 offset:10240
  v_mfma_f32_16x16x32_bf16 v[236:239], a[156:159], v[28:31], 0
  v_fma_f32 v193, v19, v201, -v193
  v_fma_f32 v194, v19, v202, -v194
  v_mfma_f32_16x16x32_bf16 v[208:211], a[160:163], v[32:35], v[208:211]
  ds_read_b64_tr_b16 a[152:153], v4 offset:8192
  ds_read_b64_tr_b16 a[154:155], v4 offset:10240
  v_mfma_f32_16x16x32_bf16 v[212:215], a[160:163], v[36:39], v[212:215]
  buffer_load_dwordx4 v253, s[16:19], s65 offen offset:1024 lds
  v_fma_f32 v195, v19, v203, -v195
  v_mfma_f32_16x16x32_bf16 v[216:219], a[164:167], v[32:35], v[216:219]
  ds_read_b64_tr_b16 a[156:157], v5 offset:8192
  ds_read_b64_tr_b16 a[158:159], v5 offset:10240
  v_mfma_f32_16x16x32_bf16 v[220:223], a[164:167], v[36:39], v[220:223]
  v_fma_f32 v196, v19, v204, -v196
  v_fma_f32 v197, v19, v205, -v197
  s_waitcnt lgkmcnt(6)
  v_mfma_f32_16x16x32_bf16 v[224:227], a[168:171], v[32:35], v[224:227]
  ds_read_b64_tr_b16 a[160:161], v2 offset:12288
  ds_read_b64_tr_b16 a[162:163], v2 offset:14336
  v_mfma_f32_16x16x32_bf16 v[228:231], a[168:171], v[36:39], v[228:231]
  buffer_load_dwordx4 v254, s[16:19], s65 offen offset:2048 lds
  v_fma_f32 v198, v19, v206, -v198
  v_mfma_f32_16x16x32_bf16 v[232:235], a[172:175], v[32:35], v[232:235]
  ds_read_b64_tr_b16 a[164:165], v3 offset:12288
  ds_read_b64_tr_b16 a[166:167], v3 offset:14336
  v_mfma_f32_16x16x32_bf16 v[236:239], a[172:175], v[36:39], v[236:239]
  v_fma_f32 v199, v19, v207, -v199
  v_cvt_pk_bf16_f32 v20, v192, v193
  v_mfma_f32_16x16x32_bf16 v[208:211], a[144:147], v[40:43], v[208:211]
  ds_read_b64_tr_b16 a[168:169], v4 offset:12288
  ds_read_b64_tr_b16 a[170:171], v4 offset:14336
  v_mfma_f32_16x16x32_bf16 v[212:215], a[144:147], v[44:47], v[212:215]
  buffer_load_dwordx4 v255, s[16:19], s65 offen offset:3072 lds
  v_cvt_pk_bf16_f32 v21, v194, v195
  s_waitcnt lgkmcnt(6)
  v_mfma_f32_16x16x32_bf16 v[216:219], a[148:151], v[40:43], v[216:219]
  ds_read_b64_tr_b16 a[172:173], v5 offset:12288
  ds_read_b64_tr_b16 a[174:175], v5 offset:14336
  v_mfma_f32_16x16x32_bf16 v[220:223], a[148:151], v[44:47], v[220:223]
  v_cvt_pk_bf16_f32 v22, v196, v197
  v_cvt_pk_bf16_f32 v23, v198, v199
  v_mfma_f32_16x16x32_bf16 v[224:227], a[152:155], v[40:43], v[224:227]
  ds_read_b64_tr_b16 a[144:145], v2 offset:16384
  ds_read_b64_tr_b16 a[146:147], v2 offset:18432
  v_mfma_f32_16x16x32_bf16 v[228:231], a[152:155], v[44:47], v[228:231]
  s_add_u32 s66, s61, 0
  s_add_u32 m0, s63, 126976
  v_mfma_f32_16x16x32_bf16 v[232:235], a[156:159], v[40:43], v[232:235]
  ds_read_b64_tr_b16 a[148:149], v3 offset:16384
  ds_read_b64_tr_b16 a[150:151], v3 offset:18432
  v_mfma_f32_16x16x32_bf16 v[236:239], a[156:159], v[44:47], v[236:239]
  buffer_load_dwordx4 v252, s[16:19], s66 offen lds
  ds_write_b128 v17, v[20:23] offset:4096
  s_waitcnt lgkmcnt(7)
  v_mfma_f32_16x16x32_bf16 v[208:211], a[160:163], v[48:51], v[208:211]
  ds_read_b64_tr_b16 a[152:153], v4 offset:16384
  ds_read_b64_tr_b16 a[154:155], v4 offset:18432
  v_mfma_f32_16x16x32_bf16 v[212:215], a[160:163], v[52:55], v[212:215]
  v_fma_f32 v200, v19, v192, -v200
  v_fma_f32 v201, v19, v193, -v201
  v_mfma_f32_16x16x32_bf16 v[216:219], a[164:167], v[48:51], v[216:219]
  ds_read_b64_tr_b16 a[156:157], v5 offset:16384
  ds_read_b64_tr_b16 a[158:159], v5 offset:18432
  v_mfma_f32_16x16x32_bf16 v[220:223], a[164:167], v[52:55], v[220:223]
  buffer_load_dwordx4 v253, s[16:19], s66 offen offset:1024 lds
  v_fma_f32 v202, v19, v194, -v202
  v_mfma_f32_16x16x32_bf16 v[224:227], a[168:171], v[48:51], v[224:227]
  ds_read_b64_tr_b16 a[160:161], v2 offset:20480
  ds_read_b64_tr_b16 a[162:163], v2 offset:22528
  v_mfma_f32_16x16x32_bf16 v[228:231], a[168:171], v[52:55], v[228:231]
  v_fma_f32 v203, v19, v195, -v203
  v_fma_f32 v204, v19, v196, -v204
  s_waitcnt lgkmcnt(7)
  v_mfma_f32_16x16x32_bf16 v[232:235], a[172:175], v[48:51], v[232:235]
  ds_read_b64_tr_b16 a[164:165], v3 offset:20480
  ds_read_b64_tr_b16 a[166:167], v3 offset:22528
  v_mfma_f32_16x16x32_bf16 v[236:239], a[172:175], v[52:55], v[236:239]
  buffer_load_dwordx4 v254, s[16:19], s66 offen offset:2048 lds
  v_fma_f32 v205, v19, v197, -v205
  v_mfma_f32_16x16x32_bf16 v[208:211], a[144:147], v[56:59], v[208:211]
  ds_read_b64_tr_b16 a[168:169], v4 offset:20480
  ds_read_b64_tr_b16 a[170:171], v4 offset:22528
  v_mfma_f32_16x16x32_bf16 v[212:215], a[144:147], v[60:63], v[212:215]
  v_fma_f32 v206, v19, v198, -v206
  v_fma_f32 v207, v19, v199, -v207
  v_mfma_f32_16x16x32_bf16 v[216:219], a[148:151], v[56:59], v[216:219]
  ds_read_b64_tr_b16 a[172:173], v5 offset:20480
  ds_read_b64_tr_b16 a[174:175], v5 offset:22528
  v_mfma_f32_16x16x32_bf16 v[220:223], a[148:151], v[60:63], v[220:223]
  buffer_load_dwordx4 v255, s[16:19], s66 offen offset:3072 lds
  v_cvt_pk_bf16_f32 v20, v200, v201
  s_waitcnt lgkmcnt(6)
  v_mfma_f32_16x16x32_bf16 v[224:227], a[152:155], v[56:59], v[224:227]
  ds_read_b64_tr_b16 a[144:145], v2 offset:24576
  ds_read_b64_tr_b16 a[146:147], v2 offset:26624
  v_mfma_f32_16x16x32_bf16 v[228:231], a[152:155], v[60:63], v[228:231]
  v_cvt_pk_bf16_f32 v21, v202, v203
  v_cvt_pk_bf16_f32 v22, v204, v205
  v_mfma_f32_16x16x32_bf16 v[232:235], a[156:159], v[56:59], v[232:235]
  ds_read_b64_tr_b16 a[148:149], v3 offset:24576
  ds_read_b64_tr_b16 a[150:151], v3 offset:26624
  v_mfma_f32_16x16x32_bf16 v[236:239], a[156:159], v[60:63], v[236:239]
  s_add_u32 s67, s62, 0
  s_add_u32 m0, s64, 110592
  v_mfma_f32_16x16x32_bf16 v[208:211], a[160:163], v[64:67], v[208:211]
  ds_read_b64_tr_b16 a[152:153], v4 offset:24576
  ds_read_b64_tr_b16 a[154:155], v4 offset:26624
  v_mfma_f32_16x16x32_bf16 v[212:215], a[160:163], v[68:71], v[212:215]
  buffer_load_dwordx4 v252, s[16:19], s67 offen lds
  v_cvt_pk_bf16_f32 v23, v206, v207
  s_waitcnt lgkmcnt(6)
  v_mfma_f32_16x16x32_bf16 v[216:219], a[164:167], v[64:67], v[216:219]
  ds_read_b64_tr_b16 a[156:157], v5 offset:24576
  ds_read_b64_tr_b16 a[158:159], v5 offset:26624
  v_mfma_f32_16x16x32_bf16 v[220:223], a[164:167], v[68:71], v[220:223]
  ds_write_b128 v17, v[20:23] offset:6144
  v_fma_f32 v192, v19, v200, -v192
  v_mfma_f32_16x16x32_bf16 v[224:227], a[168:171], v[64:67], v[224:227]
  ds_read_b64_tr_b16 a[160:161], v2 offset:28672
  ds_read_b64_tr_b16 a[162:163], v2 offset:30720
  v_mfma_f32_16x16x32_bf16 v[228:231], a[168:171], v[68:71], v[228:231]
  v_fma_f32 v193, v19, v201, -v193
  v_fma_f32 v194, v19, v202, -v194
  v_mfma_f32_16x16x32_bf16 v[232:235], a[172:175], v[64:67], v[232:235]
  ds_read_b64_tr_b16 a[164:165], v3 offset:28672
  ds_read_b64_tr_b16 a[166:167], v3 offset:30720
  v_mfma_f32_16x16x32_bf16 v[236:239], a[172:175], v[68:71], v[236:239]
  v_fma_f32 v195, v19, v203, -v195
  v_fma_f32 v196, v19, v204, -v196
  s_waitcnt lgkmcnt(7)
  v_mfma_f32_16x16x32_bf16 v[208:211], a[144:147], v[72:75], v[208:211]
  ds_read_b64_tr_b16 a[168:169], v4 offset:28672
  ds_read_b64_tr_b16 a[170:171], v4 offset:30720
  v_mfma_f32_16x16x32_bf16 v[212:215], a[144:147], v[76:79], v[212:215]
  v_fma_f32 v197, v19, v205, -v197
  v_fma_f32 v198, v19, v206, -v198
  v_mfma_f32_16x16x32_bf16 v[216:219], a[148:151], v[72:75], v[216:219]
  ds_read_b64_tr_b16 a[172:173], v5 offset:28672
  ds_read_b64_tr_b16 a[174:175], v5 offset:30720
  v_mfma_f32_16x16x32_bf16 v[220:223], a[148:151], v[76:79], v[220:223]
  v_fma_f32 v199, v19, v207, -v199
  v_cvt_pk_bf16_f32 v20, v192, v193
  v_mfma_f32_16x16x32_bf16 v[224:227], a[152:155], v[72:75], v[224:227]
  ds_read_b64_tr_b16 a[144:145], v2 offset:32768
  ds_read_b64_tr_b16 a[146:147], v2 offset:34816
  v_mfma_f32_16x16x32_bf16 v[228:231], a[152:155], v[76:79], v[228:231]
  buffer_load_dword v10, off, s[24:27], s74 sc1
  v_cvt_pk_bf16_f32 v21, v194, v195
  s_waitcnt lgkmcnt(6)
  v_mfma_f32_16x16x32_bf16 v[232:235], a[156:159], v[72:75], v[232:235]
  ds_read_b64_tr_b16 a[148:149], v3 offset:32768
  ds_read_b64_tr_b16 a[150:151], v3 offset:34816
  v_mfma_f32_16x16x32_bf16 v[236:239], a[156:159], v[76:79], v[236:239]
  v_cvt_pk_bf16_f32 v22, v196, v197
  v_cvt_pk_bf16_f32 v23, v198, v199
  v_mfma_f32_16x16x32_bf16 v[208:211], a[160:163], v[80:83], v[208:211]
  ds_read_b64_tr_b16 a[152:153], v4 offset:32768
  ds_read_b64_tr_b16 a[154:155], v4 offset:34816
  v_mfma_f32_16x16x32_bf16 v[212:215], a[160:163], v[84:87], v[212:215]
  ds_write_b128 v17, v[20:23] offset:8192
  v_fma_f32 v200, v19, v192, -v200
  v_mfma_f32_16x16x32_bf16 v[216:219], a[164:167], v[80:83], v[216:219]
  ds_read_b64_tr_b16 a[156:157], v5 offset:32768
  ds_read_b64_tr_b16 a[158:159], v5 offset:34816
  v_mfma_f32_16x16x32_bf16 v[220:223], a[164:167], v[84:87], v[220:223]
  v_fma_f32 v201, v19, v193, -v201
  v_fma_f32 v202, v19, v194, -v202
  s_waitcnt lgkmcnt(7)
  v_mfma_f32_16x16x32_bf16 v[224:227], a[168:171], v[80:83], v[224:227]
  v_fma_f32 v203, v19, v195, -v203
  v_mfma_f32_16x16x32_bf16 v[228:231], a[168:171], v[84:87], v[228:231]
  v_fma_f32 v204, v19, v196, -v204
  v_fma_f32 v205, v19, v197, -v205
  v_mfma_f32_16x16x32_bf16 v[232:235], a[172:175], v[80:83], v[232:235]
  v_fma_f32 v206, v19, v198, -v206
  v_fma_f32 v207, v19, v199, -v207
  v_mfma_f32_16x16x32_bf16 v[236:239], a[172:175], v[84:87], v[236:239]
  v_cvt_pk_bf16_f32 v20, v200, v201
  v_cvt_pk_bf16_f32 v21, v202, v203
  v_mfma_f32_16x16x32_bf16 v[208:211], a[144:147], v[88:91], v[208:211]
  v_mfma_f32_16x16x32_bf16 v[212:215], a[144:147], v[92:95], v[212:215]
  s_waitcnt vmcnt(18) lgkmcnt(0)
  s_barrier
  v_add_u32 v2, 36864, v8
  v_xor_b32 v3, 32, v2
  v_xor_b32 v4, 64, v2
  v_xor_b32 v5, 0x60, v2
  v_mfma_f32_16x16x32_bf16 v[216:219], a[148:151], v[88:91], v[216:219]
  ds_read_b64_tr_b16 a[160:161], v2 offset:0
  ds_read_b64_tr_b16 a[162:163], v2 offset:2048
  v_mfma_f32_16x16x32_bf16 v[220:223], a[148:151], v[92:95], v[220:223]
  ds_read_b64_tr_b16 a[164:165], v3 offset:0
  ds_read_b64_tr_b16 a[166:167], v3 offset:2048
  v_mfma_f32_16x16x32_bf16 v[224:227], a[152:155], v[88:91], v[224:227]
  ds_read_b64_tr_b16 a[168:169], v4 offset:0
  ds_read_b64_tr_b16 a[170:171], v4 offset:2048
  v_mfma_f32_16x16x32_bf16 v[228:231], a[152:155], v[92:95], v[228:231]
  ds_read_b64_tr_b16 a[172:173], v5 offset:0
  ds_read_b64_tr_b16 a[174:175], v5 offset:2048
  v_mfma_f32_16x16x32_bf16 v[232:235], a[156:159], v[88:91], v[232:235]
  ds_read_b64_tr_b16 a[144:145], v2 offset:4096
  ds_read_b64_tr_b16 a[146:147], v2 offset:6144
  v_mfma_f32_16x16x32_bf16 v[236:239], a[156:159], v[92:95], v[236:239]
  ds_read_b64_tr_b16 a[148:149], v3 offset:4096
  ds_read_b64_tr_b16 a[150:151], v3 offset:6144
  s_waitcnt lgkmcnt(6)
  v_mfma_f32_16x16x32_bf16 v[96:99], a[160:163], v[24:27], 0
  ds_read_b64_tr_b16 a[152:153], v4 offset:4096
  ds_read_b64_tr_b16 a[154:155], v4 offset:6144
  v_mfma_f32_16x16x32_bf16 v[100:103], a[160:163], v[28:31], 0
  v_cvt_pk_bf16_f32 v22, v204, v205
  v_cvt_pk_bf16_f32 v23, v206, v207
  v_mfma_f32_16x16x32_bf16 v[104:107], a[164:167], v[24:27], 0
  ds_read_b64_tr_b16 a[156:157], v5 offset:4096
  ds_read_b64_tr_b16 a[158:159], v5 offset:6144
  v_mfma_f32_16x16x32_bf16 v[108:111], a[164:167], v[28:31], 0
  s_add_u32 s65, s58, 0
  s_add_u32 m0, s63, 0
  v_mfma_f32_16x16x32_bf16 v[112:115], a[168:171], v[24:27], 0
  ds_read_b64_tr_b16 a[160:161], v2 offset:8192
  ds_read_b64_tr_b16 a[162:163], v2 offset:10240
  v_mfma_f32_16x16x32_bf16 v[116:119], a[168:171], v[28:31], 0
  buffer_load_dwordx4 v248, s[16:19], s65 offen lds
  ds_write_b128 v17, v[20:23] offset:10240
  s_waitcnt lgkmcnt(7)
  v_mfma_f32_16x16x32_bf16 v[120:123], a[172:175], v[24:27], 0
  ds_read_b64_tr_b16 a[164:165], v3 offset:8192
  ds_read_b64_tr_b16 a[166:167], v3 offset:10240
  v_mfma_f32_16x16x32_bf16 v[124:127], a[172:175], v[28:31], 0
  v_fma_f32 v192, v19, v200, -v192
  v_fma_f32 v193, v19, v201, -v193
  v_mfma_f32_16x16x32_bf16 v[96:99], a[144:147], v[32:35], v[96:99]
  ds_read_b64_tr_b16 a[168:169], v4 offset:8192
  ds_read_b64_tr_b16 a[170:171], v4 offset:10240
  v_mfma_f32_16x16x32_bf16 v[100:103], a[144:147], v[36:39], v[100:103]
  buffer_load_dwordx4 v249, s[16:19], s65 offen offset:1024 lds
  v_fma_f32 v194, v19, v202, -v194
  v_mfma_f32_16x16x32_bf16 v[104:107], a[148:151], v[32:35], v[104:107]
  ds_read_b64_tr_b16 a[172:173], v5 offset:8192
  ds_read_b64_tr_b16 a[174:175], v5 offset:10240
  v_mfma_f32_16x16x32_bf16 v[108:111], a[148:151], v[36:39], v[108:111]
  v_fma_f32 v195, v19, v203, -v195
  v_fma_f32 v196, v19, v204, -v196
  s_waitcnt lgkmcnt(7)
  v_mfma_f32_16x16x32_bf16 v[112:115], a[152:155], v[32:35], v[112:115]
  ds_read_b64_tr_b16 a[144:145], v2 offset:12288
  ds_read_b64_tr_b16 a[146:147], v2 offset:14336
  v_mfma_f32_16x16x32_bf16 v[116:119], a[152:155], v[36:39], v[116:119]
  buffer_load_dwordx4 v250, s[16:19], s65 offen offset:2048 lds
  v_fma_f32 v197, v19, v205, -v197
  v_mfma_f32_16x16x32_bf16 v[120:123], a[156:159], v[32:35], v[120:123]
  ds_read_b64_tr_b16 a[148:149], v3 offset:12288
  ds_read_b64_tr_b16 a[150:151], v3 offset:14336
  v_mfma_f32_16x16x32_bf16 v[124:127], a[156:159], v[36:39], v[124:127]
  v_fma_f32 v198, v19, v206, -v198
  v_fma_f32 v199, v19, v207, -v199
  v_mfma_f32_16x16x32_bf16 v[96:99], a[160:163], v[40:43], v[96:99]
  ds_read_b64_tr_b16 a[152:153], v4 offset:12288
  ds_read_b64_tr_b16 a[154:155], v4 offset:14336
  v_mfma_f32_16x16x32_bf16 v[100:103], a[160:163], v[44:47], v[100:103]
  buffer_load_dwordx4 v251, s[16:19], s65 offen offset:3072 lds
  v_cvt_pk_bf16_f32 v20, v192, v193
  s_waitcnt lgkmcnt(6)
  v_mfma_f32_16x16x32_bf16 v[104:107], a[164:167], v[40:43], v[104:107]
  ds_read_b64_tr_b16 a[156:157], v5 offset:12288
  ds_read_b64_tr_b16 a[158:159], v5 offset:14336
  v_mfma_f32_16x16x32_bf16 v[108:111], a[164:167], v[44:47], v[108:111]
  v_cvt_pk_bf16_f32 v21, v194, v195
  v_cvt_pk_bf16_f32 v22, v196, v197
  v_mfma_f32_16x16x32_bf16 v[112:115], a[168:171], v[40:43], v[112:115]
  ds_read_b64_tr_b16 a[160:161], v2 offset:16384
  ds_read_b64_tr_b16 a[162:163], v2 offset:18432
  v_mfma_f32_16x16x32_bf16 v[116:119], a[168:171], v[44:47], v[116:119]
  s_add_u32 s66, s58, 147456
  s_add_u32 m0, s63, 16384
  v_mfma_f32_16x16x32_bf16 v[120:123], a[172:175], v[40:43], v[120:123]
  ds_read_b64_tr_b16 a[164:165], v3 offset:16384
  ds_read_b64_tr_b16 a[166:167], v3 offset:18432
  v_mfma_f32_16x16x32_bf16 v[124:127], a[172:175], v[44:47], v[124:127]
  buffer_load_dwordx4 v248, s[16:19], s66 offen lds
  v_cvt_pk_bf16_f32 v23, v198, v199
  s_waitcnt vmcnt(5)
  v_readfirstlane_b32 s88, v10
  s_nop 3
  s_cmp_ge_u32 s88, 1
  s_cbranch_scc0 K1_spin
K1_spin_done:
  s_waitcnt lgkmcnt(6)
  v_mfma_f32_16x16x32_bf16 v[96:99], a[144:147], v[48:51], v[96:99]
  ds_read_b64_tr_b16 a[168:169], v4 offset:16384
  ds_read_b64_tr_b16 a[170:171], v4 offset:18432
  v_mfma_f32_16x16x32_bf16 v[100:103], a[144:147], v[52:55], v[100:103]
  ds_write_b128 v17, v[20:23] offset:12288
  v_fma_f32 v200, v19, v192, -v200
  v_mfma_f32_16x16x32_bf16 v[104:107], a[148:151], v[48:51], v[104:107]
  ds_read_b64_tr_b16 a[172:173], v5 offset:16384
  ds_read_b64_tr_b16 a[174:175], v5 offset:18432
  v_mfma_f32_16x16x32_bf16 v[108:111], a[148:151], v[52:55], v[108:111]
  buffer_load_dwordx4 v249, s[16:19], s66 offen offset:1024 lds
  v_fma_f32 v201, v19, v193, -v201
  v_mfma_f32_16x16x32_bf16 v[112:115], a[152:155], v[48:51], v[112:115]
  ds_read_b64_tr_b16 a[144:145], v2 offset:20480
  ds_read_b64_tr_b16 a[146:147], v2 offset:22528
  v_mfma_f32_16x16x32_bf16 v[116:119], a[152:155], v[52:55], v[116:119]
  v_fma_f32 v202, v19, v194, -v202
  v_fma_f32 v203, v19, v195, -v203
  s_waitcnt lgkmcnt(7)
  v_mfma_f32_16x16x32_bf16 v[120:123], a[156:159], v[48:51], v[120:123]
  ds_read_b64_tr_b16 a[148:149], v3 offset:20480
  ds_read_b64_tr_b16 a[150:151], v3 offset:22528
  v_mfma_f32_16x16x32_bf16 v[124:127], a[156:159], v[52:55], v[124:127]
  buffer_load_dwordx4 v250, s[16:19], s66 offen offset:2048 lds
  v_fma_f32 v204, v19, v196, -v204
  v_mfma_f32_16x16x32_bf16 v[96:99], a[160:163], v[56:59], v[96:99]
  ds_read_b64_tr_b16 a[152:153], v4 offset:20480
  ds_read_b64_tr_b16 a[154:155], v4 offset:22528
  v_mfma_f32_16x16x32_bf16 v[100:103], a[160:163], v[60:63], v[100:103]
  v_fma_f32 v205, v19, v197, -v205
  v_fma_f32 v206, v19, v198, -v206
  v_mfma_f32_16x16x32_bf16 v[104:107], a[164:167], v[56:59], v[104:107]
  ds_read_b64_tr_b16 a[156:157], v5 offset:20480
  ds_read_b64_tr_b16 a[158:159], v5 offset:22528
  v_mfma_f32_16x16x32_bf16 v[108:111], a[164:167], v[60:63], v[108:111]
  buffer_load_dwordx4 v251, s[16:19], s66 offen offset:3072 lds
  v_fma_f32 v207, v19, v199, -v207
  s_waitcnt lgkmcnt(6)
  v_mfma_f32_16x16x32_bf16 v[112:115], a[168:171], v[56:59], v[112:115]
  ds_read_b64_tr_b16 a[160:161], v2 offset:24576
  ds_read_b64_tr_b16 a[162:163], v2 offset:26624
  v_mfma_f32_16x16x32_bf16 v[116:119], a[168:171], v[60:63], v[116:119]
  v_cvt_pk_bf16_f32 v20, v200, v201
  v_cvt_pk_bf16_f32 v21, v202, v203
  v_mfma_f32_16x16x32_bf16 v[120:123], a[172:175], v[56:59], v[120:123]
  ds_read_b64_tr_b16 a[164:165], v3 offset:24576
  ds_read_b64_tr_b16 a[166:167], v3 offset:26624
  v_mfma_f32_16x16x32_bf16 v[124:127], a[172:175], v[60:63], v[124:127]
  s_add_u32 s67, s59, 0
  s_add_u32 m0, s64, 0
  v_mfma_f32_16x16x32_bf16 v[96:99], a[144:147], v[64:67], v[96:99]
  ds_read_b64_tr_b16 a[168:169], v4 offset:24576
  ds_read_b64_tr_b16 a[170:171], v4 offset:26624
  v_mfma_f32_16x16x32_bf16 v[100:103], a[144:147], v[68:71], v[100:103]
  buffer_load_dwordx4 v248, s[16:19], s67 offen lds
  v_cvt_pk_bf16_f32 v22, v204, v205
  s_waitcnt lgkmcnt(6)
  v_mfma_f32_16x16x32_bf16 v[104:107], a[148:151], v[64:67], v[104:107]
  ds_read_b64_tr_b16 a[172:173], v5 offset:24576
  ds_read_b64_tr_b16 a[174:175], v5 offset:26624
  v_mfma_f32_16x16x32_bf16 v[108:111], a[148:151], v[68:71], v[108:111]
  s_add_u32 s87, s69, 0
  buffer_load_dwordx4 a[176:179], v1, s[24:27], s87 offen offset:0 sc1
  v_mfma_f32_16x16x32_bf16 v[112:115], a[152:155], v[64:67], v[112:115]
  ds_read_b64_tr_b16 a[144:145], v2 offset:28672
  ds_read_b64_tr_b16 a[146:147], v2 offset:30720
  v_mfma_f32_16x16x32_bf16 v[116:119], a[152:155], v[68:71], v[116:119]
  v_cvt_pk_bf16_f32 v23, v206, v207
  ds_write_b128 v17, v[20:23] offset:14336
  v_mfma_f32_16x16x32_bf16 v[120:123], a[156:159], v[64:67], v[120:123]
  ds_read_b64_tr_b16 a[148:149], v3 offset:28672
  ds_read_b64_tr_b16 a[150:151], v3 offset:30720
  v_mfma_f32_16x16x32_bf16 v[124:127], a[156:159], v[68:71], v[124:127]
  s_add_u32 s87, s69, 0
  buffer_load_dwordx4 a[180:183], v1, s[24:27], s87 offen offset:1024 sc1
  s_waitcnt lgkmcnt(7)
  v_mfma_f32_16x16x32_bf16 v[96:99], a[160:163], v[72:75], v[96:99]
  ds_read_b64_tr_b16 a[152:153], v4 offset:28672
  ds_read_b64_tr_b16 a[154:155], v4 offset:30720
  v_mfma_f32_16x16x32_bf16 v[100:103], a[160:163], v[76:79], v[100:103]
  v_fma_f32 v192, v19, v200, -v192
  v_fma_f32 v193, v19, v201, -v193
  v_mfma_f32_16x16x32_bf16 v[104:107], a[164:167], v[72:75], v[104:107]
  ds_read_b64_tr_b16 a[156:157], v5 offset:28672
  ds_read_b64_tr_b16 a[158:159], v5 offset:30720
  v_mfma_f32_16x16x32_bf16 v[108:111], a[164:167], v[76:79], v[108:111]
  s_add_u32 s87, s69, 0
  buffer_load_dwordx4 a[184:187], v1, s[24:27], s87 offen offset:2048 sc1
  v_mfma_f32_16x16x32_bf16 v[112:115], a[168:171], v[72:75], v[112:115]
  ds_read_b64_tr_b16 a[160:161], v2 offset:32768
  ds_read_b64_tr_b16 a[162:163], v2 offset:34816
  v_mfma_f32_16x16x32_bf16 v[116:119], a[168:171], v[76:79], v[116:119]
  v_fma_f32 v194, v19, v202, -v194
  v_fma_f32 v195, v19, v203, -v195
  s_waitcnt lgkmcnt(6)
  v_mfma_f32_16x16x32_bf16 v[120:123], a[172:175], v[72:75], v[120:123]
  ds_read_b64_tr_b16 a[164:165], v3 offset:32768
  ds_read_b64_tr_b16 a[166:167], v3 offset:34816
  v_mfma_f32_16x16x32_bf16 v[124:127], a[172:175], v[76:79], v[124:127]
  s_add_u32 s87, s69, 0
  buffer_load_dwordx4 a[188:191], v1, s[24:27], s87 offen offset:3072 sc1
  v_mfma_f32_16x16x32_bf16 v[96:99], a[144:147], v[80:83], v[96:99]
  ds_read_b64_tr_b16 a[168:169], v4 offset:32768
  ds_read_b64_tr_b16 a[170:171], v4 offset:34816
  v_mfma_f32_16x16x32_bf16 v[100:103], a[144:147], v[84:87], v[100:103]
  v_fma_f32 v196, v19, v204, -v196
  v_fma_f32 v197, v19, v205, -v197
  v_mfma_f32_16x16x32_bf16 v[104:107], a[148:151], v[80:83], v[104:107]
  ds_read_b64_tr_b16 a[172:173], v5 offset:32768
  ds_read_b64_tr_b16 a[174:175], v5 offset:34816
  v_mfma_f32_16x16x32_bf16 v[108:111], a[148:151], v[84:87], v[108:111]
  s_add_u32 s87, s69, 4096
  buffer_load_dwordx4 a[192:195], v1, s[24:27], s87 offen offset:0 sc1
  s_waitcnt lgkmcnt(6)
  v_mfma_f32_16x16x32_bf16 v[112:115], a[152:155], v[80:83], v[112:115]
  v_fma_f32 v198, v19, v206, -v198
  v_mfma_f32_16x16x32_bf16 v[116:119], a[152:155], v[84:87], v[116:119]
  v_fma_f32 v199, v19, v207, -v199
  v_cvt_pk_bf16_f32 v20, v192, v193
  v_mfma_f32_16x16x32_bf16 v[120:123], a[156:159], v[80:83], v[120:123]
  s_add_u32 s87, s69, 4096
  buffer_load_dwordx4 a[196:199], v1, s[24:27], s87 offen offset:1024 sc1
  v_mfma_f32_16x16x32_bf16 v[124:127], a[156:159], v[84:87], v[124:127]
  v_cvt_pk_bf16_f32 v21, v194, v195
  v_cvt_pk_bf16_f32 v22, v196, v197
  v_mfma_f32_16x16x32_bf16 v[96:99], a[160:163], v[88:91], v[96:99]
  v_mfma_f32_16x16x32_bf16 v[100:103], a[160:163], v[92:95], v[100:103]
  v_cvt_pk_bf16_f32 v23, v198, v199
  ds_write_b128 v17, v[20:23] offset:16384
  s_waitcnt vmcnt(63) lgkmcnt(0)
  s_barrier
  v_mfma_f32_16x16x32_bf16 v[104:107], a[164:167], v[88:91], v[104:107]
  ds_read_b128 a[144:147], v18 offset:0
  ds_read_b128 a[148:151], v18 offset:1024
  v_mfma_f32_16x16x32_bf16 v[108:111], a[164:167], v[92:95], v[108:111]
  s_add_u32 s87, s69, 4096
  buffer_load_dwordx4 a[200:203], v1, s[24:27], s87 offen offset:2048 sc1
  v_mfma_f32_16x16x32_bf16 v[112:115], a[168:171], v[88:91], v[112:115]
  ds_read_b128 a[152:155], v18 offset:2048
  ds_read_b128 a[156:159], v18 offset:3072
  v_mfma_f32_16x16x32_bf16 v[116:119], a[168:171], v[92:95], v[116:119]
  v_mfma_f32_16x16x32_bf16 v[120:123], a[172:175], v[88:91], v[120:123]
  ds_read_b128 a[160:163], v18 offset:4096
  ds_read_b128 a[164:167], v18 offset:5120
  v_mfma_f32_16x16x32_bf16 v[124:127], a[172:175], v[92:95], v[124:127]
  s_add_u32 s87, s69, 4096
  buffer_load_dwordx4 a[204:207], v1, s[24:27], s87 offen offset:3072 sc1
  s_waitcnt lgkmcnt(3)
  v_mfma_f32_16x16x32_bf16 v[192:195], a[0:3], a[144:147], 0
  ds_read_b128 a[168:171], v18 offset:6144
  buffer_load_dword v10, off, s[24:27], s74 sc1
  v_mfma_f32_16x16x32_bf16 v[196:199], a[4:7], a[144:147], 0
  v_mfma_f32_16x16x32_bf16 v[200:203], a[0:3], a[148:151], 0
  ds_read_b128 a[172:175], v18 offset:7168
  s_add_u32 s65, s58, 128
  v_mfma_f32_16x16x32_bf16 v[204:207], a[4:7], a[148:151], 0
  s_add_u32 m0, s63, 36864
  v_mfma_f32_16x16x32_bf16 v[192:195], a[8:11], a[152:155], v[192:195]
  ds_read_b128 a[144:147], v18 offset:8192
  buffer_load_dwordx4 v248, s[16:19], s65 offen lds
  v_mfma_f32_16x16x32_bf16 v[196:199], a[12:15], a[152:155], v[196:199]
  s_waitcnt lgkmcnt(3)
  v_mfma_f32_16x16x32_bf16 v[200:203], a[8:11], a[156:159], v[200:203]
  ds_read_b128 a[148:151], v18 offset:9216
  v_mfma_f32_16x16x32_bf16 v[204:207], a[12:15], a[156:159], v[204:207]
  v_mfma_f32_16x16x32_bf16 v[192:195], a[16:19], a[160:163], v[192:195]
  ds_read_b128 a[152:155], v18 offset:10240
  buffer_load_dwordx4 v249, s[16:19], s65 offen offset:1024 lds
  v_mfma_f32_16x16x32_bf16 v[196:199], a[20:23], a[160:163], v[196:199]
  v_mfma_f32_16x16x32_bf16 v[200:203], a[16:19], a[164:167], v[200:203]
  ds_read_b128 a[156:159], v18 offset:11264
  v_mfma_f32_16x16x32_bf16 v[204:207], a[20:23], a[164:167], v[204:207]
  s_waitcnt lgkmcnt(3)
  v_mfma_f32_16x16x32_bf16 v[192:195], a[24:27], a[168:171], v[192:195]
  ds_read_b128 a[160:163], v18 offset:12288
  buffer_load_dwordx4 v250, s[16:19], s65 offen offset:2048 lds
  v_mfma_f32_16x16x32_bf16 v[196:199], a[28:31], a[168:171], v[196:199]
  v_mfma_f32_16x16x32_bf16 v[200:203], a[24:27], a[172:175], v[200:203]
  ds_read_b128 a[164:167], v18 offset:13312
  v_mfma_f32_16x16x32_bf16 v[204:207], a[28:31], a[172:175], v[204:207]
  v_mfma_f32_16x16x32_bf16 v[192:195], a[32:35], a[144:147], v[192:195]
  ds_read_b128 a[168:171], v18 offset:14336
  buffer_load_dwordx4 v251, s[16:19], s65 offen offset:3072 lds
  v_mfma_f32_16x16x32_bf16 v[196:199], a[36:39], a[144:147], v[196:199]
  v_bfe_u32 v20, v1, 4, 1
  s_waitcnt lgkmcnt(3)
  v_mfma_f32_16x16x32_bf16 v[200:203], a[32:35], a[148:151], v[200:203]
  ds_read_b128 a[172:175], v18 offset:15360
  v_mul_u32_u24 v20, 294912, v20
  v_mfma_f32_16x16x32_bf16 v[204:207], a[36:39], a[148:151], v[204:207]
  v_mfma_f32_16x16x32_bf16 v[192:195], a[40:43], a[152:155], v[192:195]
  ds_read_b128 a[144:147], v18 offset:16384
  s_add_u32 s66, s58, 147584
  v_mfma_f32_16x16x32_bf16 v[196:199], a[44:47], a[152:155], v[196:199]
  s_add_u32 m0, s63, 53248
  v_bfe_u32 v21, v1, 5, 3
  v_mfma_f32_16x16x32_bf16 v[200:203], a[40:43], a[156:159], v[200:203]
  ds_read_b128 a[148:151], v18 offset:17408
  buffer_load_dwordx4 v248, s[16:19], s66 offen lds
  v_mfma_f32_16x16x32_bf16 v[204:207], a[44:47], a[156:159], v[204:207]
  v_bfe_u32 v22, v1, 9, 1
  s_waitcnt lgkmcnt(3)
  v_mfma_f32_16x16x32_bf16 v[192:195], a[48:51], a[160:163], v[192:195]
  ds_read_b128 a[152:155], v18 offset:18432
  v_lshl_add_u32 v21, v22, 3, v21
  v_mfma_f32_16x16x32_bf16 v[196:199], a[52:55], a[160:163], v[196:199]
  v_mfma_f32_16x16x32_bf16 v[200:203], a[48:51], a[164:167], v[200:203]
  ds_read_b128 a[156:159], v18 offset:19456
  buffer_load_dwordx4 v249, s[16:19], s66 offen offset:1024 lds
  v_mfma_f32_16x16x32_bf16 v[204:207], a[52:55], a[164:167], v[204:207]
  s_and_b32 s88, s49, 1
  s_lshl_b32 s88, s88, 4
  v_mfma_f32_16x16x32_bf16 v[192:195], a[56:59], a[168:171], v[192:195]
  ds_read_b128 a[160:163], v18 offset:20480
  v_add_u32 v21, s88, v21
  v_mfma_f32_16x16x32_bf16 v[196:199], a[60:63], a[168:171], v[196:199]
  s_waitcnt lgkmcnt(3)
  v_mfma_f32_16x16x32_bf16 v[200:203], a[56:59], a[172:175], v[200:203]
  ds_read_b128 a[164:167], v18 offset:21504
  buffer_load_dwordx4 v250, s[16:19], s66 offen offset:2048 lds
  v_mfma_f32_16x16x32_bf16 v[204:207], a[60:63], a[172:175], v[204:207]
  v_lshlrev_b32 v21, 4, v21
  v_mfma_f32_16x16x32_bf16 v[192:195], a[64:67], a[144:147], v[192:195]
  ds_read_b128 a[168:171], v18 offset:22528
  v_bfe_u32 v22, v1, 8, 1
  v_mfma_f32_16x16x32_bf16 v[196:199], a[68:71], a[144:147], v[196:199]
  v_mfma_f32_16x16x32_bf16 v[200:203], a[64:67], a[148:151], v[200:203]
  ds_read_b128 a[172:175], v18 offset:23552
  buffer_load_dwordx4 v251, s[16:19], s66 offen offset:3072 lds
  v_mfma_f32_16x16x32_bf16 v[204:207], a[68:71], a[148:151], v[204:207]
  v_lshl_add_u32 v21, v22, 9, v21
  s_waitcnt lgkmcnt(3)
  v_mfma_f32_16x16x32_bf16 v[192:195], a[72:75], a[152:155], v[192:195]
  ds_read_b128 a[144:147], v18 offset:24576
  v_add_u32 v13, v20, v21
  v_mfma_f32_16x16x32_bf16 v[196:199], a[76:79], a[152:155], v[196:199]
  v_mfma_f32_16x16x32_bf16 v[200:203], a[72:75], a[156:159], v[200:203]
  ds_read_b128 a[148:151], v18 offset:25600
  s_add_u32 s67, s59, 128
  v_mfma_f32_16x16x32_bf16 v[204:207], a[76:79], a[156:159], v[204:207]
  s_add_u32 m0, s64, 36864
  v_mfma_f32_16x16x32_bf16 v[192:195], a[80:83], a[160:163], v[192:195]
  ds_read_b128 a[152:155], v18 offset:26624
  buffer_load_dwordx4 v248, s[16:19], s67 offen lds
  v_mfma_f32_16x16x32_bf16 v[196:199], a[84:87], a[160:163], v[196:199]
  s_waitcnt lgkmcnt(3)
  v_mfma_f32_16x16x32_bf16 v[200:203], a[80:83], a[164:167], v[200:203]
  ds_read_b128 a[156:159], v18 offset:27648
  s_add_u32 s87, s69, 8192
  v_mfma_f32_16x16x32_bf16 v[204:207], a[84:87], a[164:167], v[204:207]
  buffer_load_dwordx4 a[208:211], v1, s[24:27], s87 offen offset:0 sc1
  v_mfma_f32_16x16x32_bf16 v[192:195], a[88:91], a[168:171], v[192:195]
  ds_read_b128 a[160:163], v18 offset:28672
  v_mfma_f32_16x16x32_bf16 v[196:199], a[92:95], a[168:171], v[196:199]
  v_mfma_f32_16x16x32_bf16 v[200:203], a[88:91], a[172:175], v[200:203]
  ds_read_b128 a[164:167], v18 offset:29696
  s_add_u32 s87, s69, 8192
  v_mfma_f32_16x16x32_bf16 v[204:207], a[92:95], a[172:175], v[204:207]
  buffer_load_dwordx4 a[212:215], v1, s[24:27], s87 offen offset:1024 sc1
  s_waitcnt lgkmcnt(3)
  v_mfma_f32_16x16x32_bf16 v[192:195], a[96:99], a[144:147], v[192:195]
  ds_read_b128 a[168:171], v18 offset:30720
  v_mfma_f32_16x16x32_bf16 v[196:199], a[100:103], a[144:147], v[196:199]
  v_mfma_f32_16x16x32_bf16 v[200:203], a[96:99], a[148:151], v[200:203]
  ds_read_b128 a[172:175], v18 offset:31744
  s_add_u32 s87, s69, 8192
  v_mfma_f32_16x16x32_bf16 v[204:207], a[100:103], a[148:151], v[204:207]
  buffer_load_dwordx4 a[216:219], v1, s[24:27], s87 offen offset:2048 sc1
  v_mfma_f32_16x16x32_bf16 v[192:195], a[104:107], a[152:155], v[192:195]
  ds_read_b128 a[144:147], v18 offset:32768
  v_mfma_f32_16x16x32_bf16 v[196:199], a[108:111], a[152:155], v[196:199]
  s_waitcnt lgkmcnt(3)
  v_mfma_f32_16x16x32_bf16 v[200:203], a[104:107], a[156:159], v[200:203]
  ds_read_b128 a[148:151], v18 offset:33792
  s_add_u32 s87, s69, 8192
  v_mfma_f32_16x16x32_bf16 v[204:207], a[108:111], a[156:159], v[204:207]
  buffer_load_dwordx4 a[220:223], v1, s[24:27], s87 offen offset:3072 sc1
  v_mfma_f32_16x16x32_bf16 v[192:195], a[112:115], a[160:163], v[192:195]
  ds_read_b128 a[152:155], v18 offset:34816
  v_mfma_f32_16x16x32_bf16 v[196:199], a[116:119], a[160:163], v[196:199]
  v_mfma_f32_16x16x32_bf16 v[200:203], a[112:115], a[164:167], v[200:203]
  ds_read_b128 a[156:159], v18 offset:35840
  s_add_u32 s87, s69, 12288
  v_mfma_f32_16x16x32_bf16 v[204:207], a[116:119], a[164:167], v[204:207]
  buffer_load_dwordx4 a[224:227], v1, s[24:27], s87 offen offset:0 sc1
  s_waitcnt lgkmcnt(3)
  v_mfma_f32_16x16x32_bf16 v[192:195], a[120:123], a[168:171], v[192:195]
  v_mfma_f32_16x16x32_bf16 v[196:199], a[124:127], a[168:171], v[196:199]
  v_mfma_f32_16x16x32_bf16 v[200:203], a[120:123], a[172:175], v[200:203]
  s_add_u32 s87, s69, 12288
  buffer_load_dwordx4 a[228:231], v1, s[24:27], s87 offen offset:1024 sc1
  v_mfma_f32_16x16x32_bf16 v[204:207], a[124:127], a[172:175], v[204:207]
  v_mfma_f32_16x16x32_bf16 v[192:195], a[128:131], a[144:147], v[192:195]
  v_mfma_f32_16x16x32_bf16 v[196:199], a[132:135], a[144:147], v[196:199]
  s_waitcnt vmcnt(15)
  v_readfirstlane_b32 s88, v10
  s_nop 3
  s_cmp_ge_u32 s88, 2
  s_cbranch_scc0 K1_spin2
K1_spin2_done:
  s_waitcnt vmcnt(34) lgkmcnt(0)
  s_barrier
  v_add_u32 v2, 110592, v9
  v_xor_b32 v3, 32, v2
  v_mfma_f32_16x16x32_bf16 v[200:203], a[128:131], a[148:151], v[200:203]
  ds_read_b64_tr_b16 a[160:161], v2 offset:0
  ds_read_b64_tr_b16 a[162:163], v2 offset:1024
  ds_read_b64_tr_b16 a[164:165], v3 offset:0
  v_mfma_f32_16x16x32_bf16 v[204:207], a[132:135], a[148:151], v[204:207]
  ds_read_b64_tr_b16 a[166:167], v3 offset:1024
  s_add_u32 s87, s69, 12288
  buffer_load_dwordx4 a[232:235], v1, s[24:27], s87 offen offset:2048 sc1
  v_mfma_f32_16x16x32_bf16 v[192:195], a[136:139], a[152:155], v[192:195]
  ds_read_b64_tr_b16 a[168:169], v2 offset:2048
  ds_read_b64_tr_b16 a[170:171], v2 offset:3072
  v_mfma_f32_16x16x32_bf16 v[196:199], a[140:143], a[152:155], v[196:199]
  ds_read_b64_tr_b16 a[172:173], v3 offset:2048
  ds_read_b64_tr_b16 a[174:175], v3 offset:3072
  v_mfma_f32_16x16x32_bf16 v[200:203], a[136:139], a[156:159], v[200:203]
  ds_read_b64_tr_b16 a[144:145], v2 offset:4096
  ds_read_b64_tr_b16 a[146:147], v2 offset:5120
  ds_read_b64_tr_b16 a[148:149], v3 offset:4096
  v_mfma_f32_16x16x32_bf16 v[204:207], a[140:143], a[156:159], v[204:207]
  ds_read_b64_tr_b16 a[150:151], v3 offset:5120
  s_add_u32 s87, s69, 12288
  buffer_load_dwordx4 a[236:239], v1, s[24:27], s87 offen offset:3072 sc1
  s_lshl_b32 s88, s48, 12
  s_add_u32 s88, s88, 147456
  v_add_u32 v21, s88, v1
  s_nop 7
  ds_write_b128 v21, v[192:195] offset:0
  ds_write_b128 v21, v[196:199] offset:1024
  ds_write_b128 v21, v[200:203] offset:2048
  ds_write_b128 v21, v[204:207] offset:3072
  s_waitcnt lgkmcnt(10)
  v_mfma_f32_16x16x32_bf16 v[192:195], a[160:163], v[24:27], 0
  ds_read_b64_tr_b16 a[152:153], v2 offset:6144
  ds_read_b64_tr_b16 a[154:155], v2 offset:7168
  v_mfma_f32_16x16x32_bf16 v[196:199], a[160:163], v[28:31], 0
  v_mfma_f32_16x16x32_bf16 v[200:203], a[164:167], v[24:27], 0
  ds_read_b64_tr_b16 a[156:157], v3 offset:6144
  ds_read_b64_tr_b16 a[158:159], v3 offset:7168
  s_add_u32 s65, s58, 256
  v_mfma_f32_16x16x32_bf16 v[204:207], a[164:167], v[28:31], 0
  s_add_u32 m0, s63, 73728
  s_add_u32 s87, s69, 16384
  buffer_load_dwordx4 a[240:243], v1, s[24:27], s87 offen offset:0 sc1
  v_mfma_f32_16x16x32_bf16 v[192:195], a[168:171], v[32:35], v[192:195]
  ds_read_b64_tr_b16 a[160:161], v2 offset:8192
  ds_read_b64_tr_b16 a[162:163], v2 offset:9216
  v_mfma_f32_16x16x32_bf16 v[196:199], a[168:171], v[36:39], v[196:199]
  buffer_load_dwordx4 v248, s[16:19], s65 offen lds
  s_waitcnt lgkmcnt(10)
  v_mfma_f32_16x16x32_bf16 v[200:203], a[172:175], v[32:35], v[200:203]
  ds_read_b64_tr_b16 a[164:165], v3 offset:8192
  ds_read_b64_tr_b16 a[166:167], v3 offset:9216
  v_mfma_f32_16x16x32_bf16 v[204:207], a[172:175], v[36:39], v[204:207]
  s_add_u32 s87, s69, 16384
  buffer_load_dwordx4 a[244:247], v1, s[24:27], s87 offen offset:1024 sc1
  v_mfma_f32_16x16x32_bf16 v[192:195], a[144:147], v[40:43], v[192:195]
  ds_read_b64_tr_b16 a[168:169], v2 offset:10240
  ds_read_b64_tr_b16 a[170:171], v2 offset:11264
  v_mfma_f32_16x16x32_bf16 v[196:199], a[144:147], v[44:47], v[196:199]
  buffer_load_dwordx4 v249, s[16:19], s65 offen offset:1024 lds
  s_getpc_b64 s[32:33]
K1_pc2:
  s_add_u32 s32, s32, k2_kernel-K1_pc2
  s_addc_u32 s33, s33, 0
  s_and_b32 s33, s33, 0xffff
  s_mov_b32 s34, K2_codeend-k2_kernel
  s_mov_b32 s35, 0x20000
  v_mfma_f32_16x16x32_bf16 v[200:203], a[148:151], v[40:43], v[200:203]
  ds_read_b64_tr_b16 a[172:173], v3 offset:10240
  ds_read_b64_tr_b16 a[174:175], v3 offset:11264
  v_mfma_f32_16x16x32_bf16 v[204:207], a[148:151], v[44:47], v[204:207]
  s_lshr_b32 s88, s2, 3
  s_waitcnt lgkmcnt(6)
  v_mfma_f32_16x16x32_bf16 v[192:195], a[152:155], v[48:51], v[192:195]
  ds_read_b64_tr_b16 a[144:145], v2 offset:12288
  ds_read_b64_tr_b16 a[146:147], v2 offset:13312
  v_mfma_f32_16x16x32_bf16 v[196:199], a[152:155], v[52:55], v[196:199]
  buffer_load_dwordx4 v250, s[16:19], s65 offen offset:2048 lds
  s_lshl_b32 s88, s88, 9
  v_mfma_f32_16x16x32_bf16 v[200:203], a[156:159], v[48:51], v[200:203]
  ds_read_b64_tr_b16 a[148:149], v3 offset:12288
  ds_read_b64_tr_b16 a[150:151], v3 offset:13312
  v_mfma_f32_16x16x32_bf16 v[204:207], a[156:159], v[52:55], v[204:207]
  v_lshlrev_b32 v20, 3, v1
  v_mfma_f32_16x16x32_bf16 v[192:195], a[160:163], v[56:59], v[192:195]
  ds_read_b64_tr_b16 a[152:153], v2 offset:14336
  ds_read_b64_tr_b16 a[154:155], v2 offset:15360
  v_mfma_f32_16x16x32_bf16 v[196:199], a[160:163], v[60:63], v[196:199]
  buffer_load_dwordx4 v251, s[16:19], s65 offen offset:3072 lds
  v_add_u32 v20, s88, v20
  s_waitcnt lgkmcnt(6)
  v_mfma_f32_16x16x32_bf16 v[200:203], a[164:167], v[56:59], v[200:203]
  ds_read_b64_tr_b16 a[156:157], v3 offset:14336
  ds_read_b64_tr_b16 a[158:159], v3 offset:15360
  v_mfma_f32_16x16x32_bf16 v[204:207], a[164:167], v[60:63], v[204:207]
  v_mov_b32 v21, 0x7ff00000
  v_mfma_f32_16x16x32_bf16 v[192:195], a[168:171], v[64:67], v[192:195]
  ds_read_b64_tr_b16 a[160:161], v2 offset:32768
  ds_read_b64_tr_b16 a[162:163], v2 offset:33792
  s_add_u32 s66, s58, 147712
  v_mfma_f32_16x16x32_bf16 v[196:199], a[168:171], v[68:71], v[196:199]
  s_add_u32 m0, s63, 90112
  v_cmp_gt_u32 vcc, 64, v1
  v_mfma_f32_16x16x32_bf16 v[200:203], a[172:175], v[64:67], v[200:203]
  ds_read_b64_tr_b16 a[164:165], v3 offset:32768
  ds_read_b64_tr_b16 a[166:167], v3 offset:33792
  v_mfma_f32_16x16x32_bf16 v[204:207], a[172:175], v[68:71], v[204:207]
  buffer_load_dwordx4 v248, s[16:19], s66 offen lds
  s_nop 1
  s_waitcnt lgkmcnt(6)
  v_mfma_f32_16x16x32_bf16 v[192:195], a[144:147], v[72:75], v[192:195]
  ds_read_b64_tr_b16 a[168:169], v2 offset:16384
  ds_read_b64_tr_b16 a[170:171], v2 offset:17408
  v_mfma_f32_16x16x32_bf16 v[196:199], a[144:147], v[76:79], v[196:199]
  v_cndmask_b32 v20, v21, v20, vcc
  v_mfma_f32_16x16x32_bf16 v[200:203], a[148:151], v[72:75], v[200:203]
  ds_read_b64_tr_b16 a[172:173], v3 offset:16384
  ds_read_b64_tr_b16 a[174:175], v3 offset:17408
  v_mfma_f32_16x16x32_bf16 v[204:207], a[148:151], v[76:79], v[204:207]
  buffer_load_dwordx4 v249, s[16:19], s66 offen offset:1024 lds
  v_mfma_f32_16x16x32_bf16 v[192:195], a[152:155], v[80:83], v[192:195]
  ds_read_b64_tr_b16 a[144:145], v2 offset:18432
  ds_read_b64_tr_b16 a[146:147], v2 offset:19456
  v_mfma_f32_16x16x32_bf16 v[196:199], a[152:155], v[84:87], v[196:199]
  s_waitcnt lgkmcnt(6)
  v_mfma_f32_16x16x32_bf16 v[200:203], a[156:159], v[80:83], v[200:203]
  ds_read_b64_tr_b16 a[148:149], v3 offset:18432
  ds_read_b64_tr_b16 a[150:151], v3 offset:19456
  v_mfma_f32_16x16x32_bf16 v[204:207], a[156:159], v[84:87], v[204:207]
  buffer_load_dwordx4 v250, s[16:19], s66 offen offset:2048 lds
  v_mfma_f32_16x16x32_bf16 v[192:195], a[160:163], v[88:91], v[192:195]
  ds_read_b64_tr_b16 a[152:153], v2 offset:20480
  ds_read_b64_tr_b16 a[154:155], v2 offset:21504
  v_mfma_f32_16x16x32_bf16 v[196:199], a[160:163], v[92:95], v[196:199]
  s_waitcnt vmcnt(27)
  v_mfma_f32_16x16x32_bf16 v[200:203], a[164:167], v[88:91], v[200:203]
  ds_read_b64_tr_b16 a[156:157], v3 offset:20480
  ds_read_b64_tr_b16 a[158:159], v3 offset:21504
  v_mfma_f32_16x16x32_bf16 v[204:207], a[164:167], v[92:95], v[204:207]
  buffer_load_dwordx4 v251, s[16:19], s66 offen offset:3072 lds
  s_waitcnt lgkmcnt(6)
  v_mfma_f32_16x16x32_bf16 v[192:195], a[168:171], a[176:179], v[192:195]
  ds_read_b64_tr_b16 a[160:161], v2 offset:22528
  ds_read_b64_tr_b16 a[162:163], v2 offset:23552
  v_mfma_f32_16x16x32_bf16 v[196:199], a[168:171], a[180:183], v[196:199]
  v_mfma_f32_16x16x32_bf16 v[200:203], a[172:175], a[176:179], v[200:203]
  ds_read_b64_tr_b16 a[164:165], v3 offset:22528
  ds_read_b64_tr_b16 a[166:167], v3 offset:23552
  v_mfma_f32_16x16x32_bf16 v[204:207], a[172:175], a[180:183], v[204:207]
  s_add_u32 s67, s59, 256
  s_add_u32 m0, s64, 73728
  v_mfma_f32_16x16x32_bf16 v[192:195], a[144:147], a[184:187], v[192:195]
  ds_read_b64_tr_b16 a[168:169], v2 offset:24576
  ds_read_b64_tr_b16 a[170:171], v2 offset:25600
  v_mfma_f32_16x16x32_bf16 v[196:199], a[144:147], a[188:191], v[196:199]
  buffer_load_dwordx4 v248, s[16:19], s67 offen lds
  s_waitcnt lgkmcnt(6)
  v_mfma_f32_16x16x32_bf16 v[200:203], a[148:151], a[184:187], v[200:203]
  ds_read_b64_tr_b16 a[172:173], v3 offset:24576
  ds_read_b64_tr_b16 a[174:175], v3 offset:25600
  v_mfma_f32_16x16x32_bf16 v[204:207], a[148:151], a[188:191], v[204:207]
  v_mfma_f32_16x16x32_bf16 v[192:195], a[152:155], a[192:195], v[192:195]
  ds_read_b64_tr_b16 a[144:145], v2 offset:26624
  ds_read_b64_tr_b16 a[146:147], v2 offset:27648
  v_mfma_f32_16x16x32_bf16 v[196:199], a[152:155], a[196:199], v[196:199]
  v_mfma_f32_16x16x32_bf16 v[200:203], a[156:159], a[192:195], v[200:203]
  ds_read_b64_tr_b16 a[148:149], v3 offset:26624
  ds_read_b64_tr_b16 a[150:151], v3 offset:27648
  v_mfma_f32_16x16x32_bf16 v[204:207], a[156:159], a[196:199], v[204:207]
  s_waitcnt lgkmcnt(6)
  v_mfma_f32_16x16x32_bf16 v[192:195], a[160:163], a[200:203], v[192:195]
  ds_read_b64_tr_b16 a[152:153], v2 offset:28672
  ds_read_b64_tr_b16 a[154:155], v2 offset:29696
  v_mfma_f32_16x16x32_bf16 v[196:199], a[160:163], a[204:207], v[196:199]
  buffer_load_dword a248, v20, s[32:35], 0 offen
  s_waitcnt vmcnt(12)
  v_mfma_f32_16x16x32_bf16 v[200:203], a[164:167], a[200:203], v[200:203]
  ds_read_b64_tr_b16 a[156:157], v3 offset:28672
  ds_read_b64_tr_b16 a[158:159], v3 offset:29696
  v_mfma_f32_16x16x32_bf16 v[204:207], a[164:167], a[204:207], v[204:207]
  v_mfma_f32_16x16x32_bf16 v[192:195], a[168:171], a[208:211], v[192:195]
  ds_read_b64_tr_b16 a[160:161], v2 offset:30720
  ds_read_b64_tr_b16 a[162:163], v2 offset:31744
  v_mfma_f32_16x16x32_bf16 v[196:199], a[168:171], a[212:215], v[196:199]
  s_waitcnt lgkmcnt(6)
  v_mfma_f32_16x16x32_bf16 v[200:203], a[172:175], a[208:211], v[200:203]
  ds_read_b64_tr_b16 a[164:165], v3 offset:30720
  ds_read_b64_tr_b16 a[166:167], v3 offset:31744
  v_mfma_f32_16x16x32_bf16 v[204:207], a[172:175], a[212:215], v[204:207]
  v_mfma_f32_16x16x32_bf16 v[192:195], a[144:147], a[216:219], v[192:195]
  ds_read_b64_tr_b16 a[168:169], v2 offset:34816
  ds_read_b64_tr_b16 a[170:171], v2 offset:35840
  v_mfma_f32_16x16x32_bf16 v[196:199], a[144:147], a[220:223], v[196:199]
  v_mfma_f32_16x16x32_bf16 v[200:203], a[148:151], a[216:219], v[200:203]
  ds_read_b64_tr_b16 a[172:173], v3 offset:34816
  ds_read_b64_tr_b16 a[174:175], v3 offset:35840
  v_mfma_f32_16x16x32_bf16 v[204:207], a[148:151], a[220:223], v[204:207]
  s_waitcnt lgkmcnt(6)
  v_mfma_f32_16x16x32_bf16 v[192:195], a[152:155], a[224:227], v[192:195]
  v_mfma_f32_16x16x32_bf16 v[196:199], a[152:155], a[228:231], v[196:199]
  v_mfma_f32_16x16x32_bf16 v[200:203], a[156:159], a[224:227], v[200:203]
  v_mfma_f32_16x16x32_bf16 v[204:207], a[156:159], a[228:231], v[204:207]
  v_mfma_f32_16x16x32_bf16 v[192:195], a[160:163], a[232:235], v[192:195]
  v_mfma_f32_16x16x32_bf16 v[196:199], a[160:163], a[236:239], v[196:199]
  s_waitcnt vmcnt(9)
  s_waitcnt vmcnt(38) lgkmcnt(0)
  s_barrier
  v_mov_b32 v2, v8
  v_xor_b32 v3, 32, v2
  v_xor_b32 v4, 64, v2
  v_xor_b32 v5, 0x60, v2
  v_mfma_f32_16x16x32_bf16 v[200:203], a[164:167], a[232:235], v[200:203]
  ds_read_b64_tr_b16 a[144:145], v2 offset:0
  ds_read_b64_tr_b16 a[146:147], v2 offset:2048
  v_mfma_f32_16x16x32_bf16 v[204:207], a[164:167], a[236:239], v[204:207]
  ds_read_b64_tr_b16 a[148:149], v3 offset:0
  ds_read_b64_tr_b16 a[150:151], v3 offset:2048
  v_mfma_f32_16x16x32_bf16 v[192:195], a[168:171], a[240:243], v[192:195]
  ds_read_b64_tr_b16 a[152:153], v4 offset:0
  ds_read_b64_tr_b16 a[154:155], v4 offset:2048
  v_mfma_f32_16x16x32_bf16 v[196:199], a[168:171], a[244:247], v[196:199]
  ds_read_b64_tr_b16 a[156:157], v5 offset:0
  ds_read_b64_tr_b16 a[158:159], v5 offset:2048
  v_mfma_f32_16x16x32_bf16 v[200:203], a[172:175], a[240:243], v[200:203]
  ds_read_b64_tr_b16 a[160:161], v2 offset:4096
  ds_read_b64_tr_b16 a[162:163], v2 offset:6144
  v_mfma_f32_16x16x32_bf16 v[204:207], a[172:175], a[244:247], v[204:207]
  ds_read_b64_tr_b16 a[164:165], v3 offset:4096
  ds_read_b64_tr_b16 a[166:167], v3 offset:6144
  s_waitcnt lgkmcnt(6)
  v_mfma_f32_16x16x32_bf16 v[128:131], a[144:147], a[176:179], v[128:131]
  ds_read_b64_tr_b16 a[168:169], v4 offset:4096
  ds_read_b64_tr_b16 a[170:171], v4 offset:6144
  v_mfma_f32_16x16x32_bf16 v[132:135], a[144:147], a[180:183], v[132:135]
  s_lshr_b32 s88, s48, 1
  s_lshl_b32 s88, s88, 11
  v_mfma_f32_16x16x32_bf16 v[136:139], a[148:151], a[176:179], v[136:139]
  ds_read_b64_tr_b16 a[172:173], v5 offset:4096
  ds_read_b64_tr_b16 a[174:175], v5 offset:6144
  v_mfma_f32_16x16x32_bf16 v[140:143], a[148:151], a[180:183], v[140:143]
  s_add_u32 s65, s58, 384
  s_add_u32 m0, s63, 110592
  v_mfma_f32_16x16x32_bf16 v[144:147], a[152:155], a[176:179], v[144:147]
  ds_read_b64_tr_b16 a[144:145], v2 offset:8192
  ds_read_b64_tr_b16 a[146:147], v2 offset:10240
  v_mfma_f32_16x16x32_bf16 v[148:151], a[152:155], a[180:183], v[148:151]
  buffer_load_dwordx4 v248, s[16:19], s65 offen lds
  s_add_u32 s88, s88, 147456
  s_waitcnt lgkmcnt(6)
  v_mfma_f32_16x16x32_bf16 v[152:155], a[156:159], a[176:179], v[152:155]
  ds_read_b64_tr_b16 a[148:149], v3 offset:8192
  ds_read_b64_tr_b16 a[150:151], v3 offset:10240
  v_mfma_f32_16x16x32_bf16 v[156:159], a[156:159], a[180:183], v[156:159]
  v_add_u32 v73, s88, v1
  s_and_b32 s88, s48, 1
  v_mfma_f32_16x16x32_bf16 v[128:131], a[160:163], a[184:187], v[128:131]
  ds_read_b64_tr_b16 a[152:153], v4 offset:8192
  ds_read_b64_tr_b16 a[154:155], v4 offset:10240
  v_mfma_f32_16x16x32_bf16 v[132:135], a[160:163], a[188:191], v[132:135]
  buffer_load_dwordx4 v249, s[16:19], s65 offen offset:1024 lds
  s_lshl_b32 s89, s81, 1
  v_mfma_f32_16x16x32_bf16 v[136:139], a[164:167], a[184:187], v[136:139]
  ds_read_b64_tr_b16 a[156:157], v5 offset:8192
  ds_read_b64_tr_b16 a[158:159], v5 offset:10240
  v_mfma_f32_16x16x32_bf16 v[140:143], a[164:167], a[188:191], v[140:143]
  s_or_b32 s88, s88, s89
  s_lshr_b32 s89, 12, s88
  s_waitcnt lgkmcnt(6)
  v_mfma_f32_16x16x32_bf16 v[144:147], a[168:171], a[184:187], v[144:147]
  ds_read_b64_tr_b16 a[160:161], v2 offset:12288
  ds_read_b64_tr_b16 a[162:163], v2 offset:14336
  v_mfma_f32_16x16x32_bf16 v[148:151], a[168:171], a[188:191], v[148:151]
  buffer_load_dwordx4 v250, s[16:19], s65 offen offset:2048 lds
  v_mfma_f32_16x16x32_bf16 v[152:155], a[172:175], a[184:187], v[152:155]
  ds_read_b64_tr_b16 a[164:165], v3 offset:12288
  ds_read_b64_tr_b16 a[166:167], v3 offset:14336
  v_mfma_f32_16x16x32_bf16 v[156:159], a[172:175], a[188:191], v[156:159]
  s_bitcmp1_b32 s89, 0
  s_cselect_b32 s90, 0xbf800000, 1.0
  v_mfma_f32_16x16x32_bf16 v[128:131], a[144:147], a[192:195], v[128:131]
  ds_read_b64_tr_b16 a[168:169], v4 offset:12288
  ds_read_b64_tr_b16 a[170:171], v4 offset:14336
  v_mfma_f32_16x16x32_bf16 v[132:135], a[144:147], a[196:199], v[132:135]
  buffer_load_dwordx4 v251, s[16:19], s65 offen offset:3072 lds
  s_lshr_b32 s89, 10, s88
  s_bitcmp1_b32 s89, 0
  s_cselect_b32 s91, 0xbf800000, 1.0
  s_lshr_b32 s89, 6, s88
  s_bitcmp1_b32 s89, 0
  s_cselect_b32 s92, 0xbf800000, 1.0
  s_lshr_b32 s89, 0, s88
  s_bitcmp1_b32 s89, 0
  s_cselect_b32 s93, 0xbf800000, 1.0
  s_cmp_eq_u32 s88, 0
  s_cselect_b32 s94, 1.0, 0
  s_cselect_b32 s95, 1.0, 0
  s_cmp_eq_u32 s88, 3
  s_cselect_b32 s94, 0xbf800000, s94
  s_cselect_b32 s95, 1.0, s95
  s_cmp_eq_u32 s49, 0
  s_cselect_b32 s88, 256, 0
  v_cmp_gt_u32 vcc, s88, v1
  v_mov_b32 v74, 1.0
  s_nop 0
  v_cndmask_b32_e64 v74, v74, 0, vcc
  s_nop 0
  s_waitcnt lgkmcnt(6)
  v_mfma_f32_16x16x32_bf16 v[136:139], a[148:151], a[192:195], v[136:139]
  ds_read_b64_tr_b16 a[172:173], v5 offset:12288
  ds_read_b64_tr_b16 a[174:175], v5 offset:14336
  v_mfma_f32_16x16x32_bf16 v[140:143], a[148:151], a[196:199], v[140:143]
  ds_read_b128 v[24:27], v73 offset:0
  v_mfma_f32_16x16x32_bf16 v[144:147], a[152:155], a[192:195], v[144:147]
  ds_read_b64_tr_b16 a[144:145], v2 offset:16384
  ds_read_b64_tr_b16 a[146:147], v2 offset:18432
  s_add_u32 s66, s58, 147840
  v_mfma_f32_16x16x32_bf16 v[148:151], a[152:155], a[196:199], v[148:151]
  s_add_u32 m0, s63, 126976
  ds_read_b128 v[28:31], v73 offset:1024
  v_mfma_f32_16x16x32_bf16 v[152:155], a[156:159], a[192:195], v[152:155]
  ds_read_b64_tr_b16 a[148:149], v3 offset:16384
  ds_read_b64_tr_b16 a[150:151], v3 offset:18432
  v_mfma_f32_16x16x32_bf16 v[156:159], a[156:159], a[196:199], v[156:159]
  buffer_load_dwordx4 v248, s[16:19], s66 offen lds
  ds_read_b128 v[32:35], v73 offset:4096
  s_waitcnt lgkmcnt(9)
  v_mfma_f32_16x16x32_bf16 v[128:131], a[160:163], a[200:203], v[128:131]
  ds_read_b64_tr_b16 a[152:153], v4 offset:16384
  ds_read_b64_tr_b16 a[154:155], v4 offset:18432
  v_mfma_f32_16x16x32_bf16 v[132:135], a[160:163], a[204:207], v[132:135]
  ds_read_b128 v[36:39], v73 offset:5120
  v_mfma_f32_16x16x32_bf16 v[136:139], a[164:167], a[200:203], v[136:139]
  ds_read_b64_tr_b16 a[156:157], v5 offset:16384
  ds_read_b64_tr_b16 a[158:159], v5 offset:18432
  v_mfma_f32_16x16x32_bf16 v[140:143], a[164:167], a[204:207], v[140:143]
  buffer_load_dwordx4 v249, s[16:19], s66 offen offset:1024 lds
  ds_read_b128 v[40:43], v73 offset:8192
  v_mfma_f32_16x16x32_bf16 v[144:147], a[168:171], a[200:203], v[144:147]
  ds_read_b64_tr_b16 a[160:161], v2 offset:20480
  ds_read_b64_tr_b16 a[162:163], v2 offset:22528
  v_mfma_f32_16x16x32_bf16 v[148:151], a[168:171], a[204:207], v[148:151]
  ds_read_b128 v[44:47], v73 offset:9216
  s_waitcnt lgkmcnt(10)
  v_mfma_f32_16x16x32_bf16 v[152:155], a[172:175], a[200:203], v[152:155]
  ds_read_b64_tr_b16 a[164:165], v3 offset:20480
  ds_read_b64_tr_b16 a[166:167], v3 offset:22528
  v_mfma_f32_16x16x32_bf16 v[156:159], a[172:175], a[204:207], v[156:159]
  buffer_load_dwordx4 v250, s[16:19], s66 offen offset:2048 lds
  ds_read_b128 v[48:51], v73 offset:12288
  v_mfma_f32_16x16x32_bf16 v[128:131], a[144:147], a[208:211], v[128:131]
  ds_read_b64_tr_b16 a[168:169], v4 offset:20480
  ds_read_b64_tr_b16 a[170:171], v4 offset:22528
  v_mfma_f32_16x16x32_bf16 v[132:135], a[144:147], a[212:215], v[132:135]
  ds_read_b128 v[52:55], v73 offset:13312
  v_mfma_f32_16x16x32_bf16 v[136:139], a[148:151], a[208:211], v[136:139]
  ds_read_b64_tr_b16 a[172:173], v5 offset:20480
  ds_read_b64_tr_b16 a[174:175], v5 offset:22528
  v_mfma_f32_16x16x32_bf16 v[140:143], a[148:151], a[212:215], v[140:143]
  buffer_load_dwordx4 v251, s[16:19], s66 offen offset:3072 lds
  s_and_b32 s88, s48, 1
  s_waitcnt lgkmcnt(9)
  v_mfma_f32_16x16x32_bf16 v[144:147], a[152:155], a[208:211], v[144:147]
  ds_read_b64_tr_b16 a[144:145], v2 offset:24576
  ds_read_b64_tr_b16 a[146:147], v2 offset:26624
  v_mfma_f32_16x16x32_bf16 v[148:151], a[152:155], a[212:215], v[148:151]
  s_lshl_b32 s88, s88, 1
  s_add_u32 s88, s88, s81
  s_waitcnt lgkmcnt(4)
  v_mfma_f32_16x16x32_bf16 v[152:155], a[156:159], a[208:211], v[152:155]
  ds_read_b64_tr_b16 a[148:149], v3 offset:24576
  ds_read_b64_tr_b16 a[150:151], v3 offset:26624
  v_mfma_f32_16x16x32_bf16 v[156:159], a[156:159], a[212:215], v[156:159]
  s_add_u32 s67, s59, 384
  s_add_u32 m0, s64, 110592
  v_mfma_f32_16x16x32_bf16 v[128:131], a[160:163], a[216:219], v[128:131]
  ds_read_b64_tr_b16 a[152:153], v4 offset:24576
  ds_read_b64_tr_b16 a[154:155], v4 offset:26624
  v_mfma_f32_16x16x32_bf16 v[132:135], a[160:163], a[220:223], v[132:135]
  buffer_load_dwordx4 v248, s[16:19], s67 offen lds
  s_mul_i32 s86, s88, 608256
  s_waitcnt lgkmcnt(6)
  v_mfma_f32_16x16x32_bf16 v[136:139], a[164:167], a[216:219], v[136:139]
  ds_read_b64_tr_b16 a[156:157], v5 offset:24576
  ds_read_b64_tr_b16 a[158:159], v5 offset:26624
  v_mfma_f32_16x16x32_bf16 v[140:143], a[164:167], a[220:223], v[140:143]
  s_lshl_b32 s88, s49, 11
  s_add_u32 s86, s86, s88
  v_mfma_f32_16x16x32_bf16 v[144:147], a[168:171], a[216:219], v[144:147]
  ds_read_b64_tr_b16 a[160:161], v2 offset:28672
  ds_read_b64_tr_b16 a[162:163], v2 offset:30720
  v_mfma_f32_16x16x32_bf16 v[148:151], a[168:171], a[220:223], v[148:151]
  s_add_u32 s86, s86, 67108864
  v_bfe_u32 v68, v1, 4, 4
  v_mfma_f32_16x16x32_bf16 v[152:155], a[172:175], a[216:219], v[152:155]
  ds_read_b64_tr_b16 a[164:165], v3 offset:28672
  ds_read_b64_tr_b16 a[166:167], v3 offset:30720
  v_mfma_f32_16x16x32_bf16 v[156:159], a[172:175], a[220:223], v[156:159]
  s_lshr_b32 s88, s48, 1
  s_lshl_b32 s88, s88, 4
  v_cvt_pk_bf16_f32 v192, v192, v193
  v_cvt_pk_bf16_f32 v193, v194, v195
  v_cvt_pk_bf16_f32 v194, v196, v197
  v_cvt_pk_bf16_f32 v195, v198, v199
  s_nop 1
  v_permlane32_swap_b32 v192, v194
  v_permlane32_swap_b32 v193, v195
  v_cvt_pk_bf16_f32 v200, v200, v201
  v_cvt_pk_bf16_f32 v201, v202, v203
  v_cvt_pk_bf16_f32 v202, v204, v205
  v_cvt_pk_bf16_f32 v203, v206, v207
  s_nop 1
  v_permlane32_swap_b32 v200, v202
  v_permlane32_swap_b32 v201, v203
  s_waitcnt lgkmcnt(6)
  v_mfma_f32_16x16x32_bf16 v[128:131], a[144:147], a[224:227], v[128:131]
  ds_read_b64_tr_b16 a[168:169], v4 offset:28672
  ds_read_b64_tr_b16 a[170:171], v4 offset:30720
  v_mfma_f32_16x16x32_bf16 v[132:135], a[144:147], a[228:231], v[132:135]
  s_add_u32 s7, s71, 0
  buffer_store_dwordx4 v[192:195], v13, s[24:27], s7 offen offset:0 sc1
  v_mfma_f32_16x16x32_bf16 v[136:139], a[148:151], a[224:227], v[136:139]
  ds_read_b64_tr_b16 a[172:173], v5 offset:28672
  ds_read_b64_tr_b16 a[174:175], v5 offset:30720
  v_mfma_f32_16x16x32_bf16 v[140:143], a[148:151], a[228:231], v[140:143]
  v_add_u32 v68, s88, v68
  v_bfe_u32 v71, v1, 8, 1
  v_mfma_f32_16x16x32_bf16 v[144:147], a[152:155], a[224:227], v[144:147]
  ds_read_b64_tr_b16 a[144:145], v2 offset:32768
  ds_read_b64_tr_b16 a[146:147], v2 offset:34816
  v_mfma_f32_16x16x32_bf16 v[148:151], a[152:155], a[228:231], v[148:151]
  v_lshlrev_b32 v71, 10, v71
  v_and_b32 v70, 512, v1
  s_waitcnt lgkmcnt(6)
  v_mfma_f32_16x16x32_bf16 v[152:155], a[156:159], a[224:227], v[152:155]
  ds_read_b64_tr_b16 a[148:149], v3 offset:32768
  ds_read_b64_tr_b16 a[150:151], v3 offset:34816
  v_mfma_f32_16x16x32_bf16 v[156:159], a[156:159], a[228:231], v[156:159]
  v_add_u32 v71, v71, v70
  s_mul_i32 s88, s82, 33792
  v_mfma_f32_16x16x32_bf16 v[128:131], a[160:163], a[232:235], v[128:131]
  ds_read_b64_tr_b16 a[152:153], v4 offset:32768
  ds_read_b64_tr_b16 a[154:155], v4 offset:34816
  v_mfma_f32_16x16x32_bf16 v[132:135], a[160:163], a[236:239], v[132:135]
  v_lshl_add_u32 v72, v68, 4, v71
  v_add_u32 v72, s88, v72
  v_mfma_f32_16x16x32_bf16 v[136:139], a[164:167], a[232:235], v[136:139]
  ds_read_b64_tr_b16 a[156:157], v5 offset:32768
  ds_read_b64_tr_b16 a[158:159], v5 offset:34816
  v_mfma_f32_16x16x32_bf16 v[140:143], a[164:167], a[236:239], v[140:143]
  s_lshl_b32 s88, s82, 5
  v_add_u32 v68, s88, v68
  s_waitcnt lgkmcnt(6)
  v_mfma_f32_16x16x32_bf16 v[144:147], a[168:171], a[232:235], v[144:147]
  v_sub_u32 v69, 576, v68
  v_mfma_f32_16x16x32_bf16 v[148:151], a[168:171], a[236:239], v[148:151]
  v_lshrrev_b32 v70, 5, v69
  v_mul_u32_u24 v70, 33792, v70
  v_mfma_f32_16x16x32_bf16 v[152:155], a[172:175], a[232:235], v[152:155]
  s_add_u32 s7, s71, 0
  buffer_store_dwordx4 v[200:203], v13, s[24:27], s7 offen offset:1024 sc1
  v_mfma_f32_16x16x32_bf16 v[156:159], a[172:175], a[236:239], v[156:159]
  v_and_b32 v69, 31, v69
  v_lshlrev_b32 v69, 4, v69
  s_cmp_eq_u32 s83, 0
  s_cselect_b32 s80, 8, 0
  v_bfe_u32 v20, v1, 4, 4
  s_and_b32 s4, s48, 1
  s_lshl_b32 s4, s4, 4
  v_add_u32 v20, s4, v20
  s_lshl_b32 s4, s80, 5
  v_add_u32 v21, s4, v20
  v_cvt_f32_u32 v21, v21
  s_mov_b32 s4, 0xbae38e39
  s_mov_b32 s5, 0
  v_mul_f32 v21, s4, v21
  v_mov_b32 v22, s5
  s_cmp_eq_u32 s83, 1
  s_cselect_b32 s4, 0, -1
  v_cmp_eq_u32 vcc, s4, v20
  v_mov_b32 v23, 0.5
  v_mov_b32 v20, 0x3e800000
  v_cndmask_b32 v21, v21, v23, vcc
  v_cndmask_b32 v22, v22, v20, vcc
  v_mul_f32 v16, 0x42000000, v21
  v_fract_f32 v16, v16
  v_lshrrev_b32 v20, 8, v1
  v_lshlrev_b32 v20, 3, v20
  s_lshr_b32 s4, s48, 1
  s_mul_i32 s4, s4, 288
  v_add_u32 v20, s4, v20
  v_cvt_f32_u32 v20, v20
  v_mov_b32 v23, v20
  v_fma_f32 v76, v23, v21, v22
  v_fract_f32 v76, v76
  v_add_f32 v23, 1.0, v20
  v_fma_f32 v77, v23, v21, v22
  v_fract_f32 v77, v77
  v_add_f32 v23, 2.0, v20
  v_fma_f32 v78, v23, v21, v22
  v_fract_f32 v78, v78
  v_add_f32 v23, 3.0, v20
  v_fma_f32 v79, v23, v21, v22
  v_fract_f32 v79, v79
  v_add_f32 v23, 4.0, v20
  v_fma_f32 v80, v23, v21, v22
  v_fract_f32 v80, v80
  v_add_f32 v23, 5.0, v20
  v_fma_f32 v81, v23, v21, v22
  v_fract_f32 v81, v81
  v_add_f32 v23, 6.0, v20
  v_fma_f32 v82, v23, v21, v22
  v_fract_f32 v82, v82
  v_add_f32 v23, 7.0, v20
  v_fma_f32 v83, v23, v21, v22
  v_fract_f32 v83, v83
  s_lshr_b32 s4, s48, 1
  s_mul_i32 s4, s4, 18432
  s_and_b32 s5, s48, 1
  s_lshl_b32 s5, s5, 10
  s_add_u32 s4, s4, s5
  s_add_u32 s4, s4, 0
  v_add_u32 v17, s4, v1
  s_cmp_eq_u32 s83, 2
  s_cselect_b32 s4, 36864, 0
  v_add_u32 v18, s4, v1
  s_nop 0
  v_mfma_f32_16x16x32_bf16 v[128:131], a[144:147], a[240:243], v[128:131]
  v_mfma_f32_16x16x32_bf16 v[132:135], a[144:147], a[244:247], v[132:135]
  s_waitcnt vmcnt(31) lgkmcnt(0)
  s_barrier
  v_add_u32 v2, 36864, v8
  v_xor_b32 v3, 32, v2
  v_xor_b32 v4, 64, v2
  v_xor_b32 v5, 0x60, v2
  v_mfma_f32_16x16x32_bf16 v[136:139], a[148:151], a[240:243], v[136:139]
  ds_read_b64_tr_b16 a[160:161], v2 offset:0
  ds_read_b64_tr_b16 a[162:163], v2 offset:2048
  v_mfma_f32_16x16x32_bf16 v[140:143], a[148:151], a[244:247], v[140:143]
  ds_read_b64_tr_b16 a[164:165], v3 offset:0
  ds_read_b64_tr_b16 a[166:167], v3 offset:2048
  v_mfma_f32_16x16x32_bf16 v[144:147], a[152:155], a[240:243], v[144:147]
  ds_read_b64_tr_b16 a[168:169], v4 offset:0
  ds_read_b64_tr_b16 a[170:171], v4 offset:2048
  v_mfma_f32_16x16x32_bf16 v[148:151], a[152:155], a[244:247], v[148:151]
  ds_read_b64_tr_b16 a[172:173], v5 offset:0
  ds_read_b64_tr_b16 a[174:175], v5 offset:2048
  v_mfma_f32_16x16x32_bf16 v[152:155], a[156:159], a[240:243], v[152:155]
  ds_read_b64_tr_b16 a[144:145], v2 offset:4096
  ds_read_b64_tr_b16 a[146:147], v2 offset:6144
  v_mfma_f32_16x16x32_bf16 v[156:159], a[156:159], a[244:247], v[156:159]
  ds_read_b64_tr_b16 a[148:149], v3 offset:4096
  ds_read_b64_tr_b16 a[150:151], v3 offset:6144
  s_cmp_gt_u32 s83, 2
  s_cbranch_scc1 K1_tailN
  s_waitcnt lgkmcnt(6)
  v_mfma_f32_16x16x32_bf16 v[160:163], a[160:163], a[176:179], v[160:163]
  ds_read_b64_tr_b16 a[152:153], v4 offset:4096
  ds_read_b64_tr_b16 a[154:155], v4 offset:6144
  v_mfma_f32_16x16x32_bf16 v[164:167], a[160:163], a[180:183], v[164:167]
  v_add3_u32 v73, v69, v70, v71
  v_cmp_eq_u32 vcc, 0, v68
  v_mov_b32 v69, 0x7ff00000
  s_nop 0
  v_cndmask_b32 v73, v73, v69, vcc
  v_mfma_f32_16x16x32_bf16 v[168:171], a[164:167], a[176:179], v[168:171]
  ds_read_b64_tr_b16 a[156:157], v5 offset:4096
  ds_read_b64_tr_b16 a[158:159], v5 offset:6144
  v_mfma_f32_16x16x32_bf16 v[172:175], a[164:167], a[180:183], v[172:175]
  s_cmp_eq_u32 s81, 1
  s_cselect_b32 s87, 0x80008000, 0
  v_mul_f32 v75, s92, v40
  v_fma_f32 v75, s93, v48, v75
  v_mul_f32 v75, v74, v75
  v_fma_f32 v56, s90, v24, v75
  v_fma_f32 v56, s91, v32, v56
  v_mul_f32 v57, s90, v25
  v_fma_f32 v57, s91, v33, v57
  v_fma_f32 v57, s92, v41, v57
  v_fma_f32 v57, s93, v49, v57
  v_mul_f32 v58, s90, v26
  v_fma_f32 v58, s91, v34, v58
  v_fma_f32 v58, s92, v42, v58
  v_fma_f32 v58, s93, v50, v58
  v_mul_f32 v59, s90, v27
  v_fma_f32 v59, s91, v35, v59
  v_fma_f32 v59, s92, v43, v59
  v_fma_f32 v59, s93, v51, v59
  v_mul_f32 v60, s90, v28
  v_fma_f32 v60, s91, v36, v60
  v_fma_f32 v60, s92, v44, v60
  v_fma_f32 v60, s93, v52, v60
  v_mul_f32 v61, s90, v29
  v_fma_f32 v61, s91, v37, v61
  v_fma_f32 v61, s92, v45, v61
  v_fma_f32 v61, s93, v53, v61
  v_mul_f32 v62, s90, v30
  v_fma_f32 v62, s91, v38, v62
  v_fma_f32 v62, s92, v46, v62
  v_fma_f32 v62, s93, v54, v62
  v_mul_f32 v63, s90, v31
  v_fma_f32 v63, s91, v39, v63
  v_fma_f32 v63, s92, v47, v63
  v_fma_f32 v63, s93, v55, v63
  v_cvt_pk_bf16_f32 v64, v56, v57
  v_cvt_pk_bf16_f32 v65, v58, v59
  v_cvt_pk_bf16_f32 v66, v60, v61
  v_cvt_pk_bf16_f32 v67, v62, v63
  s_nop 1
  v_permlane16_swap_b32 v64, v66
  v_permlane16_swap_b32 v65, v67
  s_nop 0
  buffer_store_dwordx4 v[64:67], v72, s[24:27], s86 offen sc1
  v_xor_b32 v68, s87, v64
  v_xor_b32 v69, s87, v65
  v_xor_b32 v70, s87, v66
  v_xor_b32 v71, s87, v67
  buffer_store_dwordx4 v[68:71], v73, s[24:27], s86 offen sc1
  s_cmp_eq_u32 s49, 0
  s_cbranch_scc0 K1_noz512_1
  v_mul_f32 v56, s94, v40
  v_fma_f32 v56, s95, v48, v56
  v_cmp_gt_u32 vcc, 256, v1
  v_mov_b32 v57, 0
  v_mov_b32 v58, 0x7ff00000
  v_cndmask_b32 v56, v57, v56, vcc
  v_cvt_pk_bf16_f32 v60, v56, v57
  v_mov_b32 v61, 0
  v_mov_b32 v62, 0
  v_mov_b32 v63, 0
  v_and_b32 v59, 256, v1
  v_cmp_eq_u32 vcc, 0, v59
  s_add_u32 s88, s86, 32768
  s_nop 0
  v_cndmask_b32 v72, v58, v72, vcc
  v_cndmask_b32 v73, v58, v73, vcc
  buffer_store_dwordx4 v[60:63], v72, s[24:27], s88 offen sc1
  s_nop 1
  v_xor_b32 v60, s87, v60
  s_nop 0
  buffer_store_dwordx4 v[60:63], v73, s[24:27], s88 offen sc1
K1_noz512_1:
  v_mfma_f32_16x16x32_bf16 v[176:179], a[168:171], a[176:179], v[176:179]
  ds_read_b64_tr_b16 a[160:161], v2 offset:8192
  ds_read_b64_tr_b16 a[162:163], v2 offset:10240
  v_mfma_f32_16x16x32_bf16 v[180:183], a[168:171], a[180:183], v[180:183]
  s_cmp_eq_u32 s83, 0
  s_cselect_b32 s82, 8, 0
  s_mov_b32 s81, 1
  s_waitcnt lgkmcnt(6)
  v_mfma_f32_16x16x32_bf16 v[184:187], a[172:175], a[176:179], v[184:187]
  ds_read_b64_tr_b16 a[164:165], v3 offset:8192
  ds_read_b64_tr_b16 a[166:167], v3 offset:10240
  v_mfma_f32_16x16x32_bf16 v[188:191], a[172:175], a[180:183], v[188:191]
  v_mfma_f32_16x16x32_bf16 v[160:163], a[144:147], a[184:187], v[160:163]
  ds_read_b64_tr_b16 a[168:169], v4 offset:8192
  ds_read_b64_tr_b16 a[170:171], v4 offset:10240
  v_mfma_f32_16x16x32_bf16 v[164:167], a[144:147], a[188:191], v[164:167]
  v_cvt_pk_bf16_f32 v128, v128, v129
  v_cvt_pk_bf16_f32 v129, v130, v131
  v_mfma_f32_16x16x32_bf16 v[168:171], a[148:151], a[184:187], v[168:171]
  ds_read_b64_tr_b16 a[172:173], v5 offset:8192
  ds_read_b64_tr_b16 a[174:175], v5 offset:10240
  v_mfma_f32_16x16x32_bf16 v[172:175], a[148:151], a[188:191], v[172:175]
  v_cvt_pk_bf16_f32 v130, v132, v133
  v_cvt_pk_bf16_f32 v131, v134, v135
  s_waitcnt lgkmcnt(6)
  v_mfma_f32_16x16x32_bf16 v[176:179], a[152:155], a[184:187], v[176:179]
  ds_read_b64_tr_b16 a[144:145], v2 offset:12288
  ds_read_b64_tr_b16 a[146:147], v2 offset:14336
  v_mfma_f32_16x16x32_bf16 v[180:183], a[152:155], a[188:191], v[180:183]
  s_nop 1
  v_permlane32_swap_b32 v128, v130
  v_mfma_f32_16x16x32_bf16 v[184:187], a[156:159], a[184:187], v[184:187]
  ds_read_b64_tr_b16 a[148:149], v3 offset:12288
  ds_read_b64_tr_b16 a[150:151], v3 offset:14336
  v_mfma_f32_16x16x32_bf16 v[188:191], a[156:159], a[188:191], v[188:191]
  v_permlane32_swap_b32 v129, v131
  v_cvt_pk_bf16_f32 v136, v136, v137
  v_mfma_f32_16x16x32_bf16 v[160:163], a[160:163], a[192:195], v[160:163]
  ds_read_b64_tr_b16 a[152:153], v4 offset:12288
  ds_read_b64_tr_b16 a[154:155], v4 offset:14336
  v_mfma_f32_16x16x32_bf16 v[164:167], a[160:163], a[196:199], v[164:167]
  v_cvt_pk_bf16_f32 v137, v138, v139
  v_cvt_pk_bf16_f32 v138, v140, v141
  s_waitcnt lgkmcnt(6)
  v_mfma_f32_16x16x32_bf16 v[168:171], a[164:167], a[192:195], v[168:171]
  ds_read_b64_tr_b16 a[156:157], v5 offset:12288
  ds_read_b64_tr_b16 a[158:159], v5 offset:14336
  v_mfma_f32_16x16x32_bf16 v[172:175], a[164:167], a[196:199], v[172:175]
  v_cvt_pk_bf16_f32 v139, v142, v143
  s_nop 1
  v_mfma_f32_16x16x32_bf16 v[176:179], a[168:171], a[192:195], v[176:179]
  ds_read_b64_tr_b16 a[160:161], v2 offset:16384
  ds_read_b64_tr_b16 a[162:163], v2 offset:18432
  v_mfma_f32_16x16x32_bf16 v[180:183], a[168:171], a[196:199], v[180:183]
  v_permlane32_swap_b32 v136, v138
  v_permlane32_swap_b32 v137, v139
  v_mfma_f32_16x16x32_bf16 v[184:187], a[172:175], a[192:195], v[184:187]
  ds_read_b64_tr_b16 a[164:165], v3 offset:16384
  ds_read_b64_tr_b16 a[166:167], v3 offset:18432
  v_mfma_f32_16x16x32_bf16 v[188:191], a[172:175], a[196:199], v[188:191]
  v_cvt_pk_bf16_f32 v144, v144, v145
  v_cvt_pk_bf16_f32 v145, v146, v147
  s_waitcnt lgkmcnt(6)
  v_mfma_f32_16x16x32_bf16 v[160:163], a[144:147], a[200:203], v[160:163]
  ds_read_b64_tr_b16 a[168:169], v4 offset:16384
  ds_read_b64_tr_b16 a[170:171], v4 offset:18432
  v_mfma_f32_16x16x32_bf16 v[164:167], a[144:147], a[204:207], v[164:167]
  s_add_u32 s7, s70, 0
  buffer_store_dwordx4 v[128:131], v13, s[24:27], s7 offen offset:0 sc1
  v_mfma_f32_16x16x32_bf16 v[168:171], a[148:151], a[200:203], v[168:171]
  ds_read_b64_tr_b16 a[172:173], v5 offset:16384
  ds_read_b64_tr_b16 a[174:175], v5 offset:18432
  v_mfma_f32_16x16x32_bf16 v[172:175], a[148:151], a[204:207], v[172:175]
  v_cvt_pk_bf16_f32 v146, v148, v149
  v_cvt_pk_bf16_f32 v147, v150, v151
  v_mfma_f32_16x16x32_bf16 v[176:179], a[152:155], a[200:203], v[176:179]
  ds_read_b64_tr_b16 a[144:145], v2 offset:20480
  ds_read_b64_tr_b16 a[146:147], v2 offset:22528
  v_mfma_f32_16x16x32_bf16 v[180:183], a[152:155], a[204:207], v[180:183]
  s_nop 1
  v_permlane32_swap_b32 v144, v146
  s_waitcnt lgkmcnt(6)
  v_mfma_f32_16x16x32_bf16 v[184:187], a[156:159], a[200:203], v[184:187]
  ds_read_b64_tr_b16 a[148:149], v3 offset:20480
  ds_read_b64_tr_b16 a[150:151], v3 offset:22528
  v_mfma_f32_16x16x32_bf16 v[188:191], a[156:159], a[204:207], v[188:191]
  v_permlane32_swap_b32 v145, v147
  v_cvt_pk_bf16_f32 v152, v152, v153
  v_mfma_f32_16x16x32_bf16 v[160:163], a[160:163], a[208:211], v[160:163]
  ds_read_b64_tr_b16 a[152:153], v4 offset:20480
  ds_read_b64_tr_b16 a[154:155], v4 offset:22528
  v_mfma_f32_16x16x32_bf16 v[164:167], a[160:163], a[212:215], v[164:167]
  v_cvt_pk_bf16_f32 v153, v154, v155
  v_cvt_pk_bf16_f32 v154, v156, v157
  v_mfma_f32_16x16x32_bf16 v[168:171], a[164:167], a[208:211], v[168:171]
  ds_read_b64_tr_b16 a[156:157], v5 offset:20480
  ds_read_b64_tr_b16 a[158:159], v5 offset:22528
  v_mfma_f32_16x16x32_bf16 v[172:175], a[164:167], a[212:215], v[172:175]
  v_cvt_pk_bf16_f32 v155, v158, v159
  s_nop 1
  s_waitcnt lgkmcnt(6)
  v_mfma_f32_16x16x32_bf16 v[176:179], a[168:171], a[208:211], v[176:179]
  ds_read_b64_tr_b16 a[160:161], v2 offset:24576
  ds_read_b64_tr_b16 a[162:163], v2 offset:26624
  v_mfma_f32_16x16x32_bf16 v[180:183], a[168:171], a[212:215], v[180:183]
  v_permlane32_swap_b32 v152, v154
  v_permlane32_swap_b32 v153, v155
  v_mfma_f32_16x16x32_bf16 v[184:187], a[172:175], a[208:211], v[184:187]
  ds_read_b64_tr_b16 a[164:165], v3 offset:24576
  ds_read_b64_tr_b16 a[166:167], v3 offset:26624
  v_mfma_f32_16x16x32_bf16 v[188:191], a[172:175], a[212:215], v[188:191]
  s_add_u32 s7, s70, 0
  buffer_store_dwordx4 v[136:139], v13, s[24:27], s7 offen offset:1024 sc1
  v_mfma_f32_16x16x32_bf16 v[160:163], a[144:147], a[216:219], v[160:163]
  ds_read_b64_tr_b16 a[168:169], v4 offset:24576
  ds_read_b64_tr_b16 a[170:171], v4 offset:26624
  v_mfma_f32_16x16x32_bf16 v[164:167], a[144:147], a[220:223], v[164:167]
  v_cos_f32 v19, v16
  s_waitcnt lgkmcnt(6)
  v_mfma_f32_16x16x32_bf16 v[168:171], a[148:151], a[216:219], v[168:171]
  ds_read_b64_tr_b16 a[172:173], v5 offset:24576
  ds_read_b64_tr_b16 a[174:175], v5 offset:26624
  v_mfma_f32_16x16x32_bf16 v[172:175], a[148:151], a[220:223], v[172:175]
  v_add_f32 v19, v19, v19
  v_add_f32 v84, v76, v16
  v_mfma_f32_16x16x32_bf16 v[176:179], a[152:155], a[216:219], v[176:179]
  ds_read_b64_tr_b16 a[144:145], v2 offset:28672
  ds_read_b64_tr_b16 a[146:147], v2 offset:30720
  v_mfma_f32_16x16x32_bf16 v[180:183], a[152:155], a[220:223], v[180:183]
  v_add_f32 v85, v77, v16
  v_add_f32 v86, v78, v16
  v_mfma_f32_16x16x32_bf16 v[184:187], a[156:159], a[216:219], v[184:187]
  ds_read_b64_tr_b16 a[148:149], v3 offset:28672
  ds_read_b64_tr_b16 a[150:151], v3 offset:30720
  v_mfma_f32_16x16x32_bf16 v[188:191], a[156:159], a[220:223], v[188:191]
  v_add_f32 v87, v79, v16
  v_add_f32 v88, v80, v16
  s_waitcnt lgkmcnt(6)
  v_mfma_f32_16x16x32_bf16 v[160:163], a[160:163], a[224:227], v[160:163]
  ds_read_b64_tr_b16 a[152:153], v4 offset:28672
  ds_read_b64_tr_b16 a[154:155], v4 offset:30720
  v_mfma_f32_16x16x32_bf16 v[164:167], a[160:163], a[228:231], v[164:167]
  v_add_f32 v89, v81, v16
  v_add_f32 v90, v82, v16
  v_mfma_f32_16x16x32_bf16 v[168:171], a[164:167], a[224:227], v[168:171]
  ds_read_b64_tr_b16 a[156:157], v5 offset:28672
  ds_read_b64_tr_b16 a[158:159], v5 offset:30720
  v_mfma_f32_16x16x32_bf16 v[172:175], a[164:167], a[228:231], v[172:175]
  v_add_f32 v91, v83, v16
  v_mfma_f32_16x16x32_bf16 v[176:179], a[168:171], a[224:227], v[176:179]
  ds_read_b64_tr_b16 a[160:161], v2 offset:32768
  ds_read_b64_tr_b16 a[162:163], v2 offset:34816
  v_mfma_f32_16x16x32_bf16 v[180:183], a[168:171], a[228:231], v[180:183]
  s_add_u32 s7, s70, 0
  buffer_store_dwordx4 v[144:147], v13, s[24:27], s7 offen offset:2048 sc1
  s_waitcnt lgkmcnt(6)
  v_mfma_f32_16x16x32_bf16 v[184:187], a[172:175], a[224:227], v[184:187]
  ds_read_b64_tr_b16 a[164:165], v3 offset:32768
  ds_read_b64_tr_b16 a[166:167], v3 offset:34816
  v_mfma_f32_16x16x32_bf16 v[188:191], a[172:175], a[228:231], v[188:191]
  v_sin_f32 v76, v76
  v_mfma_f32_16x16x32_bf16 v[160:163], a[144:147], a[232:235], v[160:163]
  ds_read_b64_tr_b16 a[168:169], v4 offset:32768
  ds_read_b64_tr_b16 a[170:171], v4 offset:34816
  v_mfma_f32_16x16x32_bf16 v[164:167], a[144:147], a[236:239], v[164:167]
  v_sin_f32 v77, v77
  v_mfma_f32_16x16x32_bf16 v[168:171], a[148:151], a[232:235], v[168:171]
  ds_read_b64_tr_b16 a[172:173], v5 offset:32768
  ds_read_b64_tr_b16 a[174:175], v5 offset:34816
  v_mfma_f32_16x16x32_bf16 v[172:175], a[148:151], a[236:239], v[172:175]
  v_sin_f32 v78, v78
  s_waitcnt lgkmcnt(6)
  v_mfma_f32_16x16x32_bf16 v[176:179], a[152:155], a[232:235], v[176:179]
  v_cvt_pk_bf16_f32 v20, v76, v77
  v_mfma_f32_16x16x32_bf16 v[180:183], a[152:155], a[236:239], v[180:183]
  v_sin_f32 v79, v79
  v_mfma_f32_16x16x32_bf16 v[184:187], a[156:159], a[232:235], v[184:187]
  v_sin_f32 v80, v80
  v_mfma_f32_16x16x32_bf16 v[188:191], a[156:159], a[236:239], v[188:191]
  v_sin_f32 v81, v81
  v_mfma_f32_16x16x32_bf16 v[160:163], a[160:163], a[240:243], v[160:163]
  v_mfma_f32_16x16x32_bf16 v[164:167], a[160:163], a[244:247], v[164:167]
  s_waitcnt vmcnt(17) lgkmcnt(0)
  s_barrier
  v_add_u32 v2, 73728, v8
  v_xor_b32 v3, 32, v2
  v_xor_b32 v4, 64, v2
  v_xor_b32 v5, 0x60, v2
  v_mfma_f32_16x16x32_bf16 v[168:171], a[164:167], a[240:243], v[168:171]
  ds_read_b64_tr_b16 a[144:145], v2 offset:0
  ds_read_b64_tr_b16 a[146:147], v2 offset:2048
  ds_read_b64_tr_b16 a[148:149], v3 offset:0
  v_mfma_f32_16x16x32_bf16 v[172:175], a[164:167], a[244:247], v[172:175]
  ds_read_b64_tr_b16 a[150:151], v3 offset:2048
  s_add_u32 s7, s70, 0
  buffer_store_dwordx4 v[152:155], v13, s[24:27], s7 offen offset:3072 sc1
  v_mfma_f32_16x16x32_bf16 v[176:179], a[168:171], a[240:243], v[176:179]
  ds_read_b64_tr_b16 a[152:153], v4 offset:0
  ds_read_b64_tr_b16 a[154:155], v4 offset:2048
  v_mfma_f32_16x16x32_bf16 v[180:183], a[168:171], a[244:247], v[180:183]
  ds_read_b64_tr_b16 a[156:157], v5 offset:0
  ds_read_b64_tr_b16 a[158:159], v5 offset:2048
  v_mfma_f32_16x16x32_bf16 v[184:187], a[172:175], a[240:243], v[184:187]
  ds_read_b64_tr_b16 a[160:161], v2 offset:4096
  ds_read_b64_tr_b16 a[162:163], v2 offset:6144
  v_mfma_f32_16x16x32_bf16 v[188:191], a[172:175], a[244:247], v[188:191]
  ds_read_b64_tr_b16 a[164:165], v3 offset:4096
  ds_read_b64_tr_b16 a[166:167], v3 offset:6144
  s_cmp_eq_u32 s83, 2
  s_cbranch_scc0 K1_nogdma
  v_bfe_u32 v20, v1, 4, 4
  v_lshrrev_b32 v21, 8, v1
  v_lshlrev_b32 v21, 4, v21
  v_mov_b32 v22, 0x7ff00000
  v_cmp_eq_u32 vcc, 0, v20
  s_mul_i32 s66, s48, 9
  s_mul_i32 s67, s48, 9216
  v_cndmask_b32 v21, v22, v21, vcc
  s_add_u32 s65, s66, 0
  s_bitcmp1_b32 s65, 0
  s_cselect_b32 s5, 0x70000000, 0
  s_lshr_b32 s65, s65, 1
  s_lshl_b32 s65, s65, 6
  s_add_u32 s65, s65, s5
  s_add_u32 m0, s67, 36864
  s_nop 0
  buffer_load_dwordx4 v21, s[40:43], s65 offen lds
  s_add_u32 s65, s66, 1
  s_bitcmp1_b32 s65, 0
  s_cselect_b32 s5, 0x70000000, 0
  s_lshr_b32 s65, s65, 1
  s_lshl_b32 s65, s65, 6
  s_add_u32 s65, s65, s5
  s_add_u32 m0, s67, 37888
  s_nop 0
  buffer_load_dwordx4 v21, s[40:43], s65 offen lds
  s_add_u32 s65, s66, 2
  s_bitcmp1_b32 s65, 0
  s_cselect_b32 s5, 0x70000000, 0
  s_lshr_b32 s65, s65, 1
  s_lshl_b32 s65, s65, 6
  s_add_u32 s65, s65, s5
  s_add_u32 m0, s67, 38912
  s_nop 0
  buffer_load_dwordx4 v21, s[40:43], s65 offen lds
  s_add_u32 s65, s66, 3
  s_bitcmp1_b32 s65, 0
  s_cselect_b32 s5, 0x70000000, 0
  s_lshr_b32 s65, s65, 1
  s_lshl_b32 s65, s65, 6
  s_add_u32 s65, s65, s5
  s_add_u32 m0, s67, 39936
  s_nop 0
  buffer_load_dwordx4 v21, s[40:43], s65 offen lds
  s_add_u32 s65, s66, 4
  s_bitcmp1_b32 s65, 0
  s_cselect_b32 s5, 0x70000000, 0
  s_lshr_b32 s65, s65, 1
  s_lshl_b32 s65, s65, 6
  s_add_u32 s65, s65, s5
  s_add_u32 m0, s67, 40960
  s_nop 0
  buffer_load_dwordx4 v21, s[40:43], s65 offen lds
  s_add_u32 s65, s66, 5
  s_bitcmp1_b32 s65, 0
  s_cselect_b32 s5, 0x70000000, 0
  s_lshr_b32 s65, s65, 1
  s_lshl_b32 s65, s65, 6
  s_add_u32 s65, s65, s5
  s_add_u32 m0, s67, 41984
  s_nop 0
  buffer_load_dwordx4 v21, s[40:43], s65 offen lds
  s_add_u32 s65, s66, 6
  s_bitcmp1_b32 s65, 0
  s_cselect_b32 s5, 0x70000000, 0
  s_lshr_b32 s65, s65, 1
  s_lshl_b32 s65, s65, 6
  s_add_u32 s65, s65, s5
  s_add_u32 m0, s67, 43008
  s_nop 0
  buffer_load_dwordx4 v21, s[40:43], s65 offen lds
  s_add_u32 s65, s66, 7
  s_bitcmp1_b32 s65, 0
  s_cselect_b32 s5, 0x70000000, 0
  s_lshr_b32 s65, s65, 1
  s_lshl_b32 s65, s65, 6
  s_add_u32 s65, s65, s5
  s_add_u32 m0, s67, 44032
  s_nop 0
  buffer_load_dwordx4 v21, s[40:43], s65 offen lds
  s_add_u32 s65, s66, 8
  s_bitcmp1_b32 s65, 0
  s_cselect_b32 s5, 0x70000000, 0
  s_lshr_b32 s65, s65, 1
  s_lshl_b32 s65, s65, 6
  s_add_u32 s65, s65, s5
  s_add_u32 m0, s67, 45056
  s_nop 0
  buffer_load_dwordx4 v21, s[40:43], s65 offen lds
K1_nogdma:
  s_waitcnt lgkmcnt(6)
  v_mfma_f32_16x16x32_bf16 v[208:211], a[144:147], a[176:179], v[208:211]
  ds_read_b64_tr_b16 a[168:169], v4 offset:4096
  ds_read_b64_tr_b16 a[170:171], v4 offset:6144
  v_mfma_f32_16x16x32_bf16 v[212:215], a[144:147], a[180:183], v[212:215]
  v_sin_f32 v82, v82
  v_mfma_f32_16x16x32_bf16 v[216:219], a[148:151], a[176:179], v[216:219]
  ds_read_b64_tr_b16 a[172:173], v5 offset:4096
  ds_read_b64_tr_b16 a[174:175], v5 offset:6144
  v_mfma_f32_16x16x32_bf16 v[220:223], a[148:151], a[180:183], v[220:223]
  v_sin_f32 v83, v83
  v_mfma_f32_16x16x32_bf16 v[224:227], a[152:155], a[176:179], v[224:227]
  ds_read_b64_tr_b16 a[144:145], v2 offset:8192
  ds_read_b64_tr_b16 a[146:147], v2 offset:10240
  v_mfma_f32_16x16x32_bf16 v[228:231], a[152:155], a[180:183], v[228:231]
  v_cvt_pk_bf16_f32 v21, v78, v79
  v_cvt_pk_bf16_f32 v22, v80, v81
  s_waitcnt lgkmcnt(6)
  v_mfma_f32_16x16x32_bf16 v[232:235], a[156:159], a[176:179], v[232:235]
  ds_read_b64_tr_b16 a[148:149], v3 offset:8192
  ds_read_b64_tr_b16 a[150:151], v3 offset:10240
  v_mfma_f32_16x16x32_bf16 v[236:239], a[156:159], a[180:183], v[236:239]
  v_cvt_pk_bf16_f32 v23, v82, v83
  ds_write_b128 v17, v[20:23] offset:0
  v_mfma_f32_16x16x32_bf16 v[208:211], a[160:163], a[184:187], v[208:211]
  ds_read_b64_tr_b16 a[152:153], v4 offset:8192
  ds_read_b64_tr_b16 a[154:155], v4 offset:10240
  v_mfma_f32_16x16x32_bf16 v[212:215], a[160:163], a[188:191], v[212:215]
  v_cvt_pk_bf16_f32 v160, v160, v161
  v_cvt_pk_bf16_f32 v161, v162, v163
  v_mfma_f32_16x16x32_bf16 v[216:219], a[164:167], a[184:187], v[216:219]
  ds_read_b64_tr_b16 a[156:157], v5 offset:8192
  ds_read_b64_tr_b16 a[158:159], v5 offset:10240
  v_mfma_f32_16x16x32_bf16 v[220:223], a[164:167], a[188:191], v[220:223]
  v_cvt_pk_bf16_f32 v162, v164, v165
  v_cvt_pk_bf16_f32 v163, v166, v167
  s_waitcnt lgkmcnt(7)
  v_mfma_f32_16x16x32_bf16 v[224:227], a[168:171], a[184:187], v[224:227]
  ds_read_b64_tr_b16 a[160:161], v2 offset:12288
  ds_read_b64_tr_b16 a[162:163], v2 offset:14336
  v_mfma_f32_16x16x32_bf16 v[228:231], a[168:171], a[188:191], v[228:231]
  s_nop 1
  v_permlane32_swap_b32 v160, v162
  v_mfma_f32_16x16x32_bf16 v[232:235], a[172:175], a[184:187], v[232:235]
  ds_read_b64_tr_b16 a[164:165], v3 offset:12288
  ds_read_b64_tr_b16 a[166:167], v3 offset:14336
  v_mfma_f32_16x16x32_bf16 v[236:239], a[172:175], a[188:191], v[236:239]
  v_permlane32_swap_b32 v161, v163
  v_cvt_pk_bf16_f32 v168, v168, v169
  v_cvt_pk_bf16_f32 v169, v170, v171
  v_cvt_pk_bf16_f32 v170, v172, v173
  v_cvt_pk_bf16_f32 v171, v174, v175
  s_nop 1
  v_permlane32_swap_b32 v168, v170
  v_permlane32_swap_b32 v169, v171
  v_mfma_f32_16x16x32_bf16 v[208:211], a[144:147], a[192:195], v[208:211]
  ds_read_b64_tr_b16 a[168:169], v4 offset:12288
  ds_read_b64_tr_b16 a[170:171], v4 offset:14336
  v_mfma_f32_16x16x32_bf16 v[212:215], a[144:147], a[196:199], v[212:215]
  s_add_u32 s7, s70, 4096
  buffer_store_dwordx4 v[160:163], v13, s[24:27], s7 offen offset:0 sc1
  s_waitcnt lgkmcnt(6)
  v_mfma_f32_16x16x32_bf16 v[216:219], a[148:151], a[192:195], v[216:219]
  ds_read_b64_tr_b16 a[172:173], v5 offset:12288
  ds_read_b64_tr_b16 a[174:175], v5 offset:14336
  v_mfma_f32_16x16x32_bf16 v[220:223], a[148:151], a[196:199], v[220:223]
  v_cvt_pk_bf16_f32 v176, v176, v177
  v_cvt_pk_bf16_f32 v177, v178, v179
  v_mfma_f32_16x16x32_bf16 v[224:227], a[152:155], a[192:195], v[224:227]
  ds_read_b64_tr_b16 a[144:145], v2 offset:16384
  ds_read_b64_tr_b16 a[146:147], v2 offset:18432
  v_mfma_f32_16x16x32_bf16 v[228:231], a[152:155], a[196:199], v[228:231]
  v_cvt_pk_bf16_f32 v178, v180, v181
  v_cvt_pk_bf16_f32 v179, v182, v183
  v_mfma_f32_16x16x32_bf16 v[232:235], a[156:159], a[192:195], v[232:235]
  ds_read_b64_tr_b16 a[148:149], v3 offset:16384
  ds_read_b64_tr_b16 a[150:151], v3 offset:18432
  v_mfma_f32_16x16x32_bf16 v[236:239], a[156:159], a[196:199], v[236:239]
  s_nop 1
  v_permlane32_swap_b32 v176, v178
  s_waitcnt lgkmcnt(6)
  v_mfma_f32_16x16x32_bf16 v[208:211], a[160:163], a[200:203], v[208:211]
  ds_read_b64_tr_b16 a[152:153], v4 offset:16384
  ds_read_b64_tr_b16 a[154:155], v4 offset:18432
  v_mfma_f32_16x16x32_bf16 v[212:215], a[160:163], a[204:207], v[212:215]
  v_permlane32_swap_b32 v177, v179
  v_cvt_pk_bf16_f32 v184, v184, v185
  v_mfma_f32_16x16x32_bf16 v[216:219], a[164:167], a[200:203], v[216:219]
  ds_read_b64_tr_b16 a[156:157], v5 offset:16384
  ds_read_b64_tr_b16 a[158:159], v5 offset:18432
  v_mfma_f32_16x16x32_bf16 v[220:223], a[164:167], a[204:207], v[220:223]
  v_cvt_pk_bf16_f32 v185, v186, v187
  v_cvt_pk_bf16_f32 v186, v188, v189
  v_mfma_f32_16x16x32_bf16 v[224:227], a[168:171], a[200:203], v[224:227]
  ds_read_b64_tr_b16 a[160:161], v2 offset:20480
  ds_read_b64_tr_b16 a[162:163], v2 offset:22528
  v_mfma_f32_16x16x32_bf16 v[228:231], a[168:171], a[204:207], v[228:231]
  v_cvt_pk_bf16_f32 v187, v190, v191
  s_nop 1
  s_waitcnt lgkmcnt(6)
  v_mfma_f32_16x16x32_bf16 v[232:235], a[172:175], a[200:203], v[232:235]
  ds_read_b64_tr_b16 a[164:165], v3 offset:20480
  ds_read_b64_tr_b16 a[166:167], v3 offset:22528
  v_mfma_f32_16x16x32_bf16 v[236:239], a[172:175], a[204:207], v[236:239]
  v_permlane32_swap_b32 v184, v186
  v_permlane32_swap_b32 v185, v187
  v_mfma_f32_16x16x32_bf16 v[208:211], a[144:147], a[208:211], v[208:211]
  ds_read_b64_tr_b16 a[168:169], v4 offset:20480
  ds_read_b64_tr_b16 a[170:171], v4 offset:22528
  v_mfma_f32_16x16x32_bf16 v[212:215], a[144:147], a[212:215], v[212:215]
  s_add_u32 s7, s70, 4096
  buffer_store_dwordx4 v[168:171], v13, s[24:27], s7 offen offset:1024 sc1
  v_mfma_f32_16x16x32_bf16 v[216:219], a[148:151], a[208:211], v[216:219]
  ds_read_b64_tr_b16 a[172:173], v5 offset:20480
  ds_read_b64_tr_b16 a[174:175], v5 offset:22528
  v_mfma_f32_16x16x32_bf16 v[220:223], a[148:151], a[212:215], v[220:223]
  v_sin_f32 v84, v84
  s_waitcnt lgkmcnt(6)
  v_mfma_f32_16x16x32_bf16 v[224:227], a[152:155], a[208:211], v[224:227]
  ds_read_b64_tr_b16 a[144:145], v2 offset:24576
  ds_read_b64_tr_b16 a[146:147], v2 offset:26624
  v_mfma_f32_16x16x32_bf16 v[228:231], a[152:155], a[212:215], v[228:231]
  v_sin_f32 v85, v85
  v_mfma_f32_16x16x32_bf16 v[232:235], a[156:159], a[208:211], v[232:235]
  ds_read_b64_tr_b16 a[148:149], v3 offset:24576
  ds_read_b64_tr_b16 a[150:151], v3 offset:26624
  v_mfma_f32_16x16x32_bf16 v[236:239], a[156:159], a[212:215], v[236:239]
  v_sin_f32 v86, v86
  v_mfma_f32_16x16x32_bf16 v[208:211], a[160:163], a[216:219], v[208:211]
  ds_read_b64_tr_b16 a[152:153], v4 offset:24576
  ds_read_b64_tr_b16 a[154:155], v4 offset:26624
  v_mfma_f32_16x16x32_bf16 v[212:215], a[160:163], a[220:223], v[212:215]
  v_sin_f32 v87, v87
  s_waitcnt lgkmcnt(6)
  v_mfma_f32_16x16x32_bf16 v[216:219], a[164:167], a[216:219], v[216:219]
  ds_read_b64_tr_b16 a[156:157], v5 offset:24576
  ds_read_b64_tr_b16 a[158:159], v5 offset:26624
  v_mfma_f32_16x16x32_bf16 v[220:223], a[164:167], a[220:223], v[220:223]
  v_sin_f32 v88, v88
  v_mfma_f32_16x16x32_bf16 v[224:227], a[168:171], a[216:219], v[224:227]
  ds_read_b64_tr_b16 a[160:161], v2 offset:28672
  ds_read_b64_tr_b16 a[162:163], v2 offset:30720
  v_mfma_f32_16x16x32_bf16 v[228:231], a[168:171], a[220:223], v[228:231]
  v_sin_f32 v89, v89
  v_mfma_f32_16x16x32_bf16 v[232:235], a[172:175], a[216:219], v[232:235]
  ds_read_b64_tr_b16 a[164:165], v3 offset:28672
  ds_read_b64_tr_b16 a[166:167], v3 offset:30720
  v_mfma_f32_16x16x32_bf16 v[236:239], a[172:175], a[220:223], v[236:239]
  v_sin_f32 v90, v90
  s_waitcnt lgkmcnt(6)
  v_mfma_f32_16x16x32_bf16 v[208:211], a[144:147], a[224:227], v[208:211]
  ds_read_b64_tr_b16 a[168:169], v4 offset:28672
  ds_read_b64_tr_b16 a[170:171], v4 offset:30720
  v_mfma_f32_16x16x32_bf16 v[212:215], a[144:147], a[228:231], v[212:215]
  s_add_u32 s7, s70, 4096
  buffer_store_dwordx4 v[176:179], v13, s[24:27], s7 offen offset:2048 sc1
  v_mfma_f32_16x16x32_bf16 v[216:219], a[148:151], a[224:227], v[216:219]
  ds_read_b64_tr_b16 a[172:173], v5 offset:28672
  ds_read_b64_tr_b16 a[174:175], v5 offset:30720
  v_mfma_f32_16x16x32_bf16 v[220:223], a[148:151], a[228:231], v[220:223]
  v_sin_f32 v91, v91
  v_mfma_f32_16x16x32_bf16 v[224:227], a[152:155], a[224:227], v[224:227]
  ds_read_b64_tr_b16 a[144:145], v2 offset:32768
  ds_read_b64_tr_b16 a[146:147], v2 offset:34816
  v_mfma_f32_16x16x32_bf16 v[228:231], a[152:155], a[228:231], v[228:231]
  v_cvt_pk_bf16_f32 v20, v84, v85
  v_cvt_pk_bf16_f32 v21, v86, v87
  s_waitcnt lgkmcnt(6)
  v_mfma_f32_16x16x32_bf16 v[232:235], a[156:159], a[224:227], v[232:235]
  ds_read_b64_tr_b16 a[148:149], v3 offset:32768
  ds_read_b64_tr_b16 a[150:151], v3 offset:34816
  v_mfma_f32_16x16x32_bf16 v[236:239], a[156:159], a[228:231], v[236:239]
  v_cvt_pk_bf16_f32 v22, v88, v89
  v_cvt_pk_bf16_f32 v23, v90, v91
  v_mfma_f32_16x16x32_bf16 v[208:211], a[160:163], a[232:235], v[208:211]
  ds_read_b64_tr_b16 a[152:153], v4 offset:32768
  ds_read_b64_tr_b16 a[154:155], v4 offset:34816
  v_mfma_f32_16x16x32_bf16 v[212:215], a[160:163], a[236:239], v[212:215]
  ds_write_b128 v17, v[20:23] offset:2048
  v_fma_f32 v76, v19, v84, -v76
  v_mfma_f32_16x16x32_bf16 v[216:219], a[164:167], a[232:235], v[216:219]
  ds_read_b64_tr_b16 a[156:157], v5 offset:32768
  ds_read_b64_tr_b16 a[158:159], v5 offset:34816
  v_mfma_f32_16x16x32_bf16 v[220:223], a[164:167], a[236:239], v[220:223]
  v_fma_f32 v77, v19, v85, -v77
  v_fma_f32 v78, v19, v86, -v78
  s_waitcnt lgkmcnt(7)
  v_mfma_f32_16x16x32_bf16 v[224:227], a[168:171], a[232:235], v[224:227]
  v_fma_f32 v79, v19, v87, -v79
  v_mfma_f32_16x16x32_bf16 v[228:231], a[168:171], a[236:239], v[228:231]
  v_fma_f32 v80, v19, v88, -v80
  v_fma_f32 v81, v19, v89, -v81
  v_mfma_f32_16x16x32_bf16 v[232:235], a[172:175], a[232:235], v[232:235]
  v_fma_f32 v82, v19, v90, -v82
  v_fma_f32 v83, v19, v91, -v83
  v_mfma_f32_16x16x32_bf16 v[236:239], a[172:175], a[236:239], v[236:239]
  v_cvt_pk_bf16_f32 v20, v76, v77
  v_cvt_pk_bf16_f32 v21, v78, v79
  v_mfma_f32_16x16x32_bf16 v[208:211], a[144:147], a[240:243], v[208:211]
  s_add_u32 s7, s70, 4096
  buffer_store_dwordx4 v[184:187], v13, s[24:27], s7 offen offset:3072 sc1
  v_mfma_f32_16x16x32_bf16 v[212:215], a[144:147], a[244:247], v[212:215]
  v_fma_f32 v90, v19, v82, -v90
  v_cvt_pk_bf16_f32 v22, v80, v81
  v_cvt_pk_bf16_f32 v23, v82, v83
  v_fma_f32 v82, v19, v90, -v82
  v_fma_f32 v91, v19, v83, -v91
  v_fma_f32 v88, v19, v80, -v88
  v_fma_f32 v89, v19, v81, -v89
  v_fma_f32 v86, v19, v78, -v86
  v_fma_f32 v87, v19, v79, -v87
  v_fma_f32 v84, v19, v76, -v84
  v_fma_f32 v85, v19, v77, -v85
  ds_write_b128 v17, v[20:23] offset:4096
  s_nop 0
  s_nop 0
  v_cvt_pk_bf16_f32 v20, v84, v85
  v_cvt_pk_bf16_f32 v21, v86, v87
  v_cvt_pk_bf16_f32 v22, v88, v89
  v_cvt_pk_bf16_f32 v23, v90, v91
  v_fma_f32 v90, v19, v82, -v90
  v_fma_f32 v83, v19, v91, -v83
  v_fma_f32 v80, v19, v88, -v80
  v_fma_f32 v81, v19, v89, -v81
  v_fma_f32 v78, v19, v86, -v78
  v_fma_f32 v79, v19, v87, -v79
  v_fma_f32 v76, v19, v84, -v76
  v_fma_f32 v77, v19, v85, -v77
  ds_write_b128 v17, v[20:23] offset:6144
  s_nop 0
  s_nop 0
  v_cvt_pk_bf16_f32 v20, v76, v77
  v_cvt_pk_bf16_f32 v21, v78, v79
  v_cvt_pk_bf16_f32 v22, v80, v81
  v_cvt_pk_bf16_f32 v23, v82, v83
  v_fma_f32 v82, v19, v90, -v82
  v_fma_f32 v91, v19, v83, -v91
  v_fma_f32 v88, v19, v80, -v88
  v_fma_f32 v89, v19, v81, -v89
  v_fma_f32 v86, v19, v78, -v86
  v_fma_f32 v87, v19, v79, -v87
  v_fma_f32 v84, v19, v76, -v84
  v_fma_f32 v85, v19, v77, -v85
  ds_write_b128 v17, v[20:23] offset:8192
  s_nop 0
  s_nop 0
  v_cvt_pk_bf16_f32 v20, v84, v85
  v_cvt_pk_bf16_f32 v21, v86, v87
  v_cvt_pk_bf16_f32 v22, v88, v89
  v_cvt_pk_bf16_f32 v23, v90, v91
  v_fma_f32 v90, v19, v82, -v90
  v_fma_f32 v83, v19, v91, -v83
  v_fma_f32 v80, v19, v88, -v80
  v_fma_f32 v81, v19, v89, -v81
  v_fma_f32 v78, v19, v86, -v78
  v_fma_f32 v79, v19, v87, -v79
  v_fma_f32 v76, v19, v84, -v76
  v_fma_f32 v77, v19, v85, -v77
  ds_write_b128 v17, v[20:23] offset:10240
  s_nop 0
  s_nop 0
  v_cvt_pk_bf16_f32 v20, v76, v77
  v_cvt_pk_bf16_f32 v21, v78, v79
  v_cvt_pk_bf16_f32 v22, v80, v81
  v_cvt_pk_bf16_f32 v23, v82, v83
  v_fma_f32 v82, v19, v90, -v82
  v_fma_f32 v91, v19, v83, -v91
  v_fma_f32 v83, v19, v91, -v83
  v_fma_f32 v88, v19, v80, -v88
  v_fma_f32 v80, v19, v88, -v80
  v_fma_f32 v89, v19, v81, -v89
  v_fma_f32 v81, v19, v89, -v81
  v_fma_f32 v86, v19, v78, -v86
  v_fma_f32 v78, v19, v86, -v78
  v_fma_f32 v87, v19, v79, -v87
  v_fma_f32 v79, v19, v87, -v79
  v_fma_f32 v84, v19, v76, -v84
  v_fma_f32 v76, v19, v84, -v76
  v_fma_f32 v85, v19, v77, -v85
  v_fma_f32 v77, v19, v85, -v77
  ds_write_b128 v17, v[20:23] offset:12288
  s_nop 0
  s_nop 0
  v_cvt_pk_bf16_f32 v20, v84, v85
  v_cvt_pk_bf16_f32 v21, v86, v87
  v_cvt_pk_bf16_f32 v22, v88, v89
  v_cvt_pk_bf16_f32 v23, v90, v91
  ds_write_b128 v17, v[20:23] offset:14336
  s_nop 0
  s_nop 0
  v_cvt_pk_bf16_f32 v20, v76, v77
  v_cvt_pk_bf16_f32 v21, v78, v79
  v_cvt_pk_bf16_f32 v22, v80, v81
  v_cvt_pk_bf16_f32 v23, v82, v83
  ds_write_b128 v17, v[20:23] offset:16384
  s_waitcnt vmcnt(4) lgkmcnt(0)
  s_barrier
  v_mfma_f32_16x16x32_bf16 v[216:219], a[148:151], a[240:243], v[216:219]
  ds_read_b128 a[160:163], v18 offset:0
  ds_read_b128 a[164:167], v18 offset:1024
  v_mfma_f32_16x16x32_bf16 v[220:223], a[148:151], a[244:247], v[220:223]
  v_mfma_f32_16x16x32_bf16 v[224:227], a[152:155], a[240:243], v[224:227]
  ds_read_b128 a[168:171], v18 offset:2048
  ds_read_b128 a[172:175], v18 offset:3072
  v_mfma_f32_16x16x32_bf16 v[228:231], a[152:155], a[244:247], v[228:231]
  v_mfma_f32_16x16x32_bf16 v[232:235], a[156:159], a[240:243], v[232:235]
  ds_read_b128 a[144:147], v18 offset:4096
  ds_read_b128 a[148:151], v18 offset:5120
  v_mfma_f32_16x16x32_bf16 v[236:239], a[156:159], a[244:247], v[236:239]
  s_waitcnt lgkmcnt(3)
  v_mfma_f32_16x16x32_bf16 v[192:195], a[0:3], a[160:163], 0
  ds_read_b128 a[152:155], v18 offset:6144
  v_mfma_f32_16x16x32_bf16 v[196:199], a[4:7], a[160:163], 0
  v_mfma_f32_16x16x32_bf16 v[200:203], a[0:3], a[164:167], 0
  ds_read_b128 a[156:159], v18 offset:7168
  v_mfma_f32_16x16x32_bf16 v[204:207], a[4:7], a[164:167], 0
  v_mfma_f32_16x16x32_bf16 v[192:195], a[8:11], a[168:171], v[192:195]
  ds_read_b128 a[160:163], v18 offset:8192
  v_mfma_f32_16x16x32_bf16 v[196:199], a[12:15], a[168:171], v[196:199]
  s_waitcnt lgkmcnt(3)
  v_mfma_f32_16x16x32_bf16 v[200:203], a[8:11], a[172:175], v[200:203]
  ds_read_b128 a[164:167], v18 offset:9216
  v_mfma_f32_16x16x32_bf16 v[204:207], a[12:15], a[172:175], v[204:207]
  v_mfma_f32_16x16x32_bf16 v[192:195], a[16:19], a[144:147], v[192:195]
  ds_read_b128 a[168:171], v18 offset:10240
  v_cvt_pk_bf16_f32 v208, v208, v209
  v_mfma_f32_16x16x32_bf16 v[196:199], a[20:23], a[144:147], v[196:199]
  v_cvt_pk_bf16_f32 v209, v210, v211
  v_cvt_pk_bf16_f32 v210, v212, v213
  v_mfma_f32_16x16x32_bf16 v[200:203], a[16:19], a[148:151], v[200:203]
  ds_read_b128 a[172:175], v18 offset:11264
  v_cvt_pk_bf16_f32 v211, v214, v215
  v_mfma_f32_16x16x32_bf16 v[204:207], a[20:23], a[148:151], v[204:207]
  s_nop 1
  v_permlane32_swap_b32 v208, v210
  s_waitcnt lgkmcnt(3)
  v_mfma_f32_16x16x32_bf16 v[192:195], a[24:27], a[152:155], v[192:195]
  ds_read_b128 a[144:147], v18 offset:12288
  v_mfma_f32_16x16x32_bf16 v[196:199], a[28:31], a[152:155], v[196:199]
  v_permlane32_swap_b32 v209, v211
  v_cvt_pk_bf16_f32 v216, v216, v217
  v_mfma_f32_16x16x32_bf16 v[200:203], a[24:27], a[156:159], v[200:203]
  ds_read_b128 a[148:151], v18 offset:13312
  v_cvt_pk_bf16_f32 v217, v218, v219
  v_mfma_f32_16x16x32_bf16 v[204:207], a[28:31], a[156:159], v[204:207]
  v_cvt_pk_bf16_f32 v218, v220, v221
  v_cvt_pk_bf16_f32 v219, v222, v223
  s_nop 1
  v_permlane32_swap_b32 v216, v218
  v_permlane32_swap_b32 v217, v219
  v_mfma_f32_16x16x32_bf16 v[192:195], a[32:35], a[160:163], v[192:195]
  ds_read_b128 a[152:155], v18 offset:14336
  s_add_u32 s7, s70, 8192
  v_mfma_f32_16x16x32_bf16 v[196:199], a[36:39], a[160:163], v[196:199]
  buffer_store_dwordx4 v[208:211], v13, s[24:27], s7 offen offset:0 sc1
  v_cvt_pk_bf16_f32 v224, v224, v225
  s_waitcnt lgkmcnt(3)
  v_mfma_f32_16x16x32_bf16 v[200:203], a[32:35], a[164:167], v[200:203]
  ds_read_b128 a[156:159], v18 offset:15360
  v_mfma_f32_16x16x32_bf16 v[204:207], a[36:39], a[164:167], v[204:207]
  v_cvt_pk_bf16_f32 v225, v226, v227
  v_cvt_pk_bf16_f32 v226, v228, v229
  v_mfma_f32_16x16x32_bf16 v[192:195], a[40:43], a[168:171], v[192:195]
  ds_read_b128 a[160:163], v18 offset:16384
  v_cvt_pk_bf16_f32 v227, v230, v231
  v_mfma_f32_16x16x32_bf16 v[196:199], a[44:47], a[168:171], v[196:199]
  s_nop 1
  v_permlane32_swap_b32 v224, v226
  v_mfma_f32_16x16x32_bf16 v[200:203], a[40:43], a[172:175], v[200:203]
  ds_read_b128 a[164:167], v18 offset:17408
  v_permlane32_swap_b32 v225, v227
  v_mfma_f32_16x16x32_bf16 v[204:207], a[44:47], a[172:175], v[204:207]
  v_cvt_pk_bf16_f32 v232, v232, v233
  v_cvt_pk_bf16_f32 v233, v234, v235
  s_waitcnt lgkmcnt(3)
  v_mfma_f32_16x16x32_bf16 v[192:195], a[48:51], a[144:147], v[192:195]
  ds_read_b128 a[168:171], v18 offset:18432
  v_mfma_f32_16x16x32_bf16 v[196:199], a[52:55], a[144:147], v[196:199]
  v_cvt_pk_bf16_f32 v234, v236, v237
  v_cvt_pk_bf16_f32 v235, v238, v239
  v_mfma_f32_16x16x32_bf16 v[200:203], a[48:51], a[148:151], v[200:203]
  ds_read_b128 a[172:175], v18 offset:19456
  s_nop 1
  v_mfma_f32_16x16x32_bf16 v[204:207], a[52:55], a[148:151], v[204:207]
  v_permlane32_swap_b32 v232, v234
  v_permlane32_swap_b32 v233, v235
  v_mfma_f32_16x16x32_bf16 v[192:195], a[56:59], a[152:155], v[192:195]
  ds_read_b128 a[144:147], v18 offset:20480
  s_lshr_b32 s88, s48, 1
  v_mfma_f32_16x16x32_bf16 v[196:199], a[60:63], a[152:155], v[196:199]
  s_lshl_b32 s88, s88, 11
  s_add_u32 s88, s88, 147456
  s_waitcnt lgkmcnt(3)
  v_mfma_f32_16x16x32_bf16 v[200:203], a[56:59], a[156:159], v[200:203]
  ds_read_b128 a[148:151], v18 offset:21504
  s_add_u32 s7, s70, 8192
  v_mfma_f32_16x16x32_bf16 v[204:207], a[60:63], a[156:159], v[204:207]
  buffer_store_dwordx4 v[216:219], v13, s[24:27], s7 offen offset:1024 sc1
  v_add_u32 v73, s88, v1
  v_mfma_f32_16x16x32_bf16 v[192:195], a[64:67], a[160:163], v[192:195]
  ds_read_b128 a[152:155], v18 offset:22528
  s_and_b32 s88, s48, 1
  v_mfma_f32_16x16x32_bf16 v[196:199], a[68:71], a[160:163], v[196:199]
  s_lshl_b32 s89, s81, 1
  s_or_b32 s88, s88, s89
  v_mfma_f32_16x16x32_bf16 v[200:203], a[64:67], a[164:167], v[200:203]
  ds_read_b128 a[156:159], v18 offset:23552
  s_lshr_b32 s89, 12, s88
  v_mfma_f32_16x16x32_bf16 v[204:207], a[68:71], a[164:167], v[204:207]
  s_bitcmp1_b32 s89, 0
  s_cselect_b32 s90, 0xbf800000, 1.0
  s_waitcnt lgkmcnt(3)
  v_mfma_f32_16x16x32_bf16 v[192:195], a[72:75], a[168:171], v[192:195]
  ds_read_b128 a[160:163], v18 offset:24576
  v_mfma_f32_16x16x32_bf16 v[196:199], a[76:79], a[168:171], v[196:199]
  s_lshr_b32 s89, 10, s88
  v_mfma_f32_16x16x32_bf16 v[200:203], a[72:75], a[172:175], v[200:203]
  ds_read_b128 a[164:167], v18 offset:25600
  v_mfma_f32_16x16x32_bf16 v[204:207], a[76:79], a[172:175], v[204:207]
  s_bitcmp1_b32 s89, 0
  s_cselect_b32 s91, 0xbf800000, 1.0
  v_mfma_f32_16x16x32_bf16 v[192:195], a[80:83], a[144:147], v[192:195]
  ds_read_b128 a[168:171], v18 offset:26624
  s_lshr_b32 s89, 6, s88
  v_mfma_f32_16x16x32_bf16 v[196:199], a[84:87], a[144:147], v[196:199]
  s_bitcmp1_b32 s89, 0
  s_cselect_b32 s92, 0xbf800000, 1.0
  s_waitcnt lgkmcnt(3)
  v_mfma_f32_16x16x32_bf16 v[200:203], a[80:83], a[148:151], v[200:203]
  ds_read_b128 a[172:175], v18 offset:27648
  v_mfma_f32_16x16x32_bf16 v[204:207], a[84:87], a[148:151], v[204:207]
  s_lshr_b32 s89, 0, s88
  v_mfma_f32_16x16x32_bf16 v[192:195], a[88:91], a[152:155], v[192:195]
  ds_read_b128 a[144:147], v18 offset:28672
  s_add_u32 s7, s70, 8192
  v_mfma_f32_16x16x32_bf16 v[196:199], a[92:95], a[152:155], v[196:199]
  buffer_store_dwordx4 v[224:227], v13, s[24:27], s7 offen offset:2048 sc1
  v_mfma_f32_16x16x32_bf16 v[200:203], a[88:91], a[156:159], v[200:203]
  ds_read_b128 a[148:151], v18 offset:29696
  v_mfma_f32_16x16x32_bf16 v[204:207], a[92:95], a[156:159], v[204:207]
  s_bitcmp1_b32 s89, 0
  s_cselect_b32 s93, 0xbf800000, 1.0
  s_waitcnt lgkmcnt(3)
  v_mfma_f32_16x16x32_bf16 v[192:195], a[96:99], a[160:163], v[192:195]
  ds_read_b128 a[152:155], v18 offset:30720
  v_mfma_f32_16x16x32_bf16 v[196:199], a[100:103], a[160:163], v[196:199]
  s_cmp_eq_u32 s88, 0
  s_cselect_b32 s94, 1.0, 0
  s_cselect_b32 s95, 1.0, 0
  v_mfma_f32_16x16x32_bf16 v[200:203], a[96:99], a[164:167], v[200:203]
  ds_read_b128 a[156:159], v18 offset:31744
  s_cmp_eq_u32 s88, 3
  s_cselect_b32 s94, 0xbf800000, s94
  s_cselect_b32 s95, 1.0, s95
  v_mfma_f32_16x16x32_bf16 v[204:207], a[100:103], a[164:167], v[204:207]
  s_cmp_eq_u32 s49, 0
  s_cselect_b32 s88, 256, 0
  v_mfma_f32_16x16x32_bf16 v[192:195], a[104:107], a[168:171], v[192:195]
  ds_read_b128 a[160:163], v18 offset:32768
  v_cmp_gt_u32 vcc, s88, v1
  v_mov_b32 v74, 1.0
  s_nop 0
  v_cndmask_b32_e64 v74, v74, 0, vcc
  v_mfma_f32_16x16x32_bf16 v[196:199], a[108:111], a[168:171], v[196:199]
  s_and_b32 s88, s48, 1
  v_bfe_u32 v84, v1, 4, 4
  s_waitcnt lgkmcnt(3)
  v_mfma_f32_16x16x32_bf16 v[200:203], a[104:107], a[172:175], v[200:203]
  ds_read_b128 a[164:167], v18 offset:33792
  v_mfma_f32_16x16x32_bf16 v[204:207], a[108:111], a[172:175], v[204:207]
  s_lshr_b32 s89, s48, 1
  s_lshl_b32 s89, s89, 4
  v_mfma_f32_16x16x32_bf16 v[192:195], a[112:115], a[144:147], v[192:195]
  ds_read_b128 a[168:171], v18 offset:34816
  v_add_u32 v84, s89, v84
  v_mfma_f32_16x16x32_bf16 v[196:199], a[116:119], a[144:147], v[196:199]
  s_cmp_eq_u32 s83, 1
  s_cselect_b32 s89, 0, -1
  v_mfma_f32_16x16x32_bf16 v[200:203], a[112:115], a[148:151], v[200:203]
  ds_read_b128 a[172:175], v18 offset:35840
  s_add_u32 s7, s70, 8192
  v_mfma_f32_16x16x32_bf16 v[204:207], a[116:119], a[148:151], v[204:207]
  buffer_store_dwordx4 v[232:235], v13, s[24:27], s7 offen offset:3072 sc1
  v_cmp_eq_u32 vcc, s89, v84
  s_waitcnt lgkmcnt(3)
  v_mfma_f32_16x16x32_bf16 v[192:195], a[120:123], a[152:155], v[192:195]
  s_mov_b32 s89, 1.0
  v_mfma_f32_16x16x32_bf16 v[196:199], a[124:127], a[152:155], v[196:199]
  v_mov_b32 v76, s90
  v_mov_b32 v85, s89
  v_mfma_f32_16x16x32_bf16 v[200:203], a[120:123], a[156:159], v[200:203]
  v_cndmask_b32 v76, v76, v85, vcc
  v_mfma_f32_16x16x32_bf16 v[204:207], a[124:127], a[156:159], v[204:207]
  s_cmp_eq_u32 s88, 1
  s_cselect_b32 s89, 0xbf800000, 1.0
  v_mfma_f32_16x16x32_bf16 v[192:195], a[128:131], a[160:163], v[192:195]
  v_mfma_f32_16x16x32_bf16 v[196:199], a[132:135], a[160:163], v[196:199]
  s_waitcnt lgkmcnt(0)
  v_add_u32 v2, 110592, v8
  v_xor_b32 v3, 32, v2
  v_xor_b32 v4, 64, v2
  v_xor_b32 v5, 0x60, v2
  v_mfma_f32_16x16x32_bf16 v[200:203], a[128:131], a[164:167], v[200:203]
  ds_read_b64_tr_b16 a[144:145], v2 offset:0
  ds_read_b64_tr_b16 a[146:147], v2 offset:2048
  v_mfma_f32_16x16x32_bf16 v[204:207], a[132:135], a[164:167], v[204:207]
  ds_read_b64_tr_b16 a[148:149], v3 offset:0
  ds_read_b64_tr_b16 a[150:151], v3 offset:2048
  v_mfma_f32_16x16x32_bf16 v[192:195], a[136:139], a[168:171], v[192:195]
  ds_read_b64_tr_b16 a[152:153], v4 offset:0
  ds_read_b64_tr_b16 a[154:155], v4 offset:2048
  v_mfma_f32_16x16x32_bf16 v[196:199], a[140:143], a[168:171], v[196:199]
  ds_read_b64_tr_b16 a[156:157], v5 offset:0
  ds_read_b64_tr_b16 a[158:159], v5 offset:2048
  v_mfma_f32_16x16x32_bf16 v[200:203], a[136:139], a[172:175], v[200:203]
  ds_read_b64_tr_b16 a[160:161], v2 offset:4096
  ds_read_b64_tr_b16 a[162:163], v2 offset:6144
  v_mfma_f32_16x16x32_bf16 v[204:207], a[140:143], a[172:175], v[204:207]
  ds_read_b64_tr_b16 a[164:165], v3 offset:4096
  ds_read_b64_tr_b16 a[166:167], v3 offset:6144
  v_mov_b32 v77, s91
  v_mov_b32 v85, s89
  v_cndmask_b32 v77, v77, v85, vcc
  s_cmp_eq_u32 s88, 1
  s_cselect_b32 s89, 0xbf800000, 1.0
  v_mov_b32 v78, s92
  v_mov_b32 v85, s89
  v_cndmask_b32 v78, v78, v85, vcc
  s_mov_b32 s89, 1.0
  v_mov_b32 v79, s93
  v_mov_b32 v85, s89
  v_cndmask_b32 v79, v79, v85, vcc
  s_cmp_eq_u32 s88, 0
  s_cselect_b32 s89, 1.0, 0
  v_mov_b32 v85, s89
  v_mov_b32 v80, s94
  v_mov_b32 v81, s95
  v_cndmask_b32 v80, v80, v85, vcc
  v_cndmask_b32 v81, v81, v85, vcc
  v_mov_b32 v86, 0
  v_mov_b32 v87, -1
  v_cndmask_b32 v86, v86, v87, vcc
  s_nop 0
  s_lshl_b32 s88, s48, 12
  s_add_u32 s88, s88, 147456
  v_add_u32 v21, s88, v1
  s_nop 7
  ds_write_b128 v21, v[192:195] offset:0
  ds_write_b128 v21, v[196:199] offset:1024
  ds_write_b128 v21, v[200:203] offset:2048
  ds_write_b128 v21, v[204:207] offset:3072
  s_waitcnt lgkmcnt(10)
  v_mfma_f32_16x16x32_bf16 v[96:99], a[144:147], a[176:179], v[96:99]
  ds_read_b64_tr_b16 a[168:169], v4 offset:4096
  ds_read_b64_tr_b16 a[170:171], v4 offset:6144
  v_mfma_f32_16x16x32_bf16 v[100:103], a[144:147], a[180:183], v[100:103]
  v_mfma_f32_16x16x32_bf16 v[104:107], a[148:151], a[176:179], v[104:107]
  ds_read_b64_tr_b16 a[172:173], v5 offset:4096
  ds_read_b64_tr_b16 a[174:175], v5 offset:6144
  v_mfma_f32_16x16x32_bf16 v[108:111], a[148:151], a[180:183], v[108:111]
  v_mfma_f32_16x16x32_bf16 v[112:115], a[152:155], a[176:179], v[112:115]
  ds_read_b64_tr_b16 a[144:145], v2 offset:8192
  ds_read_b64_tr_b16 a[146:147], v2 offset:10240
  v_mfma_f32_16x16x32_bf16 v[116:119], a[152:155], a[180:183], v[116:119]
  s_waitcnt lgkmcnt(10)
  v_mfma_f32_16x16x32_bf16 v[120:123], a[156:159], a[176:179], v[120:123]
  ds_read_b64_tr_b16 a[148:149], v3 offset:8192
  ds_read_b64_tr_b16 a[150:151], v3 offset:10240
  v_mfma_f32_16x16x32_bf16 v[124:127], a[156:159], a[180:183], v[124:127]
  s_waitcnt lgkmcnt(8)
  s_barrier
  v_mfma_f32_16x16x32_bf16 v[96:99], a[160:163], a[184:187], v[96:99]
  ds_read_b64_tr_b16 a[152:153], v4 offset:8192
  ds_read_b64_tr_b16 a[154:155], v4 offset:10240
  v_mfma_f32_16x16x32_bf16 v[100:103], a[160:163], a[188:191], v[100:103]
  ds_read_b128 v[24:27], v73 offset:0
  v_mfma_f32_16x16x32_bf16 v[104:107], a[164:167], a[184:187], v[104:107]
  ds_read_b64_tr_b16 a[156:157], v5 offset:8192
  ds_read_b64_tr_b16 a[158:159], v5 offset:10240
  v_mfma_f32_16x16x32_bf16 v[108:111], a[164:167], a[188:191], v[108:111]
  ds_read_b128 v[28:31], v73 offset:1024
  s_waitcnt lgkmcnt(8)
  v_mfma_f32_16x16x32_bf16 v[112:115], a[168:171], a[184:187], v[112:115]
  ds_read_b64_tr_b16 a[160:161], v2 offset:12288
  ds_read_b64_tr_b16 a[162:163], v2 offset:14336
  v_mfma_f32_16x16x32_bf16 v[116:119], a[168:171], a[188:191], v[116:119]
  ds_read_b128 v[32:35], v73 offset:4096
  v_mfma_f32_16x16x32_bf16 v[120:123], a[172:175], a[184:187], v[120:123]
  ds_read_b64_tr_b16 a[164:165], v3 offset:12288
  ds_read_b64_tr_b16 a[166:167], v3 offset:14336
  v_mfma_f32_16x16x32_bf16 v[124:127], a[172:175], a[188:191], v[124:127]
  ds_read_b128 v[36:39], v73 offset:5120
  v_mfma_f32_16x16x32_bf16 v[96:99], a[144:147], a[192:195], v[96:99]
  ds_read_b64_tr_b16 a[168:169], v4 offset:12288
  ds_read_b64_tr_b16 a[170:171], v4 offset:14336
  v_mfma_f32_16x16x32_bf16 v[100:103], a[144:147], a[196:199], v[100:103]
  ds_read_b128 v[40:43], v73 offset:8192
  s_waitcnt lgkmcnt(10)
  v_mfma_f32_16x16x32_bf16 v[104:107], a[148:151], a[192:195], v[104:107]
  ds_read_b64_tr_b16 a[172:173], v5 offset:12288
  ds_read_b64_tr_b16 a[174:175], v5 offset:14336
  v_mfma_f32_16x16x32_bf16 v[108:111], a[148:151], a[196:199], v[108:111]
  ds_read_b128 v[44:47], v73 offset:9216
  v_mfma_f32_16x16x32_bf16 v[112:115], a[152:155], a[192:195], v[112:115]
  ds_read_b64_tr_b16 a[144:145], v2 offset:16384
  ds_read_b64_tr_b16 a[146:147], v2 offset:18432
  v_mfma_f32_16x16x32_bf16 v[116:119], a[152:155], a[196:199], v[116:119]
  ds_read_b128 v[48:51], v73 offset:12288
  v_mfma_f32_16x16x32_bf16 v[120:123], a[156:159], a[192:195], v[120:123]
  ds_read_b64_tr_b16 a[148:149], v3 offset:16384
  ds_read_b64_tr_b16 a[150:151], v3 offset:18432
  v_mfma_f32_16x16x32_bf16 v[124:127], a[156:159], a[196:199], v[124:127]
  ds_read_b128 v[52:55], v73 offset:13312
  s_waitcnt lgkmcnt(10)
  v_mfma_f32_16x16x32_bf16 v[96:99], a[160:163], a[200:203], v[96:99]
  ds_read_b64_tr_b16 a[152:153], v4 offset:16384
  ds_read_b64_tr_b16 a[154:155], v4 offset:18432
  v_mfma_f32_16x16x32_bf16 v[100:103], a[160:163], a[204:207], v[100:103]
  s_and_b32 s88, s48, 1
  s_lshl_b32 s88, s88, 1
  v_mfma_f32_16x16x32_bf16 v[104:107], a[164:167], a[200:203], v[104:107]
  ds_read_b64_tr_b16 a[156:157], v5 offset:16384
  ds_read_b64_tr_b16 a[158:159], v5 offset:18432
  v_mfma_f32_16x16x32_bf16 v[108:111], a[164:167], a[204:207], v[108:111]
  s_add_u32 s88, s88, s81
  s_mul_i32 s86, s88, 608256
  v_mfma_f32_16x16x32_bf16 v[112:115], a[168:171], a[200:203], v[112:115]
  ds_read_b64_tr_b16 a[160:161], v2 offset:20480
  ds_read_b64_tr_b16 a[162:163], v2 offset:22528
  v_mfma_f32_16x16x32_bf16 v[116:119], a[168:171], a[204:207], v[116:119]
  s_lshl_b32 s88, s49, 11
  s_add_u32 s86, s86, s88
  s_waitcnt lgkmcnt(6)
  s_waitcnt lgkmcnt(7)
  v_mfma_f32_16x16x32_bf16 v[120:123], a[172:175], a[200:203], v[120:123]
  ds_read_b64_tr_b16 a[164:165], v3 offset:20480
  ds_read_b64_tr_b16 a[166:167], v3 offset:22528
  v_mfma_f32_16x16x32_bf16 v[124:127], a[172:175], a[204:207], v[124:127]
  s_add_u32 s86, s86, 67108864
  v_bfe_u32 v68, v1, 4, 4
  v_mfma_f32_16x16x32_bf16 v[96:99], a[144:147], a[208:211], v[96:99]
  ds_read_b64_tr_b16 a[168:169], v4 offset:20480
  ds_read_b64_tr_b16 a[170:171], v4 offset:22528
  v_mfma_f32_16x16x32_bf16 v[100:103], a[144:147], a[212:215], v[100:103]
  s_lshr_b32 s88, s48, 1
  s_lshl_b32 s88, s88, 4
  v_mfma_f32_16x16x32_bf16 v[104:107], a[148:151], a[208:211], v[104:107]
  ds_read_b64_tr_b16 a[172:173], v5 offset:20480
  ds_read_b64_tr_b16 a[174:175], v5 offset:22528
  v_mfma_f32_16x16x32_bf16 v[108:111], a[148:151], a[212:215], v[108:111]
  v_add_u32 v68, s88, v68
  v_bfe_u32 v71, v1, 8, 1
  s_waitcnt lgkmcnt(6)
  v_mfma_f32_16x16x32_bf16 v[112:115], a[152:155], a[208:211], v[112:115]
  ds_read_b64_tr_b16 a[144:145], v2 offset:24576
  ds_read_b64_tr_b16 a[146:147], v2 offset:26624
  v_mfma_f32_16x16x32_bf16 v[116:119], a[152:155], a[212:215], v[116:119]
  v_lshlrev_b32 v71, 10, v71
  v_and_b32 v70, 512, v1
  v_mfma_f32_16x16x32_bf16 v[120:123], a[156:159], a[208:211], v[120:123]
  ds_read_b64_tr_b16 a[148:149], v3 offset:24576
  ds_read_b64_tr_b16 a[150:151], v3 offset:26624
  v_mfma_f32_16x16x32_bf16 v[124:127], a[156:159], a[212:215], v[124:127]
  v_add_u32 v71, v71, v70
  s_mul_i32 s88, s82, 33792
  v_mfma_f32_16x16x32_bf16 v[96:99], a[160:163], a[216:219], v[96:99]
  ds_read_b64_tr_b16 a[152:153], v4 offset:24576
  ds_read_b64_tr_b16 a[154:155], v4 offset:26624
  v_mfma_f32_16x16x32_bf16 v[100:103], a[160:163], a[220:223], v[100:103]
  v_lshl_add_u32 v72, v68, 4, v71
  v_add_u32 v72, s88, v72
  s_waitcnt lgkmcnt(6)
  v_mfma_f32_16x16x32_bf16 v[104:107], a[164:167], a[216:219], v[104:107]
  ds_read_b64_tr_b16 a[156:157], v5 offset:24576
  ds_read_b64_tr_b16 a[158:159], v5 offset:26624
  v_mfma_f32_16x16x32_bf16 v[108:111], a[164:167], a[220:223], v[108:111]
  s_lshl_b32 s88, s82, 5
  v_add_u32 v68, s88, v68
  v_mfma_f32_16x16x32_bf16 v[112:115], a[168:171], a[216:219], v[112:115]
  ds_read_b64_tr_b16 a[160:161], v2 offset:28672
  ds_read_b64_tr_b16 a[162:163], v2 offset:30720
  v_mfma_f32_16x16x32_bf16 v[116:119], a[168:171], a[220:223], v[116:119]
  v_sub_u32 v69, 576, v68
  v_lshrrev_b32 v70, 5, v69
  v_mfma_f32_16x16x32_bf16 v[120:123], a[172:175], a[216:219], v[120:123]
  ds_read_b64_tr_b16 a[164:165], v3 offset:28672
  ds_read_b64_tr_b16 a[166:167], v3 offset:30720
  v_mfma_f32_16x16x32_bf16 v[124:127], a[172:175], a[220:223], v[124:127]
  v_mul_u32_u24 v70, 33792, v70
  v_and_b32 v69, 31, v69
  s_waitcnt lgkmcnt(6)
  v_mfma_f32_16x16x32_bf16 v[96:99], a[144:147], a[224:227], v[96:99]
  ds_read_b64_tr_b16 a[168:169], v4 offset:28672
  ds_read_b64_tr_b16 a[170:171], v4 offset:30720
  v_mfma_f32_16x16x32_bf16 v[100:103], a[144:147], a[228:231], v[100:103]
  v_lshlrev_b32 v69, 4, v69
  v_add3_u32 v73, v69, v70, v71
  v_mfma_f32_16x16x32_bf16 v[104:107], a[148:151], a[224:227], v[104:107]
  ds_read_b64_tr_b16 a[172:173], v5 offset:28672
  ds_read_b64_tr_b16 a[174:175], v5 offset:30720
  v_mfma_f32_16x16x32_bf16 v[108:111], a[148:151], a[228:231], v[108:111]
  v_cmp_eq_u32 vcc, 0, v68
  v_mov_b32 v69, 0x7ff00000
  s_nop 0
  v_cndmask_b32 v73, v73, v69, vcc
  v_mul_f32 v75, v78, v40
  v_mfma_f32_16x16x32_bf16 v[112:115], a[152:155], a[224:227], v[112:115]
  ds_read_b64_tr_b16 a[144:145], v2 offset:32768
  ds_read_b64_tr_b16 a[146:147], v2 offset:34816
  v_mfma_f32_16x16x32_bf16 v[116:119], a[152:155], a[228:231], v[116:119]
  s_cmp_eq_u32 s81, 1
  s_cselect_b32 s87, 0x80008000, 0
  s_waitcnt lgkmcnt(6)
  v_mfma_f32_16x16x32_bf16 v[120:123], a[156:159], a[224:227], v[120:123]
  ds_read_b64_tr_b16 a[148:149], v3 offset:32768
  ds_read_b64_tr_b16 a[150:151], v3 offset:34816
  v_mfma_f32_16x16x32_bf16 v[124:127], a[156:159], a[228:231], v[124:127]
  s_cmp_eq_u32 s83, 2
  s_cselect_b32 s86, 0x70000000, s86
  v_mfma_f32_16x16x32_bf16 v[96:99], a[160:163], a[232:235], v[96:99]
  ds_read_b64_tr_b16 a[152:153], v4 offset:32768
  ds_read_b64_tr_b16 a[154:155], v4 offset:34816
  v_mfma_f32_16x16x32_bf16 v[100:103], a[160:163], a[236:239], v[100:103]
  v_bfe_u32 v88, v1, 8, 1
  v_lshlrev_b32 v88, 10, v88
  v_mfma_f32_16x16x32_bf16 v[104:107], a[164:167], a[232:235], v[104:107]
  ds_read_b64_tr_b16 a[156:157], v5 offset:32768
  ds_read_b64_tr_b16 a[158:159], v5 offset:34816
  v_mfma_f32_16x16x32_bf16 v[108:111], a[164:167], a[236:239], v[108:111]
  v_and_b32 v89, 512, v1
  v_add3_u32 v88, v88, v89, v89
  s_waitcnt lgkmcnt(6)
  v_mfma_f32_16x16x32_bf16 v[112:115], a[168:171], a[232:235], v[112:115]
  v_sub_u32 v88, v88, v89
  v_mfma_f32_16x16x32_bf16 v[116:119], a[168:171], a[236:239], v[116:119]
  v_add_u32 v88, 304128, v88
  v_mov_b32 v89, 0x7ff00000
  v_mfma_f32_16x16x32_bf16 v[120:123], a[172:175], a[232:235], v[120:123]
  v_cmp_eq_u32 vcc, -1, v86
  s_nop 1
  v_mfma_f32_16x16x32_bf16 v[124:127], a[172:175], a[236:239], v[124:127]
  v_cndmask_b32 v88, v89, v88, vcc
  s_sub_u32 s89, s86, 608256
  v_mfma_f32_16x16x32_bf16 v[96:99], a[144:147], a[240:243], v[96:99]
  v_mfma_f32_16x16x32_bf16 v[100:103], a[144:147], a[244:247], v[100:103]
  v_fma_f32 v75, v79, v48, v75
  v_mul_f32 v75, v74, v75
  v_fma_f32 v56, v76, v24, v75
  v_fma_f32 v56, v77, v32, v56
  v_mul_f32 v57, v76, v25
  v_fma_f32 v57, v77, v33, v57
  v_fma_f32 v57, v78, v41, v57
  v_fma_f32 v57, v79, v49, v57
  v_mul_f32 v58, v76, v26
  v_fma_f32 v58, v77, v34, v58
  v_fma_f32 v58, v78, v42, v58
  v_fma_f32 v58, v79, v50, v58
  v_mul_f32 v59, v76, v27
  v_fma_f32 v59, v77, v35, v59
  v_fma_f32 v59, v78, v43, v59
  v_fma_f32 v59, v79, v51, v59
  v_mul_f32 v60, v76, v28
  v_fma_f32 v60, v77, v36, v60
  v_fma_f32 v60, v78, v44, v60
  v_fma_f32 v60, v79, v52, v60
  v_mul_f32 v61, v76, v29
  v_fma_f32 v61, v77, v37, v61
  v_fma_f32 v61, v78, v45, v61
  v_fma_f32 v61, v79, v53, v61
  v_mul_f32 v62, v76, v30
  v_fma_f32 v62, v77, v38, v62
  v_fma_f32 v62, v78, v46, v62
  v_fma_f32 v62, v79, v54, v62
  v_mul_f32 v63, v76, v31
  v_fma_f32 v63, v77, v39, v63
  v_fma_f32 v63, v78, v47, v63
  v_fma_f32 v63, v79, v55, v63
  v_cvt_pk_bf16_f32 v64, v56, v57
  v_cvt_pk_bf16_f32 v65, v58, v59
  v_cvt_pk_bf16_f32 v66, v60, v61
  v_cvt_pk_bf16_f32 v67, v62, v63
  s_nop 1
  v_permlane16_swap_b32 v64, v66
  v_permlane16_swap_b32 v65, v67
  s_nop 0
  v_cmp_eq_u32 vcc, -1, v86
  buffer_store_dwordx4 v[64:67], v88, s[24:27], s89 offen sc1
  s_nop 0
  v_cndmask_b32_e64 v56, v64, 0, vcc
  v_cndmask_b32_e64 v57, v65, 0, vcc
  v_cndmask_b32_e64 v58, v66, 0, vcc
  v_cndmask_b32_e64 v59, v67, 0, vcc
  v_mov_b32 v60, 0
  v_mov_b32 v61, 0
  v_mov_b32 v62, 0
  v_mov_b32 v63, 0
  buffer_store_dwordx4 v[56:59], v72, s[24:27], s86 offen sc1
  buffer_store_dwordx4 v[60:63], v88, s[24:27], s86 offen sc1
  v_xor_b32 v68, s87, v64
  v_xor_b32 v69, s87, v65
  v_xor_b32 v70, s87, v66
  v_xor_b32 v71, s87, v67
  buffer_store_dwordx4 v[68:71], v73, s[24:27], s86 offen sc1
  s_cmp_eq_u32 s49, 0
  s_cbranch_scc0 K1_a512
  v_mul_f32 v56, v80, v40
  v_fma_f32 v56, v81, v48, v56
  v_cmp_gt_u32 vcc, 256, v1
  v_mov_b32 v57, 0
  v_mov_b32 v58, 0x7ff00000
  v_cndmask_b32 v56, v57, v56, vcc
  v_cvt_pk_bf16_f32 v60, v56, v57
  v_mov_b32 v61, 0
  v_mov_b32 v62, 0
  v_mov_b32 v63, 0
  v_and_b32 v59, 256, v1
  v_cmp_eq_u32 vcc, 0, v59
  s_add_u32 s88, s86, 32768
  s_add_u32 s89, s89, 32768
  v_cndmask_b32 v72, v58, v72, vcc
  v_cndmask_b32 v73, v58, v73, vcc
  v_cndmask_b32 v88, v58, v88, vcc
  v_cmp_eq_u32 vcc, -1, v86
  s_nop 1
  v_cndmask_b32_e64 v68, v60, 0, vcc
  v_mov_b32 v69, 0
  v_mov_b32 v70, 0
  v_mov_b32 v71, 0
  buffer_store_dwordx4 v[60:63], v88, s[24:27], s89 offen sc1
  buffer_store_dwordx4 v[68:71], v72, s[24:27], s88 offen sc1
  v_mov_b32 v24, 0
  v_mov_b32 v25, 0
  v_mov_b32 v26, 0
  v_mov_b32 v27, 0
  buffer_store_dwordx4 v[24:27], v88, s[24:27], s88 offen sc1
  s_nop 1
  v_xor_b32 v60, s87, v60
  s_nop 0
  buffer_store_dwordx4 v[60:63], v73, s[24:27], s88 offen sc1
K1_a512:
  s_waitcnt lgkmcnt(0)
  v_mfma_f32_16x16x32_bf16 v[104:107], a[148:151], a[240:243], v[104:107]
  v_mfma_f32_16x16x32_bf16 v[108:111], a[148:151], a[244:247], v[108:111]
  v_mfma_f32_16x16x32_bf16 v[112:115], a[152:155], a[240:243], v[112:115]
  v_mfma_f32_16x16x32_bf16 v[116:119], a[152:155], a[244:247], v[116:119]
  v_mfma_f32_16x16x32_bf16 v[120:123], a[156:159], a[240:243], v[120:123]
  v_mfma_f32_16x16x32_bf16 v[124:127], a[156:159], a[244:247], v[124:127]
  s_nop 7
  s_nop 7
  v_cvt_pk_bf16_f32 v96, v96, v97
  v_cvt_pk_bf16_f32 v97, v98, v99
  v_cvt_pk_bf16_f32 v98, v100, v101
  v_cvt_pk_bf16_f32 v99, v102, v103
  s_nop 1
  v_permlane32_swap_b32 v96, v98
  v_permlane32_swap_b32 v97, v99
  v_cvt_pk_bf16_f32 v104, v104, v105
  v_cvt_pk_bf16_f32 v105, v106, v107
  v_cvt_pk_bf16_f32 v106, v108, v109
  v_cvt_pk_bf16_f32 v107, v110, v111
  s_nop 1
  v_permlane32_swap_b32 v104, v106
  v_permlane32_swap_b32 v105, v107
  s_add_u32 s7, s70, 12288
  buffer_store_dwordx4 v[96:99], v13, s[24:27], s7 offen offset:0 sc1
  s_add_u32 s7, s70, 12288
  buffer_store_dwordx4 v[104:107], v13, s[24:27], s7 offen offset:1024 sc1
  v_cvt_pk_bf16_f32 v112, v112, v113
  v_cvt_pk_bf16_f32 v113, v114, v115
  v_cvt_pk_bf16_f32 v114, v116, v117
  v_cvt_pk_bf16_f32 v115, v118, v119
  s_nop 1
  v_permlane32_swap_b32 v112, v114
  v_permlane32_swap_b32 v113, v115
  v_cvt_pk_bf16_f32 v120, v120, v121
  v_cvt_pk_bf16_f32 v121, v122, v123
  v_cvt_pk_bf16_f32 v122, v124, v125
  v_cvt_pk_bf16_f32 v123, v126, v127
  s_nop 1
  v_permlane32_swap_b32 v120, v122
  v_permlane32_swap_b32 v121, v123
  s_add_u32 s7, s70, 12288
  buffer_store_dwordx4 v[112:115], v13, s[24:27], s7 offen offset:2048 sc1
  s_add_u32 s7, s70, 12288
  buffer_store_dwordx4 v[120:123], v13, s[24:27], s7 offen offset:3072 sc1
  s_cmp_eq_u32 s83, 2
  s_cbranch_scc0 K1_fin
  v_bfe_u32 v18, v1, 4, 5
  v_lshrrev_b32 v19, 4, v18
  v_lshlrev_b32 v19, 10, v19
  v_bfe_u32 v20, v18, 2, 2
  v_lshl_add_u32 v19, v20, 8, v19
  v_and_b32 v20, 3, v18
  v_lshl_add_u32 v19, v20, 2, v19
  s_lshl_b32 s88, s48, 12
  s_add_u32 s88, s88, 147456
  v_add_u32 v19, s88, v19
  s_waitcnt lgkmcnt(0)
  ds_read_b32 v22, v19
  s_lshl_b32 s84, s49, 5
  v_add_u32 v16, s84, v18
  s_cmp_eq_u32 s48, 0
  s_cselect_b32 s84, 0, 1024
  s_cmp_eq_u32 s48, 3
  s_cselect_b32 s84, 2048, s84
  s_and_b32 s85, s48, 1
  v_sub_u32 v17, s84, v16
  v_add_u32 v19, s84, v16
  s_cmp_eq_u32 s85, 1
  s_cselect_b64 vcc, -1, 0
  s_lshl_b32 s86, s48, 10
  s_sub_u32 s86, s86, 1536
  v_cndmask_b32 v19, v19, v17, vcc
  v_mov_b32 v17, s86
  s_cmp_ge_u32 s48, 2
  s_cselect_b32 s85, 0, -1
  v_cmp_eq_u32 vcc, s85, v16
  s_nop 1
  v_cndmask_b32 v19, v19, v17, vcc
  v_lshlrev_b32 v19, 2, v19
  v_mov_b32 v20, 0x7ff00000
  v_cmp_gt_u32 vcc, 512, v1
  s_waitcnt lgkmcnt(0)
  v_mul_f32 v21, 0xbfb8aa3b, v22
  v_exp_f32 v21, v21
  v_cndmask_b32 v19, v20, v19, vcc
  v_add_f32 v21, 1.0, v21
  v_rcp_f32 v21, v21
  s_mov_b32 s88, 75497472
  s_nop 0
  buffer_store_dword v21, v19, s[24:27], s88 offen sc1
  s_branch K1_fin
K1_tailN:
  s_waitcnt lgkmcnt(6)
  v_mfma_f32_16x16x32_bf16 v[160:163], a[160:163], a[176:179], v[160:163]
  ds_read_b64_tr_b16 a[152:153], v4 offset:4096
  ds_read_b64_tr_b16 a[154:155], v4 offset:6144
  v_mfma_f32_16x16x32_bf16 v[164:167], a[160:163], a[180:183], v[164:167]
  v_add3_u32 v73, v69, v70, v71
  v_cmp_eq_u32 vcc, 0, v68
  v_mov_b32 v69, 0x7ff00000
  s_nop 0
  v_cndmask_b32 v73, v73, v69, vcc
  v_mfma_f32_16x16x32_bf16 v[168:171], a[164:167], a[176:179], v[168:171]
  ds_read_b64_tr_b16 a[156:157], v5 offset:4096
  ds_read_b64_tr_b16 a[158:159], v5 offset:6144
  v_mfma_f32_16x16x32_bf16 v[172:175], a[164:167], a[180:183], v[172:175]
  s_cmp_eq_u32 s81, 1
  s_cselect_b32 s87, 0x80008000, 0
  v_mul_f32 v75, s92, v40
  v_fma_f32 v75, s93, v48, v75
  v_mul_f32 v75, v74, v75
  v_fma_f32 v56, s90, v24, v75
  v_fma_f32 v56, s91, v32, v56
  v_mul_f32 v57, s90, v25
  v_fma_f32 v57, s91, v33, v57
  v_fma_f32 v57, s92, v41, v57
  v_fma_f32 v57, s93, v49, v57
  v_mul_f32 v58, s90, v26
  v_fma_f32 v58, s91, v34, v58
  v_fma_f32 v58, s92, v42, v58
  v_fma_f32 v58, s93, v50, v58
  v_mul_f32 v59, s90, v27
  v_fma_f32 v59, s91, v35, v59
  v_fma_f32 v59, s92, v43, v59
  v_fma_f32 v59, s93, v51, v59
  v_mul_f32 v60, s90, v28
  v_fma_f32 v60, s91, v36, v60
  v_fma_f32 v60, s92, v44, v60
  v_fma_f32 v60, s93, v52, v60
  v_mul_f32 v61, s90, v29
  v_fma_f32 v61, s91, v37, v61
  v_fma_f32 v61, s92, v45, v61
  v_fma_f32 v61, s93, v53, v61
  v_mul_f32 v62, s90, v30
  v_fma_f32 v62, s91, v38, v62
  v_fma_f32 v62, s92, v46, v62
  v_fma_f32 v62, s93, v54, v62
  v_mul_f32 v63, s90, v31
  v_fma_f32 v63, s91, v39, v63
  v_fma_f32 v63, s92, v47, v63
  v_fma_f32 v63, s93, v55, v63
  v_cvt_pk_bf16_f32 v64, v56, v57
  v_cvt_pk_bf16_f32 v65, v58, v59
  v_cvt_pk_bf16_f32 v66, v60, v61
  v_cvt_pk_bf16_f32 v67, v62, v63
  s_nop 1
  v_permlane16_swap_b32 v64, v66
  v_permlane16_swap_b32 v65, v67
  s_nop 0
  buffer_store_dwordx4 v[64:67], v72, s[24:27], s86 offen sc1
  v_xor_b32 v68, s87, v64
  v_xor_b32 v69, s87, v65
  v_xor_b32 v70, s87, v66
  v_xor_b32 v71, s87, v67
  buffer_store_dwordx4 v[68:71], v73, s[24:27], s86 offen sc1
  s_cmp_eq_u32 s49, 0
  s_cbranch_scc0 K1_noz512_2
  v_mul_f32 v56, s94, v40
  v_fma_f32 v56, s95, v48, v56
  v_cmp_gt_u32 vcc, 256, v1
  v_mov_b32 v57, 0
  v_mov_b32 v58, 0x7ff00000
  v_cndmask_b32 v56, v57, v56, vcc
  v_cvt_pk_bf16_f32 v60, v56, v57
  v_mov_b32 v61, 0
  v_mov_b32 v62, 0
  v_mov_b32 v63, 0
  v_and_b32 v59, 256, v1
  v_cmp_eq_u32 vcc, 0, v59
  s_add_u32 s88, s86, 32768
  s_nop 0
  v_cndmask_b32 v72, v58, v72, vcc
  v_cndmask_b32 v73, v58, v73, vcc
  buffer_store_dwordx4 v[60:63], v72, s[24:27], s88 offen sc1
  s_nop 1
  v_xor_b32 v60, s87, v60
  s_nop 0
  buffer_store_dwordx4 v[60:63], v73, s[24:27], s88 offen sc1
K1_noz512_2:
  v_mfma_f32_16x16x32_bf16 v[176:179], a[168:171], a[176:179], v[176:179]
  ds_read_b64_tr_b16 a[160:161], v2 offset:8192
  ds_read_b64_tr_b16 a[162:163], v2 offset:10240
  v_mfma_f32_16x16x32_bf16 v[180:183], a[168:171], a[180:183], v[180:183]
  s_waitcnt lgkmcnt(6)
  v_mfma_f32_16x16x32_bf16 v[184:187], a[172:175], a[176:179], v[184:187]
  ds_read_b64_tr_b16 a[164:165], v3 offset:8192
  ds_read_b64_tr_b16 a[166:167], v3 offset:10240
  v_mfma_f32_16x16x32_bf16 v[188:191], a[172:175], a[180:183], v[188:191]
  v_mfma_f32_16x16x32_bf16 v[160:163], a[144:147], a[184:187], v[160:163]
  ds_read_b64_tr_b16 a[168:169], v4 offset:8192
  ds_read_b64_tr_b16 a[170:171], v4 offset:10240
  v_mfma_f32_16x16x32_bf16 v[164:167], a[144:147], a[188:191], v[164:167]
  v_cvt_pk_bf16_f32 v128, v128, v129
  v_cvt_pk_bf16_f32 v129, v130, v131
  v_mfma_f32_16x16x32_bf16 v[168:171], a[148:151], a[184:187], v[168:171]
  ds_read_b64_tr_b16 a[172:173], v5 offset:8192
  ds_read_b64_tr_b16 a[174:175], v5 offset:10240
  v_mfma_f32_16x16x32_bf16 v[172:175], a[148:151], a[188:191], v[172:175]
  v_cvt_pk_bf16_f32 v130, v132, v133
  v_cvt_pk_bf16_f32 v131, v134, v135
  s_waitcnt lgkmcnt(6)
  v_mfma_f32_16x16x32_bf16 v[176:179], a[152:155], a[184:187], v[176:179]
  ds_read_b64_tr_b16 a[144:145], v2 offset:12288
  ds_read_b64_tr_b16 a[146:147], v2 offset:14336
  v_mfma_f32_16x16x32_bf16 v[180:183], a[152:155], a[188:191], v[180:183]
  s_nop 1
  v_permlane32_swap_b32 v128, v130
  v_mfma_f32_16x16x32_bf16 v[184:187], a[156:159], a[184:187], v[184:187]
  ds_read_b64_tr_b16 a[148:149], v3 offset:12288
  ds_read_b64_tr_b16 a[150:151], v3 offset:14336
  v_mfma_f32_16x16x32_bf16 v[188:191], a[156:159], a[188:191], v[188:191]
  v_permlane32_swap_b32 v129, v131
  v_cvt_pk_bf16_f32 v136, v136, v137
  v_mfma_f32_16x16x32_bf16 v[160:163], a[160:163], a[192:195], v[160:163]
  ds_read_b64_tr_b16 a[152:153], v4 offset:12288
  ds_read_b64_tr_b16 a[154:155], v4 offset:14336
  v_mfma_f32_16x16x32_bf16 v[164:167], a[160:163], a[196:199], v[164:167]
  v_cvt_pk_bf16_f32 v137, v138, v139
  v_cvt_pk_bf16_f32 v138, v140, v141
  s_waitcnt lgkmcnt(6)
  v_mfma_f32_16x16x32_bf16 v[168:171], a[164:167], a[192:195], v[168:171]
  ds_read_b64_tr_b16 a[156:157], v5 offset:12288
  ds_read_b64_tr_b16 a[158:159], v5 offset:14336
  v_mfma_f32_16x16x32_bf16 v[172:175], a[164:167], a[196:199], v[172:175]
  v_cvt_pk_bf16_f32 v139, v142, v143
  s_nop 1
  v_mfma_f32_16x16x32_bf16 v[176:179], a[168:171], a[192:195], v[176:179]
  ds_read_b64_tr_b16 a[160:161], v2 offset:16384
  ds_read_b64_tr_b16 a[162:163], v2 offset:18432
  v_mfma_f32_16x16x32_bf16 v[180:183], a[168:171], a[196:199], v[180:183]
  v_permlane32_swap_b32 v136, v138
  v_permlane32_swap_b32 v137, v139
  v_mfma_f32_16x16x32_bf16 v[184:187], a[172:175], a[192:195], v[184:187]
  ds_read_b64_tr_b16 a[164:165], v3 offset:16384
  ds_read_b64_tr_b16 a[166:167], v3 offset:18432
  v_mfma_f32_16x16x32_bf16 v[188:191], a[172:175], a[196:199], v[188:191]
  v_cvt_pk_bf16_f32 v144, v144, v145
  v_cvt_pk_bf16_f32 v145, v146, v147
  s_waitcnt lgkmcnt(6)
  v_mfma_f32_16x16x32_bf16 v[160:163], a[144:147], a[200:203], v[160:163]
  ds_read_b64_tr_b16 a[168:169], v4 offset:16384
  ds_read_b64_tr_b16 a[170:171], v4 offset:18432
  v_mfma_f32_16x16x32_bf16 v[164:167], a[144:147], a[204:207], v[164:167]
  s_add_u32 s7, s70, 0
  buffer_store_dwordx4 v[128:131], v13, s[24:27], s7 offen offset:0 sc1
  v_mfma_f32_16x16x32_bf16 v[168:171], a[148:151], a[200:203], v[168:171]
  ds_read_b64_tr_b16 a[172:173], v5 offset:16384
  ds_read_b64_tr_b16 a[174:175], v5 offset:18432
  v_mfma_f32_16x16x32_bf16 v[172:175], a[148:151], a[204:207], v[172:175]
  v_cvt_pk_bf16_f32 v146, v148, v149
  v_cvt_pk_bf16_f32 v147, v150, v151
  v_mfma_f32_16x16x32_bf16 v[176:179], a[152:155], a[200:203], v[176:179]
  ds_read_b64_tr_b16 a[144:145], v2 offset:20480
  ds_read_b64_tr_b16 a[146:147], v2 offset:22528
  v_mfma_f32_16x16x32_bf16 v[180:183], a[152:155], a[204:207], v[180:183]
  s_nop 1
  v_permlane32_swap_b32 v144, v146
  s_waitcnt lgkmcnt(6)
  v_mfma_f32_16x16x32_bf16 v[184:187], a[156:159], a[200:203], v[184:187]
  ds_read_b64_tr_b16 a[148:149], v3 offset:20480
  ds_read_b64_tr_b16 a[150:151], v3 offset:22528
  v_mfma_f32_16x16x32_bf16 v[188:191], a[156:159], a[204:207], v[188:191]
  v_permlane32_swap_b32 v145, v147
  v_cvt_pk_bf16_f32 v152, v152, v153
  v_mfma_f32_16x16x32_bf16 v[160:163], a[160:163], a[208:211], v[160:163]
  ds_read_b64_tr_b16 a[152:153], v4 offset:20480
  ds_read_b64_tr_b16 a[154:155], v4 offset:22528
  v_mfma_f32_16x16x32_bf16 v[164:167], a[160:163], a[212:215], v[164:167]
  v_cvt_pk_bf16_f32 v153, v154, v155
  v_cvt_pk_bf16_f32 v154, v156, v157
  v_mfma_f32_16x16x32_bf16 v[168:171], a[164:167], a[208:211], v[168:171]
  ds_read_b64_tr_b16 a[156:157], v5 offset:20480
  ds_read_b64_tr_b16 a[158:159], v5 offset:22528
  v_mfma_f32_16x16x32_bf16 v[172:175], a[164:167], a[212:215], v[172:175]
  v_cvt_pk_bf16_f32 v155, v158, v159
  s_nop 1
  s_waitcnt lgkmcnt(6)
  v_mfma_f32_16x16x32_bf16 v[176:179], a[168:171], a[208:211], v[176:179]
  ds_read_b64_tr_b16 a[160:161], v2 offset:24576
  ds_read_b64_tr_b16 a[162:163], v2 offset:26624
  v_mfma_f32_16x16x32_bf16 v[180:183], a[168:171], a[212:215], v[180:183]
  v_permlane32_swap_b32 v152, v154
  v_permlane32_swap_b32 v153, v155
  v_mfma_f32_16x16x32_bf16 v[184:187], a[172:175], a[208:211], v[184:187]
  ds_read_b64_tr_b16 a[164:165], v3 offset:24576
  ds_read_b64_tr_b16 a[166:167], v3 offset:26624
  v_mfma_f32_16x16x32_bf16 v[188:191], a[172:175], a[212:215], v[188:191]
  s_add_u32 s7, s70, 0
  buffer_store_dwordx4 v[136:139], v13, s[24:27], s7 offen offset:1024 sc1
  v_mfma_f32_16x16x32_bf16 v[160:163], a[144:147], a[216:219], v[160:163]
  ds_read_b64_tr_b16 a[168:169], v4 offset:24576
  ds_read_b64_tr_b16 a[170:171], v4 offset:26624
  v_mfma_f32_16x16x32_bf16 v[164:167], a[144:147], a[220:223], v[164:167]
  s_waitcnt lgkmcnt(6)
  v_mfma_f32_16x16x32_bf16 v[168:171], a[148:151], a[216:219], v[168:171]
  ds_read_b64_tr_b16 a[172:173], v5 offset:24576
  ds_read_b64_tr_b16 a[174:175], v5 offset:26624
  v_mfma_f32_16x16x32_bf16 v[172:175], a[148:151], a[220:223], v[172:175]
  v_mfma_f32_16x16x32_bf16 v[176:179], a[152:155], a[216:219], v[176:179]
  ds_read_b64_tr_b16 a[144:145], v2 offset:28672
  ds_read_b64_tr_b16 a[146:147], v2 offset:30720
  v_mfma_f32_16x16x32_bf16 v[180:183], a[152:155], a[220:223], v[180:183]
  v_mfma_f32_16x16x32_bf16 v[184:187], a[156:159], a[216:219], v[184:187]
  ds_read_b64_tr_b16 a[148:149], v3 offset:28672
  ds_read_b64_tr_b16 a[150:151], v3 offset:30720
  v_mfma_f32_16x16x32_bf16 v[188:191], a[156:159], a[220:223], v[188:191]
  s_waitcnt lgkmcnt(6)
  v_mfma_f32_16x16x32_bf16 v[160:163], a[160:163], a[224:227], v[160:163]
  ds_read_b64_tr_b16 a[152:153], v4 offset:28672
  ds_read_b64_tr_b16 a[154:155], v4 offset:30720
  v_mfma_f32_16x16x32_bf16 v[164:167], a[160:163], a[228:231], v[164:167]
  v_mfma_f32_16x16x32_bf16 v[168:171], a[164:167], a[224:227], v[168:171]
  ds_read_b64_tr_b16 a[156:157], v5 offset:28672
  ds_read_b64_tr_b16 a[158:159], v5 offset:30720
  v_mfma_f32_16x16x32_bf16 v[172:175], a[164:167], a[228:231], v[172:175]
  v_mfma_f32_16x16x32_bf16 v[176:179], a[168:171], a[224:227], v[176:179]
  ds_read_b64_tr_b16 a[160:161], v2 offset:32768
  ds_read_b64_tr_b16 a[162:163], v2 offset:34816
  v_mfma_f32_16x16x32_bf16 v[180:183], a[168:171], a[228:231], v[180:183]
  s_add_u32 s7, s70, 0
  buffer_store_dwordx4 v[144:147], v13, s[24:27], s7 offen offset:2048 sc1
  s_waitcnt lgkmcnt(6)
  v_mfma_f32_16x16x32_bf16 v[184:187], a[172:175], a[224:227], v[184:187]
  ds_read_b64_tr_b16 a[164:165], v3 offset:32768
  ds_read_b64_tr_b16 a[166:167], v3 offset:34816
  v_mfma_f32_16x16x32_bf16 v[188:191], a[172:175], a[228:231], v[188:191]
  v_mfma_f32_16x16x32_bf16 v[160:163], a[144:147], a[232:235], v[160:163]
  ds_read_b64_tr_b16 a[168:169], v4 offset:32768
  ds_read_b64_tr_b16 a[170:171], v4 offset:34816
  v_mfma_f32_16x16x32_bf16 v[164:167], a[144:147], a[236:239], v[164:167]
  v_mfma_f32_16x16x32_bf16 v[168:171], a[148:151], a[232:235], v[168:171]
  ds_read_b64_tr_b16 a[172:173], v5 offset:32768
  ds_read_b64_tr_b16 a[174:175], v5 offset:34816
  v_mfma_f32_16x16x32_bf16 v[172:175], a[148:151], a[236:239], v[172:175]
  s_waitcnt lgkmcnt(6)
  v_mfma_f32_16x16x32_bf16 v[176:179], a[152:155], a[232:235], v[176:179]
  v_mfma_f32_16x16x32_bf16 v[180:183], a[152:155], a[236:239], v[180:183]
  v_mfma_f32_16x16x32_bf16 v[184:187], a[156:159], a[232:235], v[184:187]
  v_mfma_f32_16x16x32_bf16 v[188:191], a[156:159], a[236:239], v[188:191]
  v_mfma_f32_16x16x32_bf16 v[160:163], a[160:163], a[240:243], v[160:163]
  v_mfma_f32_16x16x32_bf16 v[164:167], a[160:163], a[244:247], v[164:167]
  s_waitcnt vmcnt(17) lgkmcnt(0)
  s_barrier
  v_add_u32 v2, 73728, v8
  v_xor_b32 v3, 32, v2
  v_xor_b32 v4, 64, v2
  v_xor_b32 v5, 0x60, v2
  v_mfma_f32_16x16x32_bf16 v[168:171], a[164:167], a[240:243], v[168:171]
  ds_read_b64_tr_b16 a[144:145], v2 offset:0
  ds_read_b64_tr_b16 a[146:147], v2 offset:2048
  ds_read_b64_tr_b16 a[148:149], v3 offset:0
  v_mfma_f32_16x16x32_bf16 v[172:175], a[164:167], a[244:247], v[172:175]
  ds_read_b64_tr_b16 a[150:151], v3 offset:2048
  s_add_u32 s7, s70, 0
  buffer_store_dwordx4 v[152:155], v13, s[24:27], s7 offen offset:3072 sc1
  v_mfma_f32_16x16x32_bf16 v[176:179], a[168:171], a[240:243], v[176:179]
  ds_read_b64_tr_b16 a[152:153], v4 offset:0
  ds_read_b64_tr_b16 a[154:155], v4 offset:2048
  v_mfma_f32_16x16x32_bf16 v[180:183], a[168:171], a[244:247], v[180:183]
  ds_read_b64_tr_b16 a[156:157], v5 offset:0
  ds_read_b64_tr_b16 a[158:159], v5 offset:2048
  v_mfma_f32_16x16x32_bf16 v[184:187], a[172:175], a[240:243], v[184:187]
  ds_read_b64_tr_b16 a[160:161], v2 offset:4096
  ds_read_b64_tr_b16 a[162:163], v2 offset:6144
  v_mfma_f32_16x16x32_bf16 v[188:191], a[172:175], a[244:247], v[188:191]
  ds_read_b64_tr_b16 a[164:165], v3 offset:4096
  ds_read_b64_tr_b16 a[166:167], v3 offset:6144
  s_waitcnt lgkmcnt(6)
  v_mfma_f32_16x16x32_bf16 v[208:211], a[144:147], a[176:179], v[208:211]
  ds_read_b64_tr_b16 a[168:169], v4 offset:4096
  ds_read_b64_tr_b16 a[170:171], v4 offset:6144
  v_mfma_f32_16x16x32_bf16 v[212:215], a[144:147], a[180:183], v[212:215]
  v_mfma_f32_16x16x32_bf16 v[216:219], a[148:151], a[176:179], v[216:219]
  ds_read_b64_tr_b16 a[172:173], v5 offset:4096
  ds_read_b64_tr_b16 a[174:175], v5 offset:6144
  v_mfma_f32_16x16x32_bf16 v[220:223], a[148:151], a[180:183], v[220:223]
  v_mfma_f32_16x16x32_bf16 v[224:227], a[152:155], a[176:179], v[224:227]
  ds_read_b64_tr_b16 a[144:145], v2 offset:8192
  ds_read_b64_tr_b16 a[146:147], v2 offset:10240
  v_mfma_f32_16x16x32_bf16 v[228:231], a[152:155], a[180:183], v[228:231]
  s_waitcnt lgkmcnt(6)
  v_mfma_f32_16x16x32_bf16 v[232:235], a[156:159], a[176:179], v[232:235]
  ds_read_b64_tr_b16 a[148:149], v3 offset:8192
  ds_read_b64_tr_b16 a[150:151], v3 offset:10240
  v_mfma_f32_16x16x32_bf16 v[236:239], a[156:159], a[180:183], v[236:239]
  v_mfma_f32_16x16x32_bf16 v[208:211], a[160:163], a[184:187], v[208:211]
  ds_read_b64_tr_b16 a[152:153], v4 offset:8192
  ds_read_b64_tr_b16 a[154:155], v4 offset:10240
  v_mfma_f32_16x16x32_bf16 v[212:215], a[160:163], a[188:191], v[212:215]
  v_cvt_pk_bf16_f32 v160, v160, v161
  v_cvt_pk_bf16_f32 v161, v162, v163
  v_mfma_f32_16x16x32_bf16 v[216:219], a[164:167], a[184:187], v[216:219]
  ds_read_b64_tr_b16 a[156:157], v5 offset:8192
  ds_read_b64_tr_b16 a[158:159], v5 offset:10240
  v_mfma_f32_16x16x32_bf16 v[220:223], a[164:167], a[188:191], v[220:223]
  v_cvt_pk_bf16_f32 v162, v164, v165
  v_cvt_pk_bf16_f32 v163, v166, v167
  s_waitcnt lgkmcnt(6)
  v_mfma_f32_16x16x32_bf16 v[224:227], a[168:171], a[184:187], v[224:227]
  ds_read_b64_tr_b16 a[160:161], v2 offset:12288
  ds_read_b64_tr_b16 a[162:163], v2 offset:14336
  v_mfma_f32_16x16x32_bf16 v[228:231], a[168:171], a[188:191], v[228:231]
  s_nop 1
  v_permlane32_swap_b32 v160, v162
  v_mfma_f32_16x16x32_bf16 v[232:235], a[172:175], a[184:187], v[232:235]
  ds_read_b64_tr_b16 a[164:165], v3 offset:12288
  ds_read_b64_tr_b16 a[166:167], v3 offset:14336
  v_mfma_f32_16x16x32_bf16 v[236:239], a[172:175], a[188:191], v[236:239]
  v_permlane32_swap_b32 v161, v163
  v_cvt_pk_bf16_f32 v168, v168, v169
  v_cvt_pk_bf16_f32 v169, v170, v171
  v_cvt_pk_bf16_f32 v170, v172, v173
  v_cvt_pk_bf16_f32 v171, v174, v175
  s_nop 1
  v_permlane32_swap_b32 v168, v170
  v_permlane32_swap_b32 v169, v171
  v_mfma_f32_16x16x32_bf16 v[208:211], a[144:147], a[192:195], v[208:211]
  ds_read_b64_tr_b16 a[168:169], v4 offset:12288
  ds_read_b64_tr_b16 a[170:171], v4 offset:14336
  v_mfma_f32_16x16x32_bf16 v[212:215], a[144:147], a[196:199], v[212:215]
  s_add_u32 s7, s70, 4096
  buffer_store_dwordx4 v[160:163], v13, s[24:27], s7 offen offset:0 sc1
  s_waitcnt lgkmcnt(6)
  v_mfma_f32_16x16x32_bf16 v[216:219], a[148:151], a[192:195], v[216:219]
  ds_read_b64_tr_b16 a[172:173], v5 offset:12288
  ds_read_b64_tr_b16 a[174:175], v5 offset:14336
  v_mfma_f32_16x16x32_bf16 v[220:223], a[148:151], a[196:199], v[220:223]
  v_cvt_pk_bf16_f32 v176, v176, v177
  v_cvt_pk_bf16_f32 v177, v178, v179
  v_mfma_f32_16x16x32_bf16 v[224:227], a[152:155], a[192:195], v[224:227]
  ds_read_b64_tr_b16 a[144:145], v2 offset:16384
  ds_read_b64_tr_b16 a[146:147], v2 offset:18432
  v_mfma_f32_16x16x32_bf16 v[228:231], a[152:155], a[196:199], v[228:231]
  v_cvt_pk_bf16_f32 v178, v180, v181
  v_cvt_pk_bf16_f32 v179, v182, v183
  v_mfma_f32_16x16x32_bf16 v[232:235], a[156:159], a[192:195], v[232:235]
  ds_read_b64_tr_b16 a[148:149], v3 offset:16384
  ds_read_b64_tr_b16 a[150:151], v3 offset:18432
  v_mfma_f32_16x16x32_bf16 v[236:239], a[156:159], a[196:199], v[236:239]
  s_nop 1
  v_permlane32_swap_b32 v176, v178
  s_waitcnt lgkmcnt(6)
  v_mfma_f32_16x16x32_bf16 v[208:211], a[160:163], a[200:203], v[208:211]
  ds_read_b64_tr_b16 a[152:153], v4 offset:16384
  ds_read_b64_tr_b16 a[154:155], v4 offset:18432
  v_mfma_f32_16x16x32_bf16 v[212:215], a[160:163], a[204:207], v[212:215]
  v_permlane32_swap_b32 v177, v179
  v_cvt_pk_bf16_f32 v184, v184, v185
  v_mfma_f32_16x16x32_bf16 v[216:219], a[164:167], a[200:203], v[216:219]
  ds_read_b64_tr_b16 a[156:157], v5 offset:16384
  ds_read_b64_tr_b16 a[158:159], v5 offset:18432
  v_mfma_f32_16x16x32_bf16 v[220:223], a[164:167], a[204:207], v[220:223]
  v_cvt_pk_bf16_f32 v185, v186, v187
  v_cvt_pk_bf16_f32 v186, v188, v189
  v_mfma_f32_16x16x32_bf16 v[224:227], a[168:171], a[200:203], v[224:227]
  ds_read_b64_tr_b16 a[160:161], v2 offset:20480
  ds_read_b64_tr_b16 a[162:163], v2 offset:22528
  v_mfma_f32_16x16x32_bf16 v[228:231], a[168:171], a[204:207], v[228:231]
  v_cvt_pk_bf16_f32 v187, v190, v191
  s_nop 1
  s_waitcnt lgkmcnt(6)
  v_mfma_f32_16x16x32_bf16 v[232:235], a[172:175], a[200:203], v[232:235]
  ds_read_b64_tr_b16 a[164:165], v3 offset:20480
  ds_read_b64_tr_b16 a[166:167], v3 offset:22528
  v_mfma_f32_16x16x32_bf16 v[236:239], a[172:175], a[204:207], v[236:239]
  v_permlane32_swap_b32 v184, v186
  v_permlane32_swap_b32 v185, v187
  v_mfma_f32_16x16x32_bf16 v[208:211], a[144:147], a[208:211], v[208:211]
  ds_read_b64_tr_b16 a[168:169], v4 offset:20480
  ds_read_b64_tr_b16 a[170:171], v4 offset:22528
  v_mfma_f32_16x16x32_bf16 v[212:215], a[144:147], a[212:215], v[212:215]
  s_add_u32 s7, s70, 4096
  buffer_store_dwordx4 v[168:171], v13, s[24:27], s7 offen offset:1024 sc1
  v_mfma_f32_16x16x32_bf16 v[216:219], a[148:151], a[208:211], v[216:219]
  ds_read_b64_tr_b16 a[172:173], v5 offset:20480
  ds_read_b64_tr_b16 a[174:175], v5 offset:22528
  v_mfma_f32_16x16x32_bf16 v[220:223], a[148:151], a[212:215], v[220:223]
  s_waitcnt lgkmcnt(6)
  v_mfma_f32_16x16x32_bf16 v[224:227], a[152:155], a[208:211], v[224:227]
  ds_read_b64_tr_b16 a[144:145], v2 offset:24576
  ds_read_b64_tr_b16 a[146:147], v2 offset:26624
  v_mfma_f32_16x16x32_bf16 v[228:231], a[152:155], a[212:215], v[228:231]
  v_mfma_f32_16x16x32_bf16 v[232:235], a[156:159], a[208:211], v[232:235]
  ds_read_b64_tr_b16 a[148:149], v3 offset:24576
  ds_read_b64_tr_b16 a[150:151], v3 offset:26624
  v_mfma_f32_16x16x32_bf16 v[236:239], a[156:159], a[212:215], v[236:239]
  v_mfma_f32_16x16x32_bf16 v[208:211], a[160:163], a[216:219], v[208:211]
  ds_read_b64_tr_b16 a[152:153], v4 offset:24576
  ds_read_b64_tr_b16 a[154:155], v4 offset:26624
  v_mfma_f32_16x16x32_bf16 v[212:215], a[160:163], a[220:223], v[212:215]
  s_waitcnt lgkmcnt(6)
  v_mfma_f32_16x16x32_bf16 v[216:219], a[164:167], a[216:219], v[216:219]
  ds_read_b64_tr_b16 a[156:157], v5 offset:24576
  ds_read_b64_tr_b16 a[158:159], v5 offset:26624
  v_mfma_f32_16x16x32_bf16 v[220:223], a[164:167], a[220:223], v[220:223]
  v_mfma_f32_16x16x32_bf16 v[224:227], a[168:171], a[216:219], v[224:227]
  ds_read_b64_tr_b16 a[160:161], v2 offset:28672
  ds_read_b64_tr_b16 a[162:163], v2 offset:30720
  v_mfma_f32_16x16x32_bf16 v[228:231], a[168:171], a[220:223], v[228:231]
  v_mfma_f32_16x16x32_bf16 v[232:235], a[172:175], a[216:219], v[232:235]
  ds_read_b64_tr_b16 a[164:165], v3 offset:28672
  ds_read_b64_tr_b16 a[166:167], v3 offset:30720
  v_mfma_f32_16x16x32_bf16 v[236:239], a[172:175], a[220:223], v[236:239]
  s_waitcnt lgkmcnt(6)
  v_mfma_f32_16x16x32_bf16 v[208:211], a[144:147], a[224:227], v[208:211]
  ds_read_b64_tr_b16 a[168:169], v4 offset:28672
  ds_read_b64_tr_b16 a[170:171], v4 offset:30720
  v_mfma_f32_16x16x32_bf16 v[212:215], a[144:147], a[228:231], v[212:215]
  s_add_u32 s7, s70, 4096
  buffer_store_dwordx4 v[176:179], v13, s[24:27], s7 offen offset:2048 sc1
  v_mfma_f32_16x16x32_bf16 v[216:219], a[148:151], a[224:227], v[216:219]
  ds_read_b64_tr_b16 a[172:173], v5 offset:28672
  ds_read_b64_tr_b16 a[174:175], v5 offset:30720
  v_mfma_f32_16x16x32_bf16 v[220:223], a[148:151], a[228:231], v[220:223]
  v_mfma_f32_16x16x32_bf16 v[224:227], a[152:155], a[224:227], v[224:227]
  ds_read_b64_tr_b16 a[144:145], v2 offset:32768
  ds_read_b64_tr_b16 a[146:147], v2 offset:34816
  v_mfma_f32_16x16x32_bf16 v[228:231], a[152:155], a[228:231], v[228:231]
  s_waitcnt lgkmcnt(6)
  v_mfma_f32_16x16x32_bf16 v[232:235], a[156:159], a[224:227], v[232:235]
  ds_read_b64_tr_b16 a[148:149], v3 offset:32768
  ds_read_b64_tr_b16 a[150:151], v3 offset:34816
  v_mfma_f32_16x16x32_bf16 v[236:239], a[156:159], a[228:231], v[236:239]
  v_mfma_f32_16x16x32_bf16 v[208:211], a[160:163], a[232:235], v[208:211]
  ds_read_b64_tr_b16 a[152:153], v4 offset:32768
  ds_read_b64_tr_b16 a[154:155], v4 offset:34816
  v_mfma_f32_16x16x32_bf16 v[212:215], a[160:163], a[236:239], v[212:215]
  v_mfma_f32_16x16x32_bf16 v[216:219], a[164:167], a[232:235], v[216:219]
  ds_read_b64_tr_b16 a[156:157], v5 offset:32768
  ds_read_b64_tr_b16 a[158:159], v5 offset:34816
  v_mfma_f32_16x16x32_bf16 v[220:223], a[164:167], a[236:239], v[220:223]
  s_waitcnt lgkmcnt(6)
  v_mfma_f32_16x16x32_bf16 v[224:227], a[168:171], a[232:235], v[224:227]
  v_mfma_f32_16x16x32_bf16 v[228:231], a[168:171], a[236:239], v[228:231]
  v_mfma_f32_16x16x32_bf16 v[232:235], a[172:175], a[232:235], v[232:235]
  v_mfma_f32_16x16x32_bf16 v[236:239], a[172:175], a[236:239], v[236:239]
  v_mfma_f32_16x16x32_bf16 v[208:211], a[144:147], a[240:243], v[208:211]
  s_add_u32 s7, s70, 4096
  buffer_store_dwordx4 v[184:187], v13, s[24:27], s7 offen offset:3072 sc1
  v_mfma_f32_16x16x32_bf16 v[212:215], a[144:147], a[244:247], v[212:215]
  s_waitcnt vmcnt(12) lgkmcnt(0)
  s_barrier
  v_add_u32 v2, 110592, v8
  v_xor_b32 v3, 32, v2
  v_xor_b32 v4, 64, v2
  v_xor_b32 v5, 0x60, v2
  v_mfma_f32_16x16x32_bf16 v[216:219], a[148:151], a[240:243], v[216:219]
  ds_read_b64_tr_b16 a[160:161], v2 offset:0
  ds_read_b64_tr_b16 a[162:163], v2 offset:2048
  v_mfma_f32_16x16x32_bf16 v[220:223], a[148:151], a[244:247], v[220:223]
  ds_read_b64_tr_b16 a[164:165], v3 offset:0
  ds_read_b64_tr_b16 a[166:167], v3 offset:2048
  v_mfma_f32_16x16x32_bf16 v[224:227], a[152:155], a[240:243], v[224:227]
  ds_read_b64_tr_b16 a[168:169], v4 offset:0
  ds_read_b64_tr_b16 a[170:171], v4 offset:2048
  v_mfma_f32_16x16x32_bf16 v[228:231], a[152:155], a[244:247], v[228:231]
  ds_read_b64_tr_b16 a[172:173], v5 offset:0
  ds_read_b64_tr_b16 a[174:175], v5 offset:2048
  v_mfma_f32_16x16x32_bf16 v[232:235], a[156:159], a[240:243], v[232:235]
  ds_read_b64_tr_b16 a[144:145], v2 offset:4096
  ds_read_b64_tr_b16 a[146:147], v2 offset:6144
  v_mfma_f32_16x16x32_bf16 v[236:239], a[156:159], a[244:247], v[236:239]
  ds_read_b64_tr_b16 a[148:149], v3 offset:4096
  ds_read_b64_tr_b16 a[150:151], v3 offset:6144
  s_waitcnt lgkmcnt(6)
  v_mfma_f32_16x16x32_bf16 v[96:99], a[160:163], a[176:179], v[96:99]
  ds_read_b64_tr_b16 a[152:153], v4 offset:4096
  ds_read_b64_tr_b16 a[154:155], v4 offset:6144
  v_mfma_f32_16x16x32_bf16 v[100:103], a[160:163], a[180:183], v[100:103]
  v_mfma_f32_16x16x32_bf16 v[104:107], a[164:167], a[176:179], v[104:107]
  ds_read_b64_tr_b16 a[156:157], v5 offset:4096
  ds_read_b64_tr_b16 a[158:159], v5 offset:6144
  v_mfma_f32_16x16x32_bf16 v[108:111], a[164:167], a[180:183], v[108:111]
  v_mfma_f32_16x16x32_bf16 v[112:115], a[168:171], a[176:179], v[112:115]
  ds_read_b64_tr_b16 a[160:161], v2 offset:8192
  ds_read_b64_tr_b16 a[162:163], v2 offset:10240
  v_mfma_f32_16x16x32_bf16 v[116:119], a[168:171], a[180:183], v[116:119]
  s_waitcnt lgkmcnt(6)
  v_mfma_f32_16x16x32_bf16 v[120:123], a[172:175], a[176:179], v[120:123]
  ds_read_b64_tr_b16 a[164:165], v3 offset:8192
  ds_read_b64_tr_b16 a[166:167], v3 offset:10240
  v_mfma_f32_16x16x32_bf16 v[124:127], a[172:175], a[180:183], v[124:127]
  v_mfma_f32_16x16x32_bf16 v[96:99], a[144:147], a[184:187], v[96:99]
  ds_read_b64_tr_b16 a[168:169], v4 offset:8192
  ds_read_b64_tr_b16 a[170:171], v4 offset:10240
  v_mfma_f32_16x16x32_bf16 v[100:103], a[144:147], a[188:191], v[100:103]
  v_cvt_pk_bf16_f32 v208, v208, v209
  v_cvt_pk_bf16_f32 v209, v210, v211
  v_mfma_f32_16x16x32_bf16 v[104:107], a[148:151], a[184:187], v[104:107]
  ds_read_b64_tr_b16 a[172:173], v5 offset:8192
  ds_read_b64_tr_b16 a[174:175], v5 offset:10240
  v_mfma_f32_16x16x32_bf16 v[108:111], a[148:151], a[188:191], v[108:111]
  v_cvt_pk_bf16_f32 v210, v212, v213
  v_cvt_pk_bf16_f32 v211, v214, v215
  s_waitcnt lgkmcnt(6)
  v_mfma_f32_16x16x32_bf16 v[112:115], a[152:155], a[184:187], v[112:115]
  ds_read_b64_tr_b16 a[144:145], v2 offset:12288
  ds_read_b64_tr_b16 a[146:147], v2 offset:14336
  v_mfma_f32_16x16x32_bf16 v[116:119], a[152:155], a[188:191], v[116:119]
  s_nop 1
  v_permlane32_swap_b32 v208, v210
  v_mfma_f32_16x16x32_bf16 v[120:123], a[156:159], a[184:187], v[120:123]
  ds_read_b64_tr_b16 a[148:149], v3 offset:12288
  ds_read_b64_tr_b16 a[150:151], v3 offset:14336
  v_mfma_f32_16x16x32_bf16 v[124:127], a[156:159], a[188:191], v[124:127]
  v_permlane32_swap_b32 v209, v211
  v_cvt_pk_bf16_f32 v216, v216, v217
  v_cvt_pk_bf16_f32 v217, v218, v219
  v_cvt_pk_bf16_f32 v218, v220, v221
  v_cvt_pk_bf16_f32 v219, v222, v223
  s_nop 1
  v_permlane32_swap_b32 v216, v218
  v_permlane32_swap_b32 v217, v219
  v_mfma_f32_16x16x32_bf16 v[96:99], a[160:163], a[192:195], v[96:99]
  ds_read_b64_tr_b16 a[152:153], v4 offset:12288
  ds_read_b64_tr_b16 a[154:155], v4 offset:14336
  v_mfma_f32_16x16x32_bf16 v[100:103], a[160:163], a[196:199], v[100:103]
  s_add_u32 s7, s70, 8192
  buffer_store_dwordx4 v[208:211], v13, s[24:27], s7 offen offset:0 sc1
  s_waitcnt lgkmcnt(6)
  v_mfma_f32_16x16x32_bf16 v[104:107], a[164:167], a[192:195], v[104:107]
  ds_read_b64_tr_b16 a[156:157], v5 offset:12288
  ds_read_b64_tr_b16 a[158:159], v5 offset:14336
  v_mfma_f32_16x16x32_bf16 v[108:111], a[164:167], a[196:199], v[108:111]
  v_cvt_pk_bf16_f32 v224, v224, v225
  v_cvt_pk_bf16_f32 v225, v226, v227
  v_mfma_f32_16x16x32_bf16 v[112:115], a[168:171], a[192:195], v[112:115]
  ds_read_b64_tr_b16 a[160:161], v2 offset:16384
  ds_read_b64_tr_b16 a[162:163], v2 offset:18432
  v_mfma_f32_16x16x32_bf16 v[116:119], a[168:171], a[196:199], v[116:119]
  v_cvt_pk_bf16_f32 v226, v228, v229
  v_cvt_pk_bf16_f32 v227, v230, v231
  v_mfma_f32_16x16x32_bf16 v[120:123], a[172:175], a[192:195], v[120:123]
  ds_read_b64_tr_b16 a[164:165], v3 offset:16384
  ds_read_b64_tr_b16 a[166:167], v3 offset:18432
  v_mfma_f32_16x16x32_bf16 v[124:127], a[172:175], a[196:199], v[124:127]
  s_nop 1
  v_permlane32_swap_b32 v224, v226
  s_waitcnt lgkmcnt(6)
  v_mfma_f32_16x16x32_bf16 v[96:99], a[144:147], a[200:203], v[96:99]
  ds_read_b64_tr_b16 a[168:169], v4 offset:16384
  ds_read_b64_tr_b16 a[170:171], v4 offset:18432
  v_mfma_f32_16x16x32_bf16 v[100:103], a[144:147], a[204:207], v[100:103]
  v_permlane32_swap_b32 v225, v227
  v_cvt_pk_bf16_f32 v232, v232, v233
  v_mfma_f32_16x16x32_bf16 v[104:107], a[148:151], a[200:203], v[104:107]
  ds_read_b64_tr_b16 a[172:173], v5 offset:16384
  ds_read_b64_tr_b16 a[174:175], v5 offset:18432
  v_mfma_f32_16x16x32_bf16 v[108:111], a[148:151], a[204:207], v[108:111]
  v_cvt_pk_bf16_f32 v233, v234, v235
  v_cvt_pk_bf16_f32 v234, v236, v237
  v_mfma_f32_16x16x32_bf16 v[112:115], a[152:155], a[200:203], v[112:115]
  ds_read_b64_tr_b16 a[144:145], v2 offset:20480
  ds_read_b64_tr_b16 a[146:147], v2 offset:22528
  v_mfma_f32_16x16x32_bf16 v[116:119], a[152:155], a[204:207], v[116:119]
  v_cvt_pk_bf16_f32 v235, v238, v239
  s_nop 1
  s_waitcnt lgkmcnt(6)
  v_mfma_f32_16x16x32_bf16 v[120:123], a[156:159], a[200:203], v[120:123]
  ds_read_b64_tr_b16 a[148:149], v3 offset:20480
  ds_read_b64_tr_b16 a[150:151], v3 offset:22528
  v_mfma_f32_16x16x32_bf16 v[124:127], a[156:159], a[204:207], v[124:127]
  s_add_u32 s7, s70, 8192
  buffer_store_dwordx4 v[216:219], v13, s[24:27], s7 offen offset:1024 sc1
  v_mfma_f32_16x16x32_bf16 v[96:99], a[160:163], a[208:211], v[96:99]
  ds_read_b64_tr_b16 a[152:153], v4 offset:20480
  ds_read_b64_tr_b16 a[154:155], v4 offset:22528
  v_mfma_f32_16x16x32_bf16 v[100:103], a[160:163], a[212:215], v[100:103]
  v_permlane32_swap_b32 v232, v234
  v_permlane32_swap_b32 v233, v235
  v_mfma_f32_16x16x32_bf16 v[104:107], a[164:167], a[208:211], v[104:107]
  ds_read_b64_tr_b16 a[156:157], v5 offset:20480
  ds_read_b64_tr_b16 a[158:159], v5 offset:22528
  v_mfma_f32_16x16x32_bf16 v[108:111], a[164:167], a[212:215], v[108:111]
  s_waitcnt lgkmcnt(6)
  v_mfma_f32_16x16x32_bf16 v[112:115], a[168:171], a[208:211], v[112:115]
  ds_read_b64_tr_b16 a[160:161], v2 offset:24576
  ds_read_b64_tr_b16 a[162:163], v2 offset:26624
  v_mfma_f32_16x16x32_bf16 v[116:119], a[168:171], a[212:215], v[116:119]
  v_mfma_f32_16x16x32_bf16 v[120:123], a[172:175], a[208:211], v[120:123]
  ds_read_b64_tr_b16 a[164:165], v3 offset:24576
  ds_read_b64_tr_b16 a[166:167], v3 offset:26624
  v_mfma_f32_16x16x32_bf16 v[124:127], a[172:175], a[212:215], v[124:127]
  v_mfma_f32_16x16x32_bf16 v[96:99], a[144:147], a[216:219], v[96:99]
  ds_read_b64_tr_b16 a[168:169], v4 offset:24576
  ds_read_b64_tr_b16 a[170:171], v4 offset:26624
  v_mfma_f32_16x16x32_bf16 v[100:103], a[144:147], a[220:223], v[100:103]
  s_waitcnt lgkmcnt(6)
  v_mfma_f32_16x16x32_bf16 v[104:107], a[148:151], a[216:219], v[104:107]
  ds_read_b64_tr_b16 a[172:173], v5 offset:24576
  ds_read_b64_tr_b16 a[174:175], v5 offset:26624
  v_mfma_f32_16x16x32_bf16 v[108:111], a[148:151], a[220:223], v[108:111]
  v_mfma_f32_16x16x32_bf16 v[112:115], a[152:155], a[216:219], v[112:115]
  ds_read_b64_tr_b16 a[144:145], v2 offset:28672
  ds_read_b64_tr_b16 a[146:147], v2 offset:30720
  v_mfma_f32_16x16x32_bf16 v[116:119], a[152:155], a[220:223], v[116:119]
  s_add_u32 s7, s70, 8192
  buffer_store_dwordx4 v[224:227], v13, s[24:27], s7 offen offset:2048 sc1
  v_mfma_f32_16x16x32_bf16 v[120:123], a[156:159], a[216:219], v[120:123]
  ds_read_b64_tr_b16 a[148:149], v3 offset:28672
  ds_read_b64_tr_b16 a[150:151], v3 offset:30720
  v_mfma_f32_16x16x32_bf16 v[124:127], a[156:159], a[220:223], v[124:127]
  s_waitcnt lgkmcnt(6)
  v_mfma_f32_16x16x32_bf16 v[96:99], a[160:163], a[224:227], v[96:99]
  ds_read_b64_tr_b16 a[152:153], v4 offset:28672
  ds_read_b64_tr_b16 a[154:155], v4 offset:30720
  v_mfma_f32_16x16x32_bf16 v[100:103], a[160:163], a[228:231], v[100:103]
  v_mfma_f32_16x16x32_bf16 v[104:107], a[164:167], a[224:227], v[104:107]
  ds_read_b64_tr_b16 a[156:157], v5 offset:28672
  ds_read_b64_tr_b16 a[158:159], v5 offset:30720
  v_mfma_f32_16x16x32_bf16 v[108:111], a[164:167], a[228:231], v[108:111]
  v_mfma_f32_16x16x32_bf16 v[112:115], a[168:171], a[224:227], v[112:115]
  ds_read_b64_tr_b16 a[160:161], v2 offset:32768
  ds_read_b64_tr_b16 a[162:163], v2 offset:34816
  v_mfma_f32_16x16x32_bf16 v[116:119], a[168:171], a[228:231], v[116:119]
  s_waitcnt lgkmcnt(6)
  v_mfma_f32_16x16x32_bf16 v[120:123], a[172:175], a[224:227], v[120:123]
  ds_read_b64_tr_b16 a[164:165], v3 offset:32768
  ds_read_b64_tr_b16 a[166:167], v3 offset:34816
  v_mfma_f32_16x16x32_bf16 v[124:127], a[172:175], a[228:231], v[124:127]
  v_mfma_f32_16x16x32_bf16 v[96:99], a[144:147], a[232:235], v[96:99]
  ds_read_b64_tr_b16 a[168:169], v4 offset:32768
  ds_read_b64_tr_b16 a[170:171], v4 offset:34816
  v_mfma_f32_16x16x32_bf16 v[100:103], a[144:147], a[236:239], v[100:103]
  v_mfma_f32_16x16x32_bf16 v[104:107], a[148:151], a[232:235], v[104:107]
  ds_read_b64_tr_b16 a[172:173], v5 offset:32768
  ds_read_b64_tr_b16 a[174:175], v5 offset:34816
  v_mfma_f32_16x16x32_bf16 v[108:111], a[148:151], a[236:239], v[108:111]
  s_add_u32 s7, s70, 8192
  buffer_store_dwordx4 v[232:235], v13, s[24:27], s7 offen offset:3072 sc1
  s_waitcnt lgkmcnt(6)
  v_mfma_f32_16x16x32_bf16 v[112:115], a[152:155], a[232:235], v[112:115]
  v_mfma_f32_16x16x32_bf16 v[116:119], a[152:155], a[236:239], v[116:119]
  v_mfma_f32_16x16x32_bf16 v[120:123], a[156:159], a[232:235], v[120:123]
  v_mfma_f32_16x16x32_bf16 v[124:127], a[156:159], a[236:239], v[124:127]
  v_mfma_f32_16x16x32_bf16 v[96:99], a[160:163], a[240:243], v[96:99]
  v_mfma_f32_16x16x32_bf16 v[100:103], a[160:163], a[244:247], v[100:103]
  s_waitcnt lgkmcnt(0)
  v_mfma_f32_16x16x32_bf16 v[104:107], a[164:167], a[240:243], v[104:107]
  v_mfma_f32_16x16x32_bf16 v[108:111], a[164:167], a[244:247], v[108:111]
  v_mfma_f32_16x16x32_bf16 v[112:115], a[168:171], a[240:243], v[112:115]
  v_mfma_f32_16x16x32_bf16 v[116:119], a[168:171], a[244:247], v[116:119]
  v_mfma_f32_16x16x32_bf16 v[120:123], a[172:175], a[240:243], v[120:123]
  v_mfma_f32_16x16x32_bf16 v[124:127], a[172:175], a[244:247], v[124:127]
  s_nop 7
  s_nop 7
  v_cvt_pk_bf16_f32 v96, v96, v97
  v_cvt_pk_bf16_f32 v97, v98, v99
  v_cvt_pk_bf16_f32 v98, v100, v101
  v_cvt_pk_bf16_f32 v99, v102, v103
  s_nop 1
  v_permlane32_swap_b32 v96, v98
  v_permlane32_swap_b32 v97, v99
  v_cvt_pk_bf16_f32 v104, v104, v105
  v_cvt_pk_bf16_f32 v105, v106, v107
  v_cvt_pk_bf16_f32 v106, v108, v109
  v_cvt_pk_bf16_f32 v107, v110, v111
  s_nop 1
  v_permlane32_swap_b32 v104, v106
  v_permlane32_swap_b32 v105, v107
  s_add_u32 s7, s70, 12288
  buffer_store_dwordx4 v[96:99], v13, s[24:27], s7 offen offset:0 sc1
  s_add_u32 s7, s70, 12288
  buffer_store_dwordx4 v[104:107], v13, s[24:27], s7 offen offset:1024 sc1
  v_cvt_pk_bf16_f32 v112, v112, v113
  v_cvt_pk_bf16_f32 v113, v114, v115
  v_cvt_pk_bf16_f32 v114, v116, v117
  v_cvt_pk_bf16_f32 v115, v118, v119
  s_nop 1
  v_permlane32_swap_b32 v112, v114
  v_permlane32_swap_b32 v113, v115
  v_cvt_pk_bf16_f32 v120, v120, v121
  v_cvt_pk_bf16_f32 v121, v122, v123
  v_cvt_pk_bf16_f32 v122, v124, v125
  v_cvt_pk_bf16_f32 v123, v126, v127
  s_nop 1
  v_permlane32_swap_b32 v120, v122
  v_permlane32_swap_b32 v121, v123
  s_add_u32 s7, s70, 12288
  buffer_store_dwordx4 v[112:115], v13, s[24:27], s7 offen offset:2048 sc1
  s_add_u32 s7, s70, 12288
  buffer_store_dwordx4 v[120:123], v13, s[24:27], s7 offen offset:3072 sc1
K1_fin:
  s_waitcnt vmcnt(0)
K1_end:
  s_endpgm
K1_spin:
  s_mov_b32 s87, 0
K1_spin_loop:
  s_sleep 4
  buffer_load_dword v10, off, s[24:27], s74 sc1
  s_waitcnt vmcnt(0)
  v_readfirstlane_b32 s88, v10
  s_nop 3
  s_cmp_ge_u32 s88, 1
  s_cbranch_scc1 K1_spin_done
  s_add_u32 s87, s87, 1
  s_cmp_lt_u32 s87, 0x40000
  s_cbranch_scc1 K1_spin_loop
  s_branch K1_spin_done
K1_spin2:
  s_mov_b32 s87, 0
K1_spin2_loop:
  s_sleep 4
  buffer_load_dword v10, off, s[24:27], s74 sc1
  s_waitcnt vmcnt(0)
  v_readfirstlane_b32 s88, v10
  s_nop 3
  s_cmp_ge_u32 s88, 2
  s_cbranch_scc1 K1_spin2_done
  s_add_u32 s87, s87, 1
  s_cmp_lt_u32 s87, 0x40000
  s_cbranch_scc1 K1_spin2_loop
  s_branch K1_spin2_done
K1_spinc:
  s_mov_b32 s87, 0
K1_spinc_loop:
  s_sleep 4
  buffer_load_dword v10, off, s[28:31], s72 sc1
  s_waitcnt vmcnt(0)
  v_readfirstlane_b32 s88, v10
  s_nop 3
  s_bitcmp1_b32 s88, s73
  s_cbranch_scc1 K1_spinc_done
  s_add_u32 s87, s87, 1
  s_cmp_lt_u32 s87, 0x40000
  s_cbranch_scc1 K1_spinc_loop
  s_branch K1_spinc_done
K1_codeend:
.section .rodata,"a"
.p2align 6
.amdhsa_kernel k1_kernel
  .amdhsa_next_free_vgpr 512
  .amdhsa_next_free_sgpr 102
  .amdhsa_accum_offset 256
  .amdhsa_group_segment_fixed_size 0
  .amdhsa_kernarg_size 104
  .amdhsa_user_sgpr_count 2
  .amdhsa_user_sgpr_kernarg_segment_ptr 1
  .amdhsa_system_sgpr_workgroup_id_x 1
  .amdhsa_float_denorm_mode_32 3
.end_amdhsa_kernel
.text
.globl k2_kernel
.p2align 8
.type k2_kernel,@function
k2_kernel:
  s_cmp_ge_u32 s2, 198
  s_cbranch_scc1 K2_end
  s_load_dwordx2 s[16:17], s[0:1], 96
  s_load_dwordx2 s[20:21], s[0:1], 80
  s_getpc_b64 s[24:25]
K2_pc:
  s_and_b32 s25, s25, 0xffff
  s_mov_b32 s26, K2_codeend-K2_pc
  s_mov_b32 s27, 0x20000
  s_lshr_b32 s40, s2, 3
  s_lshl_b32 s40, s40, 2
  v_add_u32 v3, s40, v0
  v_lshlrev_b32 v3, 7, v3
  v_mov_b32 v4, 0x7ff00000
  v_cmp_gt_u32 vcc, 4, v0
  s_nop 1
  v_cndmask_b32 v3, v4, v3, vcc
  buffer_load_dword v252, v3, s[24:27], 0 offen
  v_lshrrev_b32 v2, 6, v0
  v_and_b32 v0, 63, v0
  v_readfirstlane_b32 s32, v2
  v_lshlrev_b32 v1, 4, v0
  s_and_b32 s33, s2, 1
  s_bfe_u32 s40, s2, 0x10001
  s_bfe_u32 s34, s2, 0x10002
  s_lshr_b32 s41, s2, 3
  s_and_b32 s35, s41, 7
  s_lshr_b32 s41, s41, 3
  s_mul_i32 s40, s40, 3
  s_add_u32 s40, s40, s41
  s_sub_u32 s42, s2, 192
  s_cmp_ge_u32 s2, 192
  s_cselect_b32 s40, s42, s40
  s_cselect_b32 s33, 0, s33
  s_cselect_b32 s35, 0, s35
  s_cselect_b32 s34, 2, s34
  s_mul_i32 s40, s40, 3
  s_lshr_b32 s41, s32, 1
  s_add_u32 s36, s40, s41
  s_and_b32 s37, s32, 1
  s_sub_u32 s41, 3, s34
  s_cmp_eq_u32 s37, 0
  s_cselect_b32 s38, s34, s41
  s_add_u32 s41, s37, 2
  s_cmp_eq_u32 s34, 2
  s_cselect_b32 s38, s41, s38
  s_lshl_b32 s39, s35, 6
  s_add_u32 s39, s39, s33
  s_cmp_eq_u32 s34, 1
  s_cselect_b32 s42, 1024, 0
  s_cselect_b32 s43, -1, 1
  s_cmp_eq_u32 s34, 2
  s_cselect_b32 s42, 512, s42
  s_cselect_b32 s43, 0, s43
  v_and_b32 v5, 31, v0
  v_lshl_add_u32 v6, v5, 1, s39
  v_mul_lo_u32 v6, v6, s43
  v_add_u32 v6, s42, v6
  v_cvt_f32_u32 v10, v6
  v_lshrrev_b32 v6, 5, v0
  v_lshlrev_b32 v6, 3, v6
  v_cvt_f32_u32 v6, v6
  s_mov_b32 s45, 0x3a000000
  v_mul_f32 v7, s45, v10
  s_cmp_eq_u32 s37, 1
  s_cselect_b32 s46, 0xbf800000, 1.0
  v_mul_f32 v7, s46, v7
  s_lshr_b32 s47, s32, 1
  s_mul_i32 s47, s47, 11
  s_lshl_b32 s48, s47, 4
  v_cvt_f32_u32 v8, s48
  v_add_f32 v6, v6, v8
  v_mul_f32 v11, 0x41800000, v7
  s_mul_i32 s48, s37, 36864
  s_lshl_b32 s47, s47, 10
  s_add_u32 s48, s48, s47
  v_add_u32 v13, s48, v1
  v_mov_b32 v240, v6
  v_mul_f32 v232, v240, v7
  v_add_f32 v240, 1.0, v6
  v_mul_f32 v233, v240, v7
  v_add_f32 v240, 2.0, v6
  v_mul_f32 v234, v240, v7
  v_add_f32 v240, 3.0, v6
  v_mul_f32 v235, v240, v7
  v_add_f32 v240, 4.0, v6
  v_mul_f32 v236, v240, v7
  v_add_f32 v240, 5.0, v6
  v_mul_f32 v237, v240, v7
  v_add_f32 v240, 6.0, v6
  v_mul_f32 v238, v240, v7
  v_add_f32 v240, 7.0, v6
  v_mul_f32 v239, v240, v7
  s_cmp_eq_u32 s37, 1
  v_fract_f32 v240, v232
  v_fract_f32 v241, v233
  v_fract_f32 v242, v234
  v_fract_f32 v243, v235
  v_fract_f32 v244, v236
  v_fract_f32 v245, v237
  v_fract_f32 v246, v238
  v_fract_f32 v247, v239
  s_cbranch_scc1 K2_gs0
  v_cos_f32 v240, v240
  v_cos_f32 v241, v241
  v_cos_f32 v242, v242
  v_cos_f32 v243, v243
  v_cos_f32 v244, v244
  v_cos_f32 v245, v245
  v_cos_f32 v246, v246
  v_cos_f32 v247, v247
  s_branch K2_gd0
K2_gs0:
  v_sin_f32 v240, v240
  v_sin_f32 v241, v241
  v_sin_f32 v242, v242
  v_sin_f32 v243, v243
  v_sin_f32 v244, v244
  v_sin_f32 v245, v245
  v_sin_f32 v246, v246
  v_sin_f32 v247, v247
K2_gd0:
  s_nop 0
  v_cvt_pk_bf16_f32 v240, v240, v241
  v_cvt_pk_bf16_f32 v241, v242, v243
  v_cvt_pk_bf16_f32 v242, v244, v245
  v_cvt_pk_bf16_f32 v243, v246, v247
  ds_write_b128 v13, v[240:243] offset:0
  s_nop 1
  s_cmp_eq_u32 s37, 1
  v_add_f32 v232, v232, v11
  v_fract_f32 v240, v232
  v_add_f32 v233, v233, v11
  v_fract_f32 v241, v233
  v_add_f32 v234, v234, v11
  v_fract_f32 v242, v234
  v_add_f32 v235, v235, v11
  v_fract_f32 v243, v235
  v_add_f32 v236, v236, v11
  v_fract_f32 v244, v236
  v_add_f32 v237, v237, v11
  v_fract_f32 v245, v237
  v_add_f32 v238, v238, v11
  v_fract_f32 v246, v238
  v_add_f32 v239, v239, v11
  v_fract_f32 v247, v239
  s_cbranch_scc1 K2_gs1
  v_cos_f32 v240, v240
  v_cos_f32 v241, v241
  v_cos_f32 v242, v242
  v_cos_f32 v243, v243
  v_cos_f32 v244, v244
  v_cos_f32 v245, v245
  v_cos_f32 v246, v246
  v_cos_f32 v247, v247
  s_branch K2_gd1
K2_gs1:
  v_sin_f32 v240, v240
  v_sin_f32 v241, v241
  v_sin_f32 v242, v242
  v_sin_f32 v243, v243
  v_sin_f32 v244, v244
  v_sin_f32 v245, v245
  v_sin_f32 v246, v246
  v_sin_f32 v247, v247
K2_gd1:
  s_nop 0
  v_cvt_pk_bf16_f32 v240, v240, v241
  v_cvt_pk_bf16_f32 v241, v242, v243
  v_cvt_pk_bf16_f32 v242, v244, v245
  v_cvt_pk_bf16_f32 v243, v246, v247
  ds_write_b128 v13, v[240:243] offset:1024
  s_nop 1
  s_cmp_eq_u32 s37, 1
  v_add_f32 v232, v232, v11
  v_fract_f32 v240, v232
  v_add_f32 v233, v233, v11
  v_fract_f32 v241, v233
  v_add_f32 v234, v234, v11
  v_fract_f32 v242, v234
  v_add_f32 v235, v235, v11
  v_fract_f32 v243, v235
  v_add_f32 v236, v236, v11
  v_fract_f32 v244, v236
  v_add_f32 v237, v237, v11
  v_fract_f32 v245, v237
  v_add_f32 v238, v238, v11
  v_fract_f32 v246, v238
  v_add_f32 v239, v239, v11
  v_fract_f32 v247, v239
  s_cbranch_scc1 K2_gs2
  v_cos_f32 v240, v240
  v_cos_f32 v241, v241
  v_cos_f32 v242, v242
  v_cos_f32 v243, v243
  v_cos_f32 v244, v244
  v_cos_f32 v245, v245
  v_cos_f32 v246, v246
  v_cos_f32 v247, v247
  s_branch K2_gd2
K2_gs2:
  v_sin_f32 v240, v240
  v_sin_f32 v241, v241
  v_sin_f32 v242, v242
  v_sin_f32 v243, v243
  v_sin_f32 v244, v244
  v_sin_f32 v245, v245
  v_sin_f32 v246, v246
  v_sin_f32 v247, v247
K2_gd2:
  s_nop 0
  v_cvt_pk_bf16_f32 v240, v240, v241
  v_cvt_pk_bf16_f32 v241, v242, v243
  v_cvt_pk_bf16_f32 v242, v244, v245
  v_cvt_pk_bf16_f32 v243, v246, v247
  ds_write_b128 v13, v[240:243] offset:2048
  s_nop 1
  s_waitcnt lgkmcnt(0)
  s_and_b32 s17, s17, 0xffff
  s_mov_b32 s18, 268435456
  s_mov_b32 s19, 0x20000
  s_and_b32 s21, s21, 0xffff
  s_mov_b32 s22, 2359296
  s_mov_b32 s23, 0x20000
  s_lshl_b32 s49, s35, 2
  s_add_u32 s49, s49, s38
  s_lshl_b32 s49, s49, 1
  s_add_u32 s49, s49, s33
  s_mul_i32 s49, s49, 294912
  s_lshl_b32 s50, s36, 11
  s_add_u32 s49, s49, s50
  s_add_u32 s49, s49, 33554432
  v_and_b32 v5, 31, v0
  v_lshl_add_u32 v8, v5, 1, s39
  s_cmp_eq_u32 s38, 0
  s_cselect_b32 s60, 0, 1024
  s_cmp_eq_u32 s38, 3
  s_cselect_b32 s60, 2048, s60
  s_and_b32 s61, s38, 1
  v_sub_u32 v9, s60, v8
  v_add_u32 v15, s60, v8
  s_cmp_eq_u32 s61, 1
  s_cselect_b64 vcc, -1, 0
  s_lshl_b32 s62, s38, 10
  s_sub_u32 s62, s62, 1536
  v_cndmask_b32 v15, v15, v9, vcc
  v_mov_b32 v9, s62
  s_cmp_ge_u32 s38, 2
  s_cselect_b32 s61, 0, -1
  v_cmp_eq_u32 vcc, s61, v8
  s_nop 1
  v_cndmask_b32 v15, v15, v9, vcc
  v_lshlrev_b32 v2, 2, v15
  s_mov_b32 s51, 75497472
  buffer_load_dword v14, v2, s[16:19], s51 offen
  s_lshl_b32 s57, s33, 1
  s_add_u32 s57, s57, s37
  s_mul_i32 s57, s57, 18
  s_add_u32 s57, s57, s36
  s_mul_i32 s57, s57, 33792
  s_add_u32 s57, s57, 67108864
  s_add_u32 s58, s35, 0
  s_and_b32 s58, s58, 7
  s_lshl_b32 s58, s58, 12
  s_add_u32 s58, s58, s57
  buffer_load_dwordx4 v[120:123], v1, s[16:19], s58 offen offset:0
  buffer_load_dwordx4 v[124:127], v1, s[16:19], s58 offen offset:1024
  buffer_load_dwordx4 v[128:131], v1, s[16:19], s58 offen offset:2048
  buffer_load_dwordx4 v[132:135], v1, s[16:19], s58 offen offset:3072
  s_add_u32 s58, s35, 1
  s_and_b32 s58, s58, 7
  s_lshl_b32 s58, s58, 12
  s_add_u32 s58, s58, s57
  buffer_load_dwordx4 v[136:139], v1, s[16:19], s58 offen offset:0
  s_cmp_eq_u32 s37, 1
  v_add_f32 v232, v232, v11
  v_fract_f32 v240, v232
  v_add_f32 v233, v233, v11
  v_fract_f32 v241, v233
  v_add_f32 v234, v234, v11
  v_fract_f32 v242, v234
  v_add_f32 v235, v235, v11
  v_fract_f32 v243, v235
  v_add_f32 v236, v236, v11
  v_fract_f32 v244, v236
  v_add_f32 v237, v237, v11
  v_fract_f32 v245, v237
  v_add_f32 v238, v238, v11
  v_fract_f32 v246, v238
  v_add_f32 v239, v239, v11
  v_fract_f32 v247, v239
  s_cbranch_scc1 K2_gs3
  v_cos_f32 v240, v240
  v_cos_f32 v241, v241
  v_cos_f32 v242, v242
  v_cos_f32 v243, v243
  v_cos_f32 v244, v244
  v_cos_f32 v245, v245
  v_cos_f32 v246, v246
  v_cos_f32 v247, v247
  s_branch K2_gd3
K2_gs3:
  v_sin_f32 v240, v240
  v_sin_f32 v241, v241
  v_sin_f32 v242, v242
  v_sin_f32 v243, v243
  v_sin_f32 v244, v244
  v_sin_f32 v245, v245
  v_sin_f32 v246, v246
  v_sin_f32 v247, v247
K2_gd3:
  s_nop 0
  v_cvt_pk_bf16_f32 v240, v240, v241
  v_cvt_pk_bf16_f32 v241, v242, v243
  v_cvt_pk_bf16_f32 v242, v244, v245
  v_cvt_pk_bf16_f32 v243, v246, v247
  ds_write_b128 v13, v[240:243] offset:3072
  s_nop 1
  buffer_load_dwordx4 v[140:143], v1, s[16:19], s58 offen offset:1024
  buffer_load_dwordx4 v[144:147], v1, s[16:19], s58 offen offset:2048
  buffer_load_dwordx4 v[148:151], v1, s[16:19], s58 offen offset:3072
  s_cmp_eq_u32 s37, 1
  v_add_f32 v232, v232, v11
  v_fract_f32 v240, v232
  v_add_f32 v233, v233, v11
  v_fract_f32 v241, v233
  v_add_f32 v234, v234, v11
  v_fract_f32 v242, v234
  v_add_f32 v235, v235, v11
  v_fract_f32 v243, v235
  v_add_f32 v236, v236, v11
  v_fract_f32 v244, v236
  v_add_f32 v237, v237, v11
  v_fract_f32 v245, v237
  v_add_f32 v238, v238, v11
  v_fract_f32 v246, v238
  v_add_f32 v239, v239, v11
  v_fract_f32 v247, v239
  s_cbranch_scc1 K2_gs4
  v_cos_f32 v240, v240
  v_cos_f32 v241, v241
  v_cos_f32 v242, v242
  v_cos_f32 v243, v243
  v_cos_f32 v244, v244
  v_cos_f32 v245, v245
  v_cos_f32 v246, v246
  v_cos_f32 v247, v247
  s_branch K2_gd4
K2_gs4:
  v_sin_f32 v240, v240
  v_sin_f32 v241, v241
  v_sin_f32 v242, v242
  v_sin_f32 v243, v243
  v_sin_f32 v244, v244
  v_sin_f32 v245, v245
  v_sin_f32 v246, v246
  v_sin_f32 v247, v247
K2_gd4:
  s_nop 0
  v_cvt_pk_bf16_f32 v240, v240, v241
  v_cvt_pk_bf16_f32 v241, v242, v243
  v_cvt_pk_bf16_f32 v242, v244, v245
  v_cvt_pk_bf16_f32 v243, v246, v247
  ds_write_b128 v13, v[240:243] offset:4096
  s_nop 1
  s_add_u32 s58, s35, 2
  s_and_b32 s58, s58, 7
  s_lshl_b32 s58, s58, 12
  s_add_u32 s58, s58, s57
  buffer_load_dwordx4 v[152:155], v1, s[16:19], s58 offen offset:0
  buffer_load_dwordx4 v[156:159], v1, s[16:19], s58 offen offset:1024
  buffer_load_dwordx4 v[160:163], v1, s[16:19], s58 offen offset:2048
  s_cmp_eq_u32 s37, 1
  v_add_f32 v232, v232, v11
  v_fract_f32 v240, v232
  v_add_f32 v233, v233, v11
  v_fract_f32 v241, v233
  v_add_f32 v234, v234, v11
  v_fract_f32 v242, v234
  v_add_f32 v235, v235, v11
  v_fract_f32 v243, v235
  v_add_f32 v236, v236, v11
  v_fract_f32 v244, v236
  v_add_f32 v237, v237, v11
  v_fract_f32 v245, v237
  v_add_f32 v238, v238, v11
  v_fract_f32 v246, v238
  v_add_f32 v239, v239, v11
  v_fract_f32 v247, v239
  s_cbranch_scc1 K2_gs5
  v_cos_f32 v240, v240
  v_cos_f32 v241, v241
  v_cos_f32 v242, v242
  v_cos_f32 v243, v243
  v_cos_f32 v244, v244
  v_cos_f32 v245, v245
  v_cos_f32 v246, v246
  v_cos_f32 v247, v247
  s_branch K2_gd5
K2_gs5:
  v_sin_f32 v240, v240
  v_sin_f32 v241, v241
  v_sin_f32 v242, v242
  v_sin_f32 v243, v243
  v_sin_f32 v244, v244
  v_sin_f32 v245, v245
  v_sin_f32 v246, v246
  v_sin_f32 v247, v247
K2_gd5:
  s_nop 0
  v_cvt_pk_bf16_f32 v240, v240, v241
  v_cvt_pk_bf16_f32 v241, v242, v243
  v_cvt_pk_bf16_f32 v242, v244, v245
  v_cvt_pk_bf16_f32 v243, v246, v247
  ds_write_b128 v13, v[240:243] offset:5120
  s_nop 1
  buffer_load_dwordx4 v[164:167], v1, s[16:19], s58 offen offset:3072
  s_add_u32 s58, s35, 3
  s_and_b32 s58, s58, 7
  s_lshl_b32 s58, s58, 12
  s_add_u32 s58, s58, s57
  buffer_load_dwordx4 v[168:171], v1, s[16:19], s58 offen offset:0
  buffer_load_dwordx4 v[172:175], v1, s[16:19], s58 offen offset:1024
  s_cmp_eq_u32 s37, 1
  v_add_f32 v232, v232, v11
  v_fract_f32 v240, v232
  v_add_f32 v233, v233, v11
  v_fract_f32 v241, v233
  v_add_f32 v234, v234, v11
  v_fract_f32 v242, v234
  v_add_f32 v235, v235, v11
  v_fract_f32 v243, v235
  v_add_f32 v236, v236, v11
  v_fract_f32 v244, v236
  v_add_f32 v237, v237, v11
  v_fract_f32 v245, v237
  v_add_f32 v238, v238, v11
  v_fract_f32 v246, v238
  v_add_f32 v239, v239, v11
  v_fract_f32 v247, v239
  s_cbranch_scc1 K2_gs6
  v_cos_f32 v240, v240
  v_cos_f32 v241, v241
  v_cos_f32 v242, v242
  v_cos_f32 v243, v243
  v_cos_f32 v244, v244
  v_cos_f32 v245, v245
  v_cos_f32 v246, v246
  v_cos_f32 v247, v247
  s_branch K2_gd6
K2_gs6:
  v_sin_f32 v240, v240
  v_sin_f32 v241, v241
  v_sin_f32 v242, v242
  v_sin_f32 v243, v243
  v_sin_f32 v244, v244
  v_sin_f32 v245, v245
  v_sin_f32 v246, v246
  v_sin_f32 v247, v247
K2_gd6:
  s_nop 0
  v_cvt_pk_bf16_f32 v240, v240, v241
  v_cvt_pk_bf16_f32 v241, v242, v243
  v_cvt_pk_bf16_f32 v242, v244, v245
  v_cvt_pk_bf16_f32 v243, v246, v247
  ds_write_b128 v13, v[240:243] offset:6144
  s_nop 1
  buffer_load_dwordx4 v[176:179], v1, s[16:19], s58 offen offset:2048
  buffer_load_dwordx4 v[180:183], v1, s[16:19], s58 offen offset:3072
  s_add_u32 s65, s49, 0
  buffer_load_dwordx4 v[56:59], v1, s[16:19], s65 offen offset:0
  s_cmp_eq_u32 s37, 1
  v_add_f32 v232, v232, v11
  v_fract_f32 v240, v232
  v_add_f32 v233, v233, v11
  v_fract_f32 v241, v233
  v_add_f32 v234, v234, v11
  v_fract_f32 v242, v234
  v_add_f32 v235, v235, v11
  v_fract_f32 v243, v235
  v_add_f32 v236, v236, v11
  v_fract_f32 v244, v236
  v_add_f32 v237, v237, v11
  v_fract_f32 v245, v237
  v_add_f32 v238, v238, v11
  v_fract_f32 v246, v238
  v_add_f32 v239, v239, v11
  v_fract_f32 v247, v239
  s_cbranch_scc1 K2_gs7
  v_cos_f32 v240, v240
  v_cos_f32 v241, v241
  v_cos_f32 v242, v242
  v_cos_f32 v243, v243
  v_cos_f32 v244, v244
  v_cos_f32 v245, v245
  v_cos_f32 v246, v246
  v_cos_f32 v247, v247
  s_branch K2_gd7
K2_gs7:
  v_sin_f32 v240, v240
  v_sin_f32 v241, v241
  v_sin_f32 v242, v242
  v_sin_f32 v243, v243
  v_sin_f32 v244, v244
  v_sin_f32 v245, v245
  v_sin_f32 v246, v246
  v_sin_f32 v247, v247
K2_gd7:
  s_nop 0
  v_cvt_pk_bf16_f32 v240, v240, v241
  v_cvt_pk_bf16_f32 v241, v242, v243
  v_cvt_pk_bf16_f32 v242, v244, v245
  v_cvt_pk_bf16_f32 v243, v246, v247
  ds_write_b128 v13, v[240:243] offset:7168
  s_nop 1
  buffer_load_dwordx4 v[60:63], v1, s[16:19], s65 offen offset:1024
  s_add_u32 s65, s49, 36864
  buffer_load_dwordx4 v[64:67], v1, s[16:19], s65 offen offset:0
  buffer_load_dwordx4 v[68:71], v1, s[16:19], s65 offen offset:1024
  s_cmp_eq_u32 s37, 1
  v_add_f32 v232, v232, v11
  v_fract_f32 v240, v232
  v_add_f32 v233, v233, v11
  v_fract_f32 v241, v233
  v_add_f32 v234, v234, v11
  v_fract_f32 v242, v234
  v_add_f32 v235, v235, v11
  v_fract_f32 v243, v235
  v_add_f32 v236, v236, v11
  v_fract_f32 v244, v236
  v_add_f32 v237, v237, v11
  v_fract_f32 v245, v237
  v_add_f32 v238, v238, v11
  v_fract_f32 v246, v238
  v_add_f32 v239, v239, v11
  v_fract_f32 v247, v239
  s_cbranch_scc1 K2_gs8
  v_cos_f32 v240, v240
  v_cos_f32 v241, v241
  v_cos_f32 v242, v242
  v_cos_f32 v243, v243
  v_cos_f32 v244, v244
  v_cos_f32 v245, v245
  v_cos_f32 v246, v246
  v_cos_f32 v247, v247
  s_branch K2_gd8
K2_gs8:
  v_sin_f32 v240, v240
  v_sin_f32 v241, v241
  v_sin_f32 v242, v242
  v_sin_f32 v243, v243
  v_sin_f32 v244, v244
  v_sin_f32 v245, v245
  v_sin_f32 v246, v246
  v_sin_f32 v247, v247
K2_gd8:
  s_nop 0
  v_cvt_pk_bf16_f32 v240, v240, v241
  v_cvt_pk_bf16_f32 v241, v242, v243
  v_cvt_pk_bf16_f32 v242, v244, v245
  v_cvt_pk_bf16_f32 v243, v246, v247
  ds_write_b128 v13, v[240:243] offset:8192
  s_nop 1
  s_add_u32 s65, s49, 73728
  buffer_load_dwordx4 v[72:75], v1, s[16:19], s65 offen offset:0
  buffer_load_dwordx4 v[76:79], v1, s[16:19], s65 offen offset:1024
  s_add_u32 s65, s49, 110592
  buffer_load_dwordx4 v[80:83], v1, s[16:19], s65 offen offset:0
  s_cmp_eq_u32 s37, 1
  v_add_f32 v232, v232, v11
  v_fract_f32 v240, v232
  v_add_f32 v233, v233, v11
  v_fract_f32 v241, v233
  v_add_f32 v234, v234, v11
  v_fract_f32 v242, v234
  v_add_f32 v235, v235, v11
  v_fract_f32 v243, v235
  v_add_f32 v236, v236, v11
  v_fract_f32 v244, v236
  v_add_f32 v237, v237, v11
  v_fract_f32 v245, v237
  v_add_f32 v238, v238, v11
  v_fract_f32 v246, v238
  v_add_f32 v239, v239, v11
  v_fract_f32 v247, v239
  s_cbranch_scc1 K2_gs9
  v_cos_f32 v240, v240
  v_cos_f32 v241, v241
  v_cos_f32 v242, v242
  v_cos_f32 v243, v243
  v_cos_f32 v244, v244
  v_cos_f32 v245, v245
  v_cos_f32 v246, v246
  v_cos_f32 v247, v247
  s_branch K2_gd9
K2_gs9:
  v_sin_f32 v240, v240
  v_sin_f32 v241, v241
  v_sin_f32 v242, v242
  v_sin_f32 v243, v243
  v_sin_f32 v244, v244
  v_sin_f32 v245, v245
  v_sin_f32 v246, v246
  v_sin_f32 v247, v247
K2_gd9:
  s_nop 0
  v_cvt_pk_bf16_f32 v240, v240, v241
  v_cvt_pk_bf16_f32 v241, v242, v243
  v_cvt_pk_bf16_f32 v242, v244, v245
  v_cvt_pk_bf16_f32 v243, v246, v247
  ds_write_b128 v13, v[240:243] offset:9216
  s_nop 1
  buffer_load_dwordx4 v[84:87], v1, s[16:19], s65 offen offset:1024
  s_cmp_eq_u32 s37, 1
  v_add_f32 v232, v232, v11
  v_fract_f32 v240, v232
  v_add_f32 v233, v233, v11
  v_fract_f32 v241, v233
  v_add_f32 v234, v234, v11
  v_fract_f32 v242, v234
  v_add_f32 v235, v235, v11
  v_fract_f32 v243, v235
  v_add_f32 v236, v236, v11
  v_fract_f32 v244, v236
  v_add_f32 v237, v237, v11
  v_fract_f32 v245, v237
  v_add_f32 v238, v238, v11
  v_fract_f32 v246, v238
  v_add_f32 v239, v239, v11
  v_fract_f32 v247, v239
  s_cbranch_scc1 K2_gs10
  v_cos_f32 v240, v240
  v_cos_f32 v241, v241
  v_cos_f32 v242, v242
  v_cos_f32 v243, v243
  v_cos_f32 v244, v244
  v_cos_f32 v245, v245
  v_cos_f32 v246, v246
  v_cos_f32 v247, v247
  s_branch K2_gd10
K2_gs10:
  v_sin_f32 v240, v240
  v_sin_f32 v241, v241
  v_sin_f32 v242, v242
  v_sin_f32 v243, v243
  v_sin_f32 v244, v244
  v_sin_f32 v245, v245
  v_sin_f32 v246, v246
  v_sin_f32 v247, v247
K2_gd10:
  s_nop 0
  v_cvt_pk_bf16_f32 v240, v240, v241
  v_cvt_pk_bf16_f32 v241, v242, v243
  v_cvt_pk_bf16_f32 v242, v244, v245
  v_cvt_pk_bf16_f32 v243, v246, v247
  ds_write_b128 v13, v[240:243] offset:10240
  s_nop 1
  s_waitcnt lgkmcnt(0)
  s_barrier
  s_mul_i32 s59, s37, 36864
  v_add_u32 v10, s59, v1
  s_add_u32 s63, s35, 0
  s_and_b32 s63, s63, 7
  s_lshl_b32 s63, s63, 12
  v_add_u32 v9, s63, v10
  ds_read_b128 v[16:19], v9 offset:0
  ds_read_b128 v[20:23], v9 offset:1024
  ds_read_b128 v[4:7], v9 offset:2048
  s_waitcnt vmcnt(23) lgkmcnt(2)
  v_mfma_f32_32x32x16_bf16 v[24:39], v[120:123], v[16:19], 0
  s_add_u32 s58, s35, 4
  s_and_b32 s58, s58, 7
  s_lshl_b32 s58, s58, 12
  s_add_u32 s58, s58, s57
  buffer_load_dwordx4 v[184:187], v1, s[16:19], s58 offen offset:0
  ds_read_b128 v[16:19], v9 offset:3072
  s_waitcnt vmcnt(23) lgkmcnt(2)
  v_mfma_f32_32x32x16_bf16 v[24:39], v[124:127], v[20:23], v[24:39]
  buffer_load_dwordx4 v[188:191], v1, s[16:19], s58 offen offset:1024
  s_add_u32 s65, s49, 147456
  buffer_load_dwordx4 v[88:91], v1, s[16:19], s65 offen offset:0
  s_add_u32 s63, s35, 1
  s_and_b32 s63, s63, 7
  s_lshl_b32 s63, s63, 12
  v_add_u32 v9, s63, v10
  ds_read_b128 v[20:23], v9 offset:0
  s_waitcnt vmcnt(24) lgkmcnt(2)
  v_mfma_f32_32x32x16_bf16 v[24:39], v[128:131], v[4:7], v[24:39]
  buffer_load_dwordx4 v[192:195], v1, s[16:19], s58 offen offset:2048
  ds_read_b128 v[4:7], v9 offset:1024
  s_waitcnt vmcnt(24) lgkmcnt(2)
  v_mfma_f32_32x32x16_bf16 v[24:39], v[132:135], v[16:19], v[24:39]
  buffer_load_dwordx4 v[196:199], v1, s[16:19], s58 offen offset:3072
  buffer_load_dwordx4 v[92:95], v1, s[16:19], s65 offen offset:1024
  ds_read_b128 v[16:19], v9 offset:2048
  s_waitcnt vmcnt(25) lgkmcnt(2)
  v_mfma_f32_32x32x16_bf16 v[24:39], v[136:139], v[20:23], v[24:39]
  s_add_u32 s58, s35, 5
  s_and_b32 s58, s58, 7
  s_lshl_b32 s58, s58, 12
  s_add_u32 s58, s58, s57
  buffer_load_dwordx4 v[200:203], v1, s[16:19], s58 offen offset:0
  ds_read_b128 v[20:23], v9 offset:3072
  s_waitcnt vmcnt(25) lgkmcnt(2)
  v_mfma_f32_32x32x16_bf16 v[24:39], v[140:143], v[4:7], v[24:39]
  buffer_load_dwordx4 v[204:207], v1, s[16:19], s58 offen offset:1024
  s_add_u32 s65, s49, 184320
  buffer_load_dwordx4 v[96:99], v1, s[16:19], s65 offen offset:0
  s_add_u32 s63, s35, 2
  s_and_b32 s63, s63, 7
  s_lshl_b32 s63, s63, 12
  v_add_u32 v9, s63, v10
  ds_read_b128 v[4:7], v9 offset:0
  s_waitcnt vmcnt(26) lgkmcnt(2)
  v_mfma_f32_32x32x16_bf16 v[24:39], v[144:147], v[16:19], v[24:39]
  buffer_load_dwordx4 v[208:211], v1, s[16:19], s58 offen offset:2048
  ds_read_b128 v[16:19], v9 offset:1024
  s_waitcnt vmcnt(26) lgkmcnt(2)
  v_mfma_f32_32x32x16_bf16 v[24:39], v[148:151], v[20:23], v[24:39]
  buffer_load_dwordx4 v[212:215], v1, s[16:19], s58 offen offset:3072
  buffer_load_dwordx4 v[100:103], v1, s[16:19], s65 offen offset:1024
  ds_read_b128 v[20:23], v9 offset:2048
  s_waitcnt vmcnt(27) lgkmcnt(2)
  v_mfma_f32_32x32x16_bf16 v[24:39], v[152:155], v[4:7], v[24:39]
  s_add_u32 s58, s35, 6
  s_and_b32 s58, s58, 7
  s_lshl_b32 s58, s58, 12
  s_add_u32 s58, s58, s57
  buffer_load_dwordx4 v[216:219], v1, s[16:19], s58 offen offset:0
  ds_read_b128 v[4:7], v9 offset:3072
  s_waitcnt vmcnt(27) lgkmcnt(2)
  v_mfma_f32_32x32x16_bf16 v[24:39], v[156:159], v[16:19], v[24:39]
  buffer_load_dwordx4 v[220:223], v1, s[16:19], s58 offen offset:1024
  s_add_u32 s65, s49, 221184
  buffer_load_dwordx4 v[104:107], v1, s[16:19], s65 offen offset:0
  s_add_u32 s63, s35, 3
  s_and_b32 s63, s63, 7
  s_lshl_b32 s63, s63, 12
  v_add_u32 v9, s63, v10
  ds_read_b128 v[16:19], v9 offset:0
  s_waitcnt vmcnt(28) lgkmcnt(2)
  v_mfma_f32_32x32x16_bf16 v[24:39], v[160:163], v[20:23], v[24:39]
  buffer_load_dwordx4 v[224:227], v1, s[16:19], s58 offen offset:2048
  ds_read_b128 v[20:23], v9 offset:1024
  s_waitcnt vmcnt(28) lgkmcnt(2)
  v_mfma_f32_32x32x16_bf16 v[24:39], v[164:167], v[4:7], v[24:39]
  buffer_load_dwordx4 v[228:231], v1, s[16:19], s58 offen offset:3072
  buffer_load_dwordx4 v[108:111], v1, s[16:19], s65 offen offset:1024
  ds_read_b128 v[4:7], v9 offset:2048
  s_waitcnt vmcnt(29) lgkmcnt(2)
  v_mfma_f32_32x32x16_bf16 v[24:39], v[168:171], v[16:19], v[24:39]
  s_add_u32 s58, s35, 7
  s_and_b32 s58, s58, 7
  s_lshl_b32 s58, s58, 12
  s_add_u32 s58, s58, s57
  buffer_load_dwordx4 v[232:235], v1, s[16:19], s58 offen offset:0
  ds_read_b128 v[16:19], v9 offset:3072
  s_waitcnt vmcnt(29) lgkmcnt(2)
  v_mfma_f32_32x32x16_bf16 v[24:39], v[172:175], v[20:23], v[24:39]
  buffer_load_dwordx4 v[236:239], v1, s[16:19], s58 offen offset:1024
  s_add_u32 s65, s49, 258048
  buffer_load_dwordx4 v[112:115], v1, s[16:19], s65 offen offset:0
  s_add_u32 s63, s35, 4
  s_and_b32 s63, s63, 7
  s_lshl_b32 s63, s63, 12
  v_add_u32 v9, s63, v10
  ds_read_b128 v[20:23], v9 offset:0
  s_waitcnt vmcnt(30) lgkmcnt(2)
  v_mfma_f32_32x32x16_bf16 v[24:39], v[176:179], v[4:7], v[24:39]
  buffer_load_dwordx4 v[240:243], v1, s[16:19], s58 offen offset:2048
  ds_read_b128 v[4:7], v9 offset:1024
  s_waitcnt vmcnt(30) lgkmcnt(2)
  v_mfma_f32_32x32x16_bf16 v[24:39], v[180:183], v[16:19], v[24:39]
  buffer_load_dwordx4 v[244:247], v1, s[16:19], s58 offen offset:3072
  buffer_load_dwordx4 v[116:119], v1, s[16:19], s65 offen offset:1024
  ds_read_b128 v[16:19], v9 offset:2048
  s_waitcnt vmcnt(23) lgkmcnt(2)
  v_mfma_f32_32x32x16_bf16 v[24:39], v[184:187], v[20:23], v[24:39]
  s_add_u32 s58, s57, 32768
  buffer_load_dwordx4 v[248:251], v1, s[16:19], s58 offen offset:0
  ds_read_b128 v[20:23], v9 offset:3072
  s_waitcnt vmcnt(23) lgkmcnt(2)
  v_mfma_f32_32x32x16_bf16 v[24:39], v[188:191], v[4:7], v[24:39]
  s_add_u32 s63, s35, 5
  s_and_b32 s63, s63, 7
  s_lshl_b32 s63, s63, 12
  v_add_u32 v9, s63, v10
  ds_read_b128 v[4:7], v9 offset:0
  s_waitcnt vmcnt(21) lgkmcnt(2)
  v_mfma_f32_32x32x16_bf16 v[24:39], v[192:195], v[16:19], v[24:39]
  v_lshlrev_b32 v2, 16, v56
  v_and_b32 v3, 0xffff0000, v56
  v_lshlrev_b32 v8, 16, v64
  v_and_b32 v252, 0xffff0000, v64
  v_add_f32 v56, v2, v8
  v_add_f32 v64, v3, v252
  v_lshlrev_b32 v2, 16, v57
  v_and_b32 v3, 0xffff0000, v57
  ds_read_b128 v[16:19], v9 offset:1024
  s_waitcnt vmcnt(20) lgkmcnt(2)
  v_mfma_f32_32x32x16_bf16 v[24:39], v[196:199], v[20:23], v[24:39]
  v_lshlrev_b32 v8, 16, v65
  v_and_b32 v252, 0xffff0000, v65
  v_add_f32 v57, v2, v8
  v_add_f32 v65, v3, v252
  v_lshlrev_b32 v2, 16, v58
  v_and_b32 v3, 0xffff0000, v58
  v_lshlrev_b32 v8, 16, v66
  v_and_b32 v252, 0xffff0000, v66
  ds_read_b128 v[20:23], v9 offset:2048
  s_waitcnt vmcnt(18) lgkmcnt(2)
  v_mfma_f32_32x32x16_bf16 v[24:39], v[200:203], v[4:7], v[24:39]
  v_add_f32 v58, v2, v8
  v_add_f32 v66, v3, v252
  v_lshlrev_b32 v2, 16, v59
  v_and_b32 v3, 0xffff0000, v59
  v_lshlrev_b32 v8, 16, v67
  v_and_b32 v252, 0xffff0000, v67
  v_add_f32 v59, v2, v8
  v_add_f32 v67, v3, v252
  ds_read_b128 v[4:7], v9 offset:3072
  s_waitcnt vmcnt(17) lgkmcnt(2)
  v_mfma_f32_32x32x16_bf16 v[24:39], v[204:207], v[16:19], v[24:39]
  v_lshlrev_b32 v2, 16, v60
  v_and_b32 v3, 0xffff0000, v60
  v_lshlrev_b32 v8, 16, v68
  v_and_b32 v252, 0xffff0000, v68
  v_add_f32 v60, v2, v8
  v_add_f32 v68, v3, v252
  v_lshlrev_b32 v2, 16, v61
  v_and_b32 v3, 0xffff0000, v61
  s_add_u32 s63, s35, 6
  s_and_b32 s63, s63, 7
  s_lshl_b32 s63, s63, 12
  v_add_u32 v9, s63, v10
  ds_read_b128 v[16:19], v9 offset:0
  s_waitcnt vmcnt(15) lgkmcnt(2)
  v_mfma_f32_32x32x16_bf16 v[24:39], v[208:211], v[20:23], v[24:39]
  v_lshlrev_b32 v8, 16, v69
  v_and_b32 v252, 0xffff0000, v69
  v_add_f32 v61, v2, v8
  v_add_f32 v69, v3, v252
  v_lshlrev_b32 v2, 16, v62
  v_and_b32 v3, 0xffff0000, v62
  v_lshlrev_b32 v8, 16, v70
  v_and_b32 v252, 0xffff0000, v70
  ds_read_b128 v[20:23], v9 offset:1024
  s_waitcnt vmcnt(14) lgkmcnt(2)
  v_mfma_f32_32x32x16_bf16 v[24:39], v[212:215], v[4:7], v[24:39]
  v_add_f32 v62, v2, v8
  v_add_f32 v70, v3, v252
  v_lshlrev_b32 v2, 16, v63
  v_and_b32 v3, 0xffff0000, v63
  v_lshlrev_b32 v8, 16, v71
  v_and_b32 v252, 0xffff0000, v71
  v_add_f32 v63, v2, v8
  v_add_f32 v71, v3, v252
  ds_read_b128 v[4:7], v9 offset:2048
  s_waitcnt vmcnt(12) lgkmcnt(2)
  v_mfma_f32_32x32x16_bf16 v[24:39], v[216:219], v[16:19], v[24:39]
  v_lshlrev_b32 v2, 16, v72
  v_and_b32 v3, 0xffff0000, v72
  v_add_f32 v56, v56, v2
  v_add_f32 v64, v64, v3
  v_lshlrev_b32 v2, 16, v73
  v_and_b32 v3, 0xffff0000, v73
  v_add_f32 v57, v57, v2
  v_add_f32 v65, v65, v3
  ds_read_b128 v[16:19], v9 offset:3072
  s_waitcnt vmcnt(11) lgkmcnt(2)
  v_mfma_f32_32x32x16_bf16 v[24:39], v[220:223], v[20:23], v[24:39]
  v_lshlrev_b32 v2, 16, v74
  v_and_b32 v3, 0xffff0000, v74
  v_add_f32 v58, v58, v2
  v_add_f32 v66, v66, v3
  v_lshlrev_b32 v2, 16, v75
  v_and_b32 v3, 0xffff0000, v75
  v_add_f32 v59, v59, v2
  v_add_f32 v67, v67, v3
  s_add_u32 s63, s35, 7
  s_and_b32 s63, s63, 7
  s_lshl_b32 s63, s63, 12
  v_add_u32 v9, s63, v10
  ds_read_b128 v[20:23], v9 offset:0
  s_waitcnt vmcnt(9) lgkmcnt(2)
  v_mfma_f32_32x32x16_bf16 v[24:39], v[224:227], v[4:7], v[24:39]
  v_lshlrev_b32 v2, 16, v76
  v_and_b32 v3, 0xffff0000, v76
  v_add_f32 v60, v60, v2
  v_add_f32 v68, v68, v3
  v_lshlrev_b32 v2, 16, v77
  v_and_b32 v3, 0xffff0000, v77
  v_add_f32 v61, v61, v2
  v_add_f32 v69, v69, v3
  ds_read_b128 v[4:7], v9 offset:1024
  s_waitcnt vmcnt(8) lgkmcnt(2)
  v_mfma_f32_32x32x16_bf16 v[24:39], v[228:231], v[16:19], v[24:39]
  v_lshlrev_b32 v2, 16, v78
  v_and_b32 v3, 0xffff0000, v78
  v_add_f32 v62, v62, v2
  v_add_f32 v70, v70, v3
  v_lshlrev_b32 v2, 16, v79
  v_and_b32 v3, 0xffff0000, v79
  v_add_f32 v63, v63, v2
  v_add_f32 v71, v71, v3
  ds_read_b128 v[16:19], v9 offset:2048
  s_waitcnt vmcnt(6) lgkmcnt(2)
  v_mfma_f32_32x32x16_bf16 v[24:39], v[232:235], v[20:23], v[24:39]
  v_lshlrev_b32 v2, 16, v80
  v_and_b32 v3, 0xffff0000, v80
  v_add_f32 v56, v56, v2
  v_add_f32 v64, v64, v3
  v_lshlrev_b32 v2, 16, v81
  v_and_b32 v3, 0xffff0000, v81
  v_add_f32 v57, v57, v2
  v_add_f32 v65, v65, v3
  ds_read_b128 v[20:23], v9 offset:3072
  s_waitcnt vmcnt(5) lgkmcnt(2)
  v_mfma_f32_32x32x16_bf16 v[24:39], v[236:239], v[4:7], v[24:39]
  v_lshlrev_b32 v2, 16, v82
  v_and_b32 v3, 0xffff0000, v82
  v_add_f32 v58, v58, v2
  v_add_f32 v66, v66, v3
  v_lshlrev_b32 v2, 16, v83
  v_and_b32 v3, 0xffff0000, v83
  v_add_f32 v59, v59, v2
  v_add_f32 v67, v67, v3
  ds_read_b128 v[4:7], v10 offset:32768
  s_waitcnt vmcnt(3) lgkmcnt(2)
  v_mfma_f32_32x32x16_bf16 v[24:39], v[240:243], v[16:19], v[24:39]
  v_lshlrev_b32 v2, 16, v84
  v_and_b32 v3, 0xffff0000, v84
  v_add_f32 v60, v60, v2
  v_add_f32 v68, v68, v3
  v_lshlrev_b32 v2, 16, v85
  v_and_b32 v3, 0xffff0000, v85
  v_add_f32 v61, v61, v2
  v_add_f32 v69, v69, v3
  s_waitcnt vmcnt(2) lgkmcnt(1)
  v_mfma_f32_32x32x16_bf16 v[24:39], v[244:247], v[20:23], v[24:39]
  v_lshlrev_b32 v2, 16, v86
  v_and_b32 v3, 0xffff0000, v86
  v_add_f32 v62, v62, v2
  v_add_f32 v70, v70, v3
  v_lshlrev_b32 v2, 16, v87
  v_and_b32 v3, 0xffff0000, v87
  v_add_f32 v63, v63, v2
  v_add_f32 v71, v71, v3
  s_waitcnt vmcnt(0) lgkmcnt(0)
  v_mfma_f32_32x32x16_bf16 v[24:39], v[248:251], v[4:7], v[24:39]
  s_nop 7
  s_nop 7
  s_lshl_b32 s45, s32, 12
  s_add_u32 s45, s45, 73728
  v_add_u32 v2, s45, v1
  s_xor_b32 s46, s32, 1
  s_lshl_b32 s46, s46, 12
  s_add_u32 s46, s46, 73728
  v_add_u32 v3, s46, v1
  ds_write_b128 v2, v[24:27] offset:0
  ds_write_b128 v2, v[28:31] offset:1024
  ds_write_b128 v2, v[32:35] offset:2048
  ds_write_b128 v2, v[36:39] offset:3072
  s_waitcnt lgkmcnt(0)
  s_barrier
  ds_read_b128 v[120:123], v3 offset:0
  ds_read_b128 v[124:127], v3 offset:1024
  ds_read_b128 v[128:131], v3 offset:2048
  ds_read_b128 v[132:135], v3 offset:3072
  s_waitcnt vmcnt(1)
  v_lshlrev_b32 v2, 16, v88
  v_and_b32 v3, 0xffff0000, v88
  v_add_f32 v56, v56, v2
  v_add_f32 v64, v64, v3
  v_lshlrev_b32 v2, 16, v89
  v_and_b32 v3, 0xffff0000, v89
  v_add_f32 v57, v57, v2
  v_add_f32 v65, v65, v3
  v_lshlrev_b32 v2, 16, v90
  v_and_b32 v3, 0xffff0000, v90
  v_add_f32 v58, v58, v2
  v_add_f32 v66, v66, v3
  v_lshlrev_b32 v2, 16, v91
  v_and_b32 v3, 0xffff0000, v91
  v_add_f32 v59, v59, v2
  v_add_f32 v67, v67, v3
  v_lshlrev_b32 v2, 16, v92
  v_and_b32 v3, 0xffff0000, v92
  v_add_f32 v60, v60, v2
  v_add_f32 v68, v68, v3
  v_lshlrev_b32 v2, 16, v93
  v_and_b32 v3, 0xffff0000, v93
  v_add_f32 v61, v61, v2
  v_add_f32 v69, v69, v3
  v_lshlrev_b32 v2, 16, v94
  v_and_b32 v3, 0xffff0000, v94
  v_add_f32 v62, v62, v2
  v_add_f32 v70, v70, v3
  v_lshlrev_b32 v2, 16, v95
  v_and_b32 v3, 0xffff0000, v95
  v_add_f32 v63, v63, v2
  v_add_f32 v71, v71, v3
  v_lshlrev_b32 v2, 16, v96
  v_and_b32 v3, 0xffff0000, v96
  v_add_f32 v56, v56, v2
  v_add_f32 v64, v64, v3
  v_lshlrev_b32 v2, 16, v97
  v_and_b32 v3, 0xffff0000, v97
  v_add_f32 v57, v57, v2
  v_add_f32 v65, v65, v3
  v_lshlrev_b32 v2, 16, v98
  v_and_b32 v3, 0xffff0000, v98
  v_add_f32 v58, v58, v2
  v_add_f32 v66, v66, v3
  v_lshlrev_b32 v2, 16, v99
  v_and_b32 v3, 0xffff0000, v99
  v_add_f32 v59, v59, v2
  v_add_f32 v67, v67, v3
  v_lshlrev_b32 v2, 16, v100
  v_and_b32 v3, 0xffff0000, v100
  v_add_f32 v60, v60, v2
  v_add_f32 v68, v68, v3
  v_lshlrev_b32 v2, 16, v101
  v_and_b32 v3, 0xffff0000, v101
  v_add_f32 v61, v61, v2
  v_add_f32 v69, v69, v3
  v_lshlrev_b32 v2, 16, v102
  v_and_b32 v3, 0xffff0000, v102
  v_add_f32 v62, v62, v2
  v_add_f32 v70, v70, v3
  v_lshlrev_b32 v2, 16, v103
  v_and_b32 v3, 0xffff0000, v103
  v_add_f32 v63, v63, v2
  v_add_f32 v71, v71, v3
  v_lshlrev_b32 v2, 16, v104
  v_and_b32 v3, 0xffff0000, v104
  v_add_f32 v56, v56, v2
  v_add_f32 v64, v64, v3
  v_lshlrev_b32 v2, 16, v105
  v_and_b32 v3, 0xffff0000, v105
  v_add_f32 v57, v57, v2
  v_add_f32 v65, v65, v3
  v_lshlrev_b32 v2, 16, v106
  v_and_b32 v3, 0xffff0000, v106
  v_add_f32 v58, v58, v2
  v_add_f32 v66, v66, v3
  v_lshlrev_b32 v2, 16, v107
  v_and_b32 v3, 0xffff0000, v107
  v_add_f32 v59, v59, v2
  v_add_f32 v67, v67, v3
  v_lshlrev_b32 v2, 16, v108
  v_and_b32 v3, 0xffff0000, v108
  v_add_f32 v60, v60, v2
  v_add_f32 v68, v68, v3
  v_lshlrev_b32 v2, 16, v109
  v_and_b32 v3, 0xffff0000, v109
  v_add_f32 v61, v61, v2
  v_add_f32 v69, v69, v3
  v_lshlrev_b32 v2, 16, v110
  v_and_b32 v3, 0xffff0000, v110
  v_add_f32 v62, v62, v2
  v_add_f32 v70, v70, v3
  v_lshlrev_b32 v2, 16, v111
  v_and_b32 v3, 0xffff0000, v111
  v_add_f32 v63, v63, v2
  v_add_f32 v71, v71, v3
  v_lshlrev_b32 v2, 16, v112
  v_and_b32 v3, 0xffff0000, v112
  v_add_f32 v56, v56, v2
  v_add_f32 v64, v64, v3
  v_lshlrev_b32 v2, 16, v113
  v_and_b32 v3, 0xffff0000, v113
  v_add_f32 v57, v57, v2
  v_add_f32 v65, v65, v3
  v_lshlrev_b32 v2, 16, v114
  v_and_b32 v3, 0xffff0000, v114
  v_add_f32 v58, v58, v2
  v_add_f32 v66, v66, v3
  v_lshlrev_b32 v2, 16, v115
  v_and_b32 v3, 0xffff0000, v115
  v_add_f32 v59, v59, v2
  v_add_f32 v67, v67, v3
  v_lshlrev_b32 v2, 16, v116
  v_and_b32 v3, 0xffff0000, v116
  v_add_f32 v60, v60, v2
  v_add_f32 v68, v68, v3
  v_lshlrev_b32 v2, 16, v117
  v_and_b32 v3, 0xffff0000, v117
  v_add_f32 v61, v61, v2
  v_add_f32 v69, v69, v3
  v_lshlrev_b32 v2, 16, v118
  v_and_b32 v3, 0xffff0000, v118
  v_add_f32 v62, v62, v2
  v_add_f32 v70, v70, v3
  v_lshlrev_b32 v2, 16, v119
  v_and_b32 v3, 0xffff0000, v119
  v_add_f32 v63, v63, v2
  v_add_f32 v71, v71, v3
  s_waitcnt lgkmcnt(0)
  s_cmp_eq_u32 s37, 0
  s_cselect_b32 s45, 1.0, 0xbf800000
  v_fma_f32 v24, s45, v24, v120
  v_fma_f32 v25, s45, v25, v121
  v_fma_f32 v26, s45, v26, v122
  v_fma_f32 v27, s45, v27, v123
  v_fma_f32 v28, s45, v28, v124
  v_fma_f32 v29, s45, v29, v125
  v_fma_f32 v30, s45, v30, v126
  v_fma_f32 v31, s45, v31, v127
  v_fma_f32 v32, s45, v32, v128
  v_fma_f32 v33, s45, v33, v129
  v_fma_f32 v34, s45, v34, v130
  v_fma_f32 v35, s45, v35, v131
  v_fma_f32 v36, s45, v36, v132
  v_fma_f32 v37, s45, v37, v133
  v_fma_f32 v38, s45, v38, v134
  v_fma_f32 v39, s45, v39, v135
  v_sub_f32 v24, v24, v56
  v_fma_f32 v24, v14, v24, v56
  v_sub_f32 v25, v25, v64
  v_fma_f32 v25, v14, v25, v64
  v_sub_f32 v26, v26, v57
  v_fma_f32 v26, v14, v26, v57
  v_sub_f32 v27, v27, v65
  v_fma_f32 v27, v14, v27, v65
  v_sub_f32 v28, v28, v58
  v_fma_f32 v28, v14, v28, v58
  v_sub_f32 v29, v29, v66
  v_fma_f32 v29, v14, v29, v66
  v_sub_f32 v30, v30, v59
  v_fma_f32 v30, v14, v30, v59
  v_sub_f32 v31, v31, v67
  v_fma_f32 v31, v14, v31, v67
  v_sub_f32 v32, v32, v60
  v_fma_f32 v32, v14, v32, v60
  v_sub_f32 v33, v33, v68
  v_fma_f32 v33, v14, v33, v68
  v_sub_f32 v34, v34, v61
  v_fma_f32 v34, v14, v34, v61
  v_sub_f32 v35, v35, v69
  v_fma_f32 v35, v14, v35, v69
  v_sub_f32 v36, v36, v62
  v_fma_f32 v36, v14, v36, v62
  v_sub_f32 v37, v37, v70
  v_fma_f32 v37, v14, v37, v70
  v_sub_f32 v38, v38, v63
  v_fma_f32 v38, v14, v38, v63
  v_sub_f32 v39, v39, v71
  v_fma_f32 v39, v14, v39, v71
  v_cvt_pk_bf16_f32 v56, v24, v25
  v_cvt_pk_bf16_f32 v57, v26, v27
  v_cvt_pk_bf16_f32 v58, v28, v29
  v_cvt_pk_bf16_f32 v59, v30, v31
  v_cvt_pk_bf16_f32 v60, v32, v33
  v_cvt_pk_bf16_f32 v61, v34, v35
  v_cvt_pk_bf16_f32 v62, v36, v37
  v_cvt_pk_bf16_f32 v63, v38, v39
  s_nop 1
  v_permlane32_swap_b32 v56, v58
  v_permlane32_swap_b32 v57, v59
  v_permlane32_swap_b32 v60, v62
  v_permlane32_swap_b32 v61, v63
  v_mul_u32_u24 v2, 1152, v15
  v_lshrrev_b32 v6, 5, v0
  v_lshl_add_u32 v2, v6, 4, v2
  v_and_b32 v3, 31, v0
  v_mov_b32 v4, 0x7ff00000
  s_or_b32 s44, s35, s33
  s_cmp_ge_u32 s38, 2
  s_cselect_b32 s45, s44, 1
  s_cmp_eq_u32 s45, 0
  s_cbranch_scc0 K2_st
  s_cmp_eq_u32 s34, 2
  s_cbranch_scc1 K2_onlyc0
  v_cmp_eq_u32 vcc, 0, v3
  s_nop 1
  v_cndmask_b32 v2, v2, v4, vcc
  s_branch K2_st
K2_onlyc0:
  v_cmp_eq_u32 vcc, 0, v3
  s_nop 1
  v_cndmask_b32 v2, v4, v2, vcc
K2_st:
  s_lshl_b32 s59, s36, 6
  buffer_store_dwordx4 v[56:59], v2, s[20:23], s59 offen
  buffer_store_dwordx4 v[60:63], v2, s[20:23], s59 offen offset:32
K2_end:
  s_endpgm
K2_codeend:
.section .rodata,"a"
.p2align 6
.amdhsa_kernel k2_kernel
  .amdhsa_next_free_vgpr 256
  .amdhsa_next_free_sgpr 80
  .amdhsa_accum_offset 256
  .amdhsa_group_segment_fixed_size 0
  .amdhsa_kernarg_size 104
  .amdhsa_user_sgpr_count 2
  .amdhsa_user_sgpr_kernarg_segment_ptr 1
  .amdhsa_system_sgpr_workgroup_id_x 1
  .amdhsa_float_denorm_mode_32 3
.end_amdhsa_kernel
.text
```
